```python
import torch

def _softmax(x, axis=-1):
    return torch.softmax(x, dim=axis)
def _gelu(x):
    return torch.nn.functional.gelu(x, approximate="tanh")
def _silu(x):
    return torch.nn.functional.silu(x)
def _sigmoid(x):
    return torch.sigmoid(x)
def _layernorm(x, axis=-1, eps=1e-5):
    m = x.mean(dim=axis, keepdim=True)
    v = x.var(dim=axis, keepdim=True, unbiased=False)
    return (x - m) / torch.sqrt(v + eps)
def _scatter_add(tgt, idx, src, axis=0):
    return tgt.clone().index_add_(axis, idx, src)
def _segment_sum(src, seg, n):
    out = torch.zeros((n,) + src.shape[1:], dtype=src.dtype)
    return out.index_add_(0, seg, src)
def _pad(x, pw):
    flat = tuple(v for pair in reversed(pw) for v in pair)
    return torch.nn.functional.pad(x, flat)

kernel_name = 'gated_mix__sliding_local_dilated__mixer_s_mlp__prompt'

def setup_inputs():

    _w = (lambda a: (lambda t: t.to(torch.bfloat16) if t.is_floating_point() else t)(torch.as_tensor(a)))
    def _A_setup():
        B, S, D = 1, 2048, 576
        return {
            "x": _w((lambda *s: torch.randn(*s, dtype=torch.bfloat16) * 0.05)(B, S, D)),
            "wqkv": _w((lambda *s: torch.randn(*s, dtype=torch.bfloat16) * 1.6)(D, 3 * D)),
            "wo": _w((lambda *s: torch.randn(*s, dtype=torch.bfloat16) * 0.05)(D, D)),
        }
    _A_in = _A_setup()

    def _B_setup():
        B, S, D, F = 1, 2048, 576, 4608
        return {
            "x":  _w((lambda *s: torch.randn(*s, dtype=torch.bfloat16) * 0.05)(B, S, D)),
            "w1": _w((lambda *s: torch.randn(*s, dtype=torch.bfloat16) * 3.2)(D, D) * (D ** -0.5)),
            "w2": _w((lambda *s: torch.randn(*s, dtype=torch.bfloat16) * 3.2)(D, D) * (D ** -0.5)),
            "w3": _w((lambda *s: torch.randn(*s, dtype=torch.bfloat16) * 3.2)(D, F) * (D ** -0.5)),
            "w4": _w((lambda *s: torch.randn(*s, dtype=torch.bfloat16) * 3.2)(F, D) * (F ** -0.5)),
        }
    _B_in = _B_setup()

    return {
        "A_x": _A_in["x"],
        "A_wqkv": _A_in["wqkv"],
        "A_wo": _A_in["wo"],
        "B_x": _B_in["x"],
        "B_w1": _B_in["w1"],
        "B_w2": _B_in["w2"],
        "B_w3": _B_in["w3"],
        "B_w4": _B_in["w4"],
        "gate_w": _w((lambda *s: torch.randn(*s, dtype=torch.bfloat16) * 0.05)(576) * 16.0),
    }

def reference(A_x, A_wqkv, A_wo, B_x, B_w1, B_w2, B_w3, B_w4, gate_w):
    def _A_ref(x, wqkv, wo):
        B, S, D = x.shape
        H = 32; Dh = D // H
        W, dil = 8, 2
        qkv = (lambda x, *d: x.permute(*d))((x @ wqkv).reshape(B, S, 3, H, Dh), 2, 0, 3, 1, 4)
        q, k, v = qkv[0], qkv[1], qkv[2]
        scale = Dh ** -0.5
        pos = torch.arange(S)
        off = torch.arange(W) * dil
        idx = pos[:, None] - off[None, :]
        mask = idx >= 0
        idx_c = torch.where(mask, idx, 0).reshape(-1)
        kg = k[:, :, idx_c, :].reshape(B, H, S, W, Dh)
        vg = v[:, :, idx_c, :].reshape(B, H, S, W, Dh)
        logits = torch.einsum("bhsd,bhswd->bhsw", q, kg) * scale
        logits = torch.where(mask[None, None, :, :], logits, -1e9)
        attn = _softmax(logits, axis=-1)
        o = torch.einsum("bhsw,bhswd->bhsd", attn, vg)
        return (lambda x, *d: x.permute(*d))(o, 0, 2, 1, 3).reshape(B, S, D) @ wo

    def _B_ref(x, w1, w2, w3, w4):
        B, S, D = x.shape
        h = _gelu(_layernorm(x, axis=-1) @ w1)
        c = D // 4
        g0 = _pad(h[:, :, 0*c:1*c], ((0, 0), (1, 0), (0, 0)))[:, :S, :]
        g1 = _pad(h[:, :, 1*c:2*c], ((0, 0), (0, 1), (0, 0)))[:, 1:, :]
        g2 = _pad(h[:, :, 2*c:3*c], ((0, 0), (2, 0), (0, 0)))[:, :S, :]
        g3 = _pad(h[:, :, 3*c:   ], ((0, 0), (0, 2), (0, 0)))[:, 2:, :]
        hs = torch.concatenate([g0, g1, g2, g3], axis=-1) @ w2
        x1 = x + hs
        h2 = _gelu(_layernorm(x1, axis=-1) @ w3) @ w4
        return x1 + h2

    x = A_x
    g = _sigmoid((x * gate_w).sum(-1, keepdims=True))
    a = _A_ref(x, A_wqkv, A_wo)
    b = _B_ref(x, B_w1, B_w2, B_w3, B_w4)
    return g * a + (1 - g) * b
```

```asm
; @launch grid=(256,1,1) block=(256,1,1) lds=161408
.amdgcn_target "amdgcn-amd-amdhsa--gfx950"
.text
.globl gated_mix__sliding_local_dilated__mixer_s_mlp__prompt_kernel
.p2align 8
.type gated_mix__sliding_local_dilated__mixer_s_mlp__prompt_kernel,@function
gated_mix__sliding_local_dilated__mixer_s_mlp__prompt_kernel:
s_cmp_ge_u32 s2, 256
s_cbranch_scc1 L_end
s_load_dwordx2 s[4:5], s[0:1], 0
s_load_dwordx2 s[8:9], s[0:1], 8
s_load_dwordx2 s[12:13], s[0:1], 16
s_load_dwordx8 s[72:79], s[0:1], 32
s_load_dwordx8 s[80:87], s[0:1], 64
v_lshrrev_b32 v1, 6, v0
v_and_b32 v0, 63, v0
v_readfirstlane_b32 s50, v1
s_getpc_b64 s[68:69]
L_pc:
s_sub_u32 s68, s68, L_pc-gated_mix__sliding_local_dilated__mixer_s_mlp__prompt_kernel
s_subb_u32 s69, s69, 0
s_mov_b32 s70, L_end-gated_mix__sliding_local_dilated__mixer_s_mlp__prompt_kernel
s_mov_b32 s71, 0x20000
s_lshr_b32 s52, s2, 3
s_lshl_b32 s52, s52, 2
s_add_u32 s52, s52, s50
s_lshl_b32 s52, s52, 9
v_lshlrev_b32 v1, 3, v0
buffer_load_dwordx2 a[250:251], v1, s[68:71], s52 offen
v_lshlrev_b32 v59, 4, v0
s_and_b32 s52, s2, 3
s_lshl_b32 s52, s52, 1
s_lshr_b32 s53, s2, 3
s_and_b32 s53, s53, 1
s_add_u32 s49, s52, s53
s_and_b32 s52, s2, 7
s_lshr_b32 s52, s52, 2
s_lshl_b32 s52, s52, 4
s_lshr_b32 s53, s2, 4
s_add_u32 s48, s52, s53
s_lshl_b32 s63, s48, 2
s_add_u32 s63, s63, s50
s_cmp_lt_u32 s63, 72
s_cselect_b32 s90, s63, 1000
s_add_u32 s91, s63, 34
s_cmp_ge_u32 s63, 94
s_cselect_b32 s91, s91, 1000
s_mul_i32 s52, s49, 144
s_and_b32 s60, s52, 0xffffff80
s_mov_b32 s6, 2359296
s_mov_b32 s7, 0x20000
s_mov_b32 s10, 1990656
s_mov_b32 s11, 0x20000
s_mov_b32 s14, 663552
s_mov_b32 s15, 0x20000
s_mov_b32 s18, 663552
s_mov_b32 s19, 0x20000
s_mov_b32 s22, 663552
s_mov_b32 s23, 0x20000
s_mov_b32 s26, 5308416
s_mov_b32 s27, 0x20000
s_mov_b32 s30, 5308416
s_mov_b32 s31, 0x20000
s_mov_b32 s34, 1152
s_mov_b32 s35, 0x20000
s_mov_b32 s38, 2359296
s_mov_b32 s39, 0x20000
s_mov_b32 s42, 256
s_mov_b32 s43, 0x20000
s_mov_b32 s46, 38237184
s_mov_b32 s47, 0x20000
s_mul_i32 s52, s63, 18432
s_mul_i32 s53, s50, 18432
s_add_u32 s53, s53, 86016
s_mov_b32 m0, s53
v_add_u32 v1, 0, v0
v_mul_u32_u24 v2, 911, v1
v_lshrrev_b32 v2, 17, v2
v_xor_b32 v1, v1, v2
v_lshlrev_b32 v184, 4, v1
v_add_u32 v1, 64, v0
v_mul_u32_u24 v2, 911, v1
v_lshrrev_b32 v2, 17, v2
v_xor_b32 v1, v1, v2
v_subrev_u32 v1, 64, v1
v_lshlrev_b32 v185, 4, v1
v_add_u32 v1, 128, v0
v_mul_u32_u24 v2, 911, v1
v_lshrrev_b32 v2, 17, v2
v_xor_b32 v1, v1, v2
v_subrev_u32 v1, 128, v1
v_lshlrev_b32 v186, 4, v1
v_add_u32 v1, 192, v0
v_mul_u32_u24 v2, 911, v1
v_lshrrev_b32 v2, 17, v2
v_xor_b32 v1, v1, v2
v_subrev_u32 v1, 192, v1
v_lshlrev_b32 v187, 4, v1
v_add_u32 v1, 256, v0
v_mul_u32_u24 v2, 911, v1
v_lshrrev_b32 v2, 17, v2
v_xor_b32 v1, v1, v2
v_lshlrev_b32 v188, 4, v1
v_add_u32 v1, 320, v0
v_mul_u32_u24 v2, 911, v1
v_lshrrev_b32 v2, 17, v2
v_xor_b32 v1, v1, v2
v_subrev_u32 v1, 64, v1
v_lshlrev_b32 v189, 4, v1
v_add_u32 v1, 384, v0
v_mul_u32_u24 v2, 911, v1
v_lshrrev_b32 v2, 17, v2
v_xor_b32 v1, v1, v2
v_subrev_u32 v1, 128, v1
v_lshlrev_b32 v190, 4, v1
v_add_u32 v1, 448, v0
v_mul_u32_u24 v2, 911, v1
v_lshrrev_b32 v2, 17, v2
v_xor_b32 v1, v1, v2
v_subrev_u32 v1, 192, v1
v_lshlrev_b32 v191, 4, v1
v_add_u32 v1, 512, v0
v_mul_u32_u24 v2, 911, v1
v_lshrrev_b32 v2, 17, v2
v_xor_b32 v1, v1, v2
v_lshlrev_b32 v192, 4, v1
v_add_u32 v1, 576, v0
v_mul_u32_u24 v2, 911, v1
v_lshrrev_b32 v2, 17, v2
v_xor_b32 v1, v1, v2
v_subrev_u32 v1, 64, v1
v_lshlrev_b32 v193, 4, v1
v_add_u32 v1, 640, v0
v_mul_u32_u24 v2, 911, v1
v_lshrrev_b32 v2, 17, v2
v_xor_b32 v1, v1, v2
v_subrev_u32 v1, 128, v1
v_lshlrev_b32 v194, 4, v1
v_add_u32 v1, 704, v0
v_mul_u32_u24 v2, 911, v1
v_lshrrev_b32 v2, 17, v2
v_xor_b32 v1, v1, v2
v_subrev_u32 v1, 192, v1
v_lshlrev_b32 v195, 4, v1
v_add_u32 v1, 768, v0
v_mul_u32_u24 v2, 911, v1
v_lshrrev_b32 v2, 17, v2
v_xor_b32 v1, v1, v2
v_lshlrev_b32 v196, 4, v1
v_add_u32 v1, 832, v0
v_mul_u32_u24 v2, 911, v1
v_lshrrev_b32 v2, 17, v2
v_xor_b32 v1, v1, v2
v_subrev_u32 v1, 64, v1
v_lshlrev_b32 v197, 4, v1
v_add_u32 v1, 896, v0
v_mul_u32_u24 v2, 911, v1
v_lshrrev_b32 v2, 17, v2
v_xor_b32 v1, v1, v2
v_subrev_u32 v1, 128, v1
v_lshlrev_b32 v198, 4, v1
v_add_u32 v1, 960, v0
v_mul_u32_u24 v2, 911, v1
v_lshrrev_b32 v2, 17, v2
v_xor_b32 v1, v1, v2
v_subrev_u32 v1, 192, v1
v_lshlrev_b32 v199, 4, v1
v_add_u32 v1, 1024, v0
v_mul_u32_u24 v2, 911, v1
v_lshrrev_b32 v2, 17, v2
v_xor_b32 v1, v1, v2
v_lshlrev_b32 v200, 4, v1
v_add_u32 v1, 1088, v0
v_mul_u32_u24 v2, 911, v1
v_lshrrev_b32 v2, 17, v2
v_xor_b32 v1, v1, v2
v_subrev_u32 v1, 64, v1
v_lshlrev_b32 v201, 4, v1
s_waitcnt lgkmcnt(0)
buffer_load_dwordx4 v184, s[4:7], s52 offen offset:0 lds
buffer_load_dwordx4 v185, s[4:7], s52 offen offset:1024 lds
buffer_load_dwordx4 v186, s[4:7], s52 offen offset:2048 lds
buffer_load_dwordx4 v187, s[4:7], s52 offen offset:3072 lds
s_add_u32 m0, s53, 4096
s_nop 0
buffer_load_dwordx4 v188, s[4:7], s52 offen offset:0 lds
buffer_load_dwordx4 v189, s[4:7], s52 offen offset:1024 lds
buffer_load_dwordx4 v190, s[4:7], s52 offen offset:2048 lds
buffer_load_dwordx4 v191, s[4:7], s52 offen offset:3072 lds
s_add_u32 m0, s53, 8192
s_nop 0
buffer_load_dwordx4 v192, s[4:7], s52 offen offset:0 lds
buffer_load_dwordx4 v193, s[4:7], s52 offen offset:1024 lds
buffer_load_dwordx4 v194, s[4:7], s52 offen offset:2048 lds
buffer_load_dwordx4 v195, s[4:7], s52 offen offset:3072 lds
s_add_u32 m0, s53, 12288
s_nop 0
buffer_load_dwordx4 v196, s[4:7], s52 offen offset:0 lds
buffer_load_dwordx4 v197, s[4:7], s52 offen offset:1024 lds
buffer_load_dwordx4 v198, s[4:7], s52 offen offset:2048 lds
buffer_load_dwordx4 v199, s[4:7], s52 offen offset:3072 lds
s_add_u32 m0, s53, 16384
s_nop 0
buffer_load_dwordx4 v200, s[4:7], s52 offen offset:0 lds
buffer_load_dwordx4 v201, s[4:7], s52 offen offset:1024 lds
s_mov_b32 s16, s72
s_mov_b32 s17, s73
s_mov_b32 s20, s74
s_mov_b32 s21, s75
s_mov_b32 s24, s76
s_mov_b32 s25, s77
s_mov_b32 s28, s78
s_mov_b32 s29, s79
s_mov_b32 s32, s80
s_mov_b32 s33, s81
s_mov_b32 s36, s82
s_mov_b32 s37, s83
s_mov_b32 s40, s84
s_mov_b32 s41, s85
s_mov_b32 s44, s86
s_mov_b32 s45, s87
s_mov_b32 s76, s28
s_mov_b32 s77, s29
s_mov_b32 s78, 5308416
s_mov_b32 s79, 0x20000
s_mul_i32 s54, s50, 288
s_add_u32 m0, s54, 160000
s_mov_b64 exec, 0x3ffff
buffer_load_dwordx4 v59, s[32:35], s54 offen lds
s_mov_b64 exec, -1
s_xor_b32 s52, s2, 36
s_xor_b32 s53, s50, 0
s_or_b32 s52, s52, s53
s_cmp_lg_u32 s52, 0
s_cbranch_scc1 L_nolead_1
v_add_u32 v1, 37953536, v59
buffer_load_dwordx4 v[112:115], v1, s[44:47], 0 offen offset:0 sc0 sc1
buffer_load_dwordx4 v[116:119], v1, s[44:47], 0 offen offset:1024 sc0 sc1
buffer_load_dwordx4 v[120:123], v1, s[44:47], 0 offen offset:2048 sc0 sc1
buffer_load_dwordx4 v[124:127], v1, s[44:47], 0 offen offset:3072 sc0 sc1
v_add_u32 v1, 4096, v1
buffer_load_dwordx4 v[128:131], v1, s[44:47], 0 offen offset:0 sc0 sc1
v_lshrrev_b32 v1, 1, v0
v_mul_u32_u24 v1, 128, v1
v_and_b32 v2, 1, v0
v_lshl_add_u32 v1, v2, 4, v1
v_add_u32 v1, 37958656, v1
buffer_load_dwordx4 v[132:135], v1, s[44:47], 0 offen sc0 sc1
v_add_u32 v1, 4096, v1
buffer_load_dwordx4 v[136:139], v1, s[44:47], 0 offen sc0 sc1
v_add_u32 v1, 4096, v1
buffer_load_dwordx4 v[140:143], v1, s[44:47], 0 offen sc0 sc1
v_add_u32 v1, 4096, v1
buffer_load_dwordx4 v[144:147], v1, s[44:47], 0 offen sc0 sc1
s_waitcnt vmcnt(0)
v_lshrrev_b32 v112, 3, v112
v_lshrrev_b32 v113, 3, v113
v_lshrrev_b32 v114, 3, v114
v_lshrrev_b32 v115, 3, v115
v_lshrrev_b32 v116, 3, v116
v_lshrrev_b32 v117, 3, v117
v_lshrrev_b32 v118, 3, v118
v_lshrrev_b32 v119, 3, v119
v_lshrrev_b32 v120, 3, v120
v_lshrrev_b32 v121, 3, v121
v_lshrrev_b32 v122, 3, v122
v_lshrrev_b32 v123, 3, v123
v_lshrrev_b32 v124, 3, v124
v_lshrrev_b32 v125, 3, v125
v_lshrrev_b32 v126, 3, v126
v_lshrrev_b32 v127, 3, v127
v_lshrrev_b32 v128, 3, v128
v_lshrrev_b32 v129, 3, v129
v_lshrrev_b32 v130, 3, v130
v_lshrrev_b32 v131, 3, v131
v_lshrrev_b32 v132, 3, v132
v_lshrrev_b32 v133, 3, v133
v_lshrrev_b32 v134, 3, v134
v_lshrrev_b32 v135, 3, v135
v_lshrrev_b32 v136, 3, v136
v_lshrrev_b32 v137, 3, v137
v_lshrrev_b32 v138, 3, v138
v_lshrrev_b32 v139, 3, v139
v_lshrrev_b32 v140, 3, v140
v_lshrrev_b32 v141, 3, v141
v_lshrrev_b32 v142, 3, v142
v_lshrrev_b32 v143, 3, v143
v_lshrrev_b32 v144, 3, v144
v_lshrrev_b32 v145, 3, v145
v_lshrrev_b32 v146, 3, v146
v_lshrrev_b32 v147, 3, v147
s_mov_b32 s52, 0
L_cand_2:
s_add_u32 s52, s52, 1
s_mov_b64 s[56:57], 0
v_cmp_eq_u32 vcc, s52, v112
s_nop 0
s_or_b64 s[56:57], s[56:57], vcc
v_cmp_eq_u32 vcc, s52, v113
s_nop 0
s_or_b64 s[56:57], s[56:57], vcc
v_cmp_eq_u32 vcc, s52, v114
s_nop 0
s_or_b64 s[56:57], s[56:57], vcc
v_cmp_eq_u32 vcc, s52, v115
s_nop 0
s_or_b64 s[56:57], s[56:57], vcc
v_cmp_eq_u32 vcc, s52, v116
s_nop 0
s_or_b64 s[56:57], s[56:57], vcc
v_cmp_eq_u32 vcc, s52, v117
s_nop 0
s_or_b64 s[56:57], s[56:57], vcc
v_cmp_eq_u32 vcc, s52, v118
s_nop 0
s_or_b64 s[56:57], s[56:57], vcc
v_cmp_eq_u32 vcc, s52, v119
s_nop 0
s_or_b64 s[56:57], s[56:57], vcc
v_cmp_eq_u32 vcc, s52, v120
s_nop 0
s_or_b64 s[56:57], s[56:57], vcc
v_cmp_eq_u32 vcc, s52, v121
s_nop 0
s_or_b64 s[56:57], s[56:57], vcc
v_cmp_eq_u32 vcc, s52, v122
s_nop 0
s_or_b64 s[56:57], s[56:57], vcc
v_cmp_eq_u32 vcc, s52, v123
s_nop 0
s_or_b64 s[56:57], s[56:57], vcc
v_cmp_eq_u32 vcc, s52, v124
s_nop 0
s_or_b64 s[56:57], s[56:57], vcc
v_cmp_eq_u32 vcc, s52, v125
s_nop 0
s_or_b64 s[56:57], s[56:57], vcc
v_cmp_eq_u32 vcc, s52, v126
s_nop 0
s_or_b64 s[56:57], s[56:57], vcc
v_cmp_eq_u32 vcc, s52, v127
s_nop 0
s_or_b64 s[56:57], s[56:57], vcc
v_cmp_eq_u32 vcc, s52, v128
s_nop 0
s_or_b64 s[56:57], s[56:57], vcc
v_cmp_eq_u32 vcc, s52, v129
s_nop 0
s_or_b64 s[56:57], s[56:57], vcc
v_cmp_eq_u32 vcc, s52, v130
s_nop 0
s_or_b64 s[56:57], s[56:57], vcc
v_cmp_eq_u32 vcc, s52, v131
s_nop 0
s_or_b64 s[56:57], s[56:57], vcc
v_cmp_eq_u32 vcc, s52, v132
s_nop 0
s_or_b64 s[56:57], s[56:57], vcc
v_cmp_eq_u32 vcc, s52, v133
s_nop 0
s_or_b64 s[56:57], s[56:57], vcc
v_cmp_eq_u32 vcc, s52, v134
s_nop 0
s_or_b64 s[56:57], s[56:57], vcc
v_cmp_eq_u32 vcc, s52, v135
s_nop 0
s_or_b64 s[56:57], s[56:57], vcc
v_cmp_eq_u32 vcc, s52, v136
s_nop 0
s_or_b64 s[56:57], s[56:57], vcc
v_cmp_eq_u32 vcc, s52, v137
s_nop 0
s_or_b64 s[56:57], s[56:57], vcc
v_cmp_eq_u32 vcc, s52, v138
s_nop 0
s_or_b64 s[56:57], s[56:57], vcc
v_cmp_eq_u32 vcc, s52, v139
s_nop 0
s_or_b64 s[56:57], s[56:57], vcc
v_cmp_eq_u32 vcc, s52, v140
s_nop 0
s_or_b64 s[56:57], s[56:57], vcc
v_cmp_eq_u32 vcc, s52, v141
s_nop 0
s_or_b64 s[56:57], s[56:57], vcc
v_cmp_eq_u32 vcc, s52, v142
s_nop 0
s_or_b64 s[56:57], s[56:57], vcc
v_cmp_eq_u32 vcc, s52, v143
s_nop 0
s_or_b64 s[56:57], s[56:57], vcc
v_cmp_eq_u32 vcc, s52, v144
s_nop 0
s_or_b64 s[56:57], s[56:57], vcc
v_cmp_eq_u32 vcc, s52, v145
s_nop 0
s_or_b64 s[56:57], s[56:57], vcc
v_cmp_eq_u32 vcc, s52, v146
s_nop 0
s_or_b64 s[56:57], s[56:57], vcc
v_cmp_eq_u32 vcc, s52, v147
s_nop 0
s_or_b64 s[56:57], s[56:57], vcc
s_cmp_ge_u32 s52, 2400
s_cbranch_scc1 L_cand_2_x
s_cmp_lg_u64 s[56:57], 0
s_cbranch_scc1 L_cand_2
L_cand_2_x:
v_mov_b32 v1, s52
v_mov_b32 v2, 0
s_mov_b64 exec, 1
buffer_store_dword v1, v2, s[40:43], 0 offen sc0 sc1
s_mov_b64 exec, -1
L_nolead_1:
s_mul_i32 s67, s49, 1778688
s_add_u32 s67, s67, 23724032
s_cmp_ge_u32 s90, 1000
s_cbranch_scc1 L_skip_3
s_mov_b32 s53, s90
s_mul_i32 s70, s53, 3641
s_lshr_b32 s70, s70, 16
s_mul_i32 s52, s70, 18
s_sub_u32 s71, s53, s52
s_cmp_eq_u32 s70, 3
s_cselect_b32 s76, s20, s8
s_cselect_b32 s77, s21, s9
s_mov_b32 s78, 1990656
s_cselect_b32 s78, 663552, s78
s_mov_b32 s79, 0x20000
s_mov_b32 s72, 3456
s_cselect_b32 s72, 1152, s72
s_add_u32 s52, s70, 1
s_mul_i32 s52, s52, 1152
s_cmp_ge_u32 s70, 2
s_cselect_b32 s52, 0, s52
s_mul_i32 s53, s71, s72
s_lshl_b32 s53, s53, 5
s_add_u32 s52, s52, s53
s_add_u32 s52, s52, s60
s_lshl_b32 s53, s72, 2
s_sub_u32 s53, s53, 1024
s_lshl_b32 s54, s50, 13
s_add_u32 m0, s54, 49152
v_lshrrev_b32 v1, 4, v0
v_and_b32 v2, 15, v0
v_lshlrev_b32 v3, 1, v1
v_xor_b32 v2, v2, v3
v_lshlrev_b32 v2, 4, v2
v_xor_b32 v3, 128, v2
v_mul_u32_u24 v1, s72, v1
v_add_u32 v2, v1, v2
v_add_u32 v3, v1, v3
buffer_load_dwordx4 v2, s[76:79], s52 offen offset:0 nt lds
s_add_u32 s52, s52, s53
buffer_load_dwordx4 v2, s[76:79], s52 offen offset:1024 nt lds
s_add_u32 s52, s52, s53
buffer_load_dwordx4 v3, s[76:79], s52 offen offset:2048 nt lds
s_add_u32 s52, s52, s53
buffer_load_dwordx4 v3, s[76:79], s52 offen offset:3072 nt lds
s_add_u32 s52, s52, 4096
s_add_u32 m0, s54, 53248
s_add_u32 s52, s52, s53
buffer_load_dwordx4 v2, s[76:79], s52 offen offset:0 nt lds
s_add_u32 s52, s52, s53
buffer_load_dwordx4 v2, s[76:79], s52 offen offset:1024 nt lds
s_add_u32 s52, s52, s53
buffer_load_dwordx4 v3, s[76:79], s52 offen offset:2048 nt lds
s_add_u32 s52, s52, s53
buffer_load_dwordx4 v3, s[76:79], s52 offen offset:3072 nt lds
L_skip_3:
s_mov_b32 s61, 0x3f803f80
s_mov_b32 s88, 0x00003f80
s_mov_b32 s89, 0x3f800000
s_mov_b32 s62, 0xffff0000
s_mul_i32 s64, s50, 18432
s_lshl_b32 s65, s50, 12
s_mov_b32 s66, 0xbdd2d3e8
v_mov_b32 v58, 0xc0135761
v_lshrrev_b32 v1, 4, v0
v_and_b32 v2, 15, v0
v_lshlrev_b32 v3, 1, v1
v_xor_b32 v3, v3, v2
v_lshlrev_b32 v3, 4, v3
v_xor_b32 v4, 128, v3
v_mul_u32_u24 v5, 1152, v1
v_add_u32 v110, v5, v3
v_add_u32 v111, v5, v4
v_lshrrev_b32 v1, 4, v0
v_and_b32 v2, 15, v0
v_lshrrev_b32 v3, 2, v2
v_and_b32 v4, 3, v0
v_and_b32 v5, 1, v1
v_lshlrev_b32 v5, 3, v5
v_lshl_or_b32 v5, v3, 1, v5
v_lshlrev_b32 v6, 11, v1
v_lshl_add_u32 v6, v3, 8, v6
v_and_b32 v7, 1, v4
v_lshl_add_u32 v6, v7, 3, v6
v_lshrrev_b32 v7, 1, v4
v_add_u32 v7, s49, v7
v_add_u32 v60, 0, v7
v_xor_b32 v60, v60, v5
v_lshl_add_u32 v105, v60, 4, v6
v_add_u32 v60, 2, v7
v_xor_b32 v60, v60, v5
v_lshl_add_u32 v106, v60, 4, v6
v_add_u32 v60, 4, v7
v_xor_b32 v60, v60, v5
v_lshl_add_u32 v107, v60, 4, v6
v_add_u32 v60, 6, v7
v_xor_b32 v60, v60, v5
v_lshl_add_u32 v108, v60, 4, v6
v_add_u32 v60, 8, v7
v_xor_b32 v60, v60, v5
v_lshl_add_u32 v109, v60, 4, v6
v_cmp_gt_u32 vcc, 2, v1
s_mul_i32 s52, s49, 9
v_and_b32 v5, 1, v1
v_lshlrev_b32 v5, 1, v5
v_lshrrev_b32 v6, 1, v1
v_add_u32 v5, v5, v6
v_add_u32 v5, s52, v5
s_mul_i32 s53, s50, 18432
s_add_u32 s53, s53, 86016
v_mul_u32_u24 v6, 1152, v2
v_add_u32 v6, s53, v6
v_lshrrev_b32 v7, 1, v2
v_mov_b32 v60, v5
v_lshrrev_b32 v50, 2, v60
v_lshlrev_b32 v50, 10, v50
v_and_b32 v61, 3, v60
v_lshl_add_u32 v50, v61, 8, v50
v_xor_b32 v60, v60, v7
v_lshl_add_u32 v62, v60, 4, v6
v_add_u32 v60, 4, v5
v_lshrrev_b32 v51, 2, v60
v_lshlrev_b32 v51, 10, v51
v_and_b32 v61, 3, v60
v_lshl_add_u32 v51, v61, 8, v51
v_xor_b32 v60, v60, v7
v_lshl_add_u32 v63, v60, 4, v6
s_add_u32 s54, s52, 8
v_mov_b32 v60, s54
v_lshrrev_b32 v52, 2, v60
v_lshlrev_b32 v52, 10, v52
v_and_b32 v61, 3, v60
v_lshl_add_u32 v52, v61, 8, v52
v_xor_b32 v60, v60, v7
v_lshl_add_u32 v64, v60, 4, v6
v_and_b32 v60, 1, v1
v_lshl_add_u32 v64, v60, 3, v64
v_lshl_add_u32 v52, v60, 3, v52
v_mov_b32 v60, 1073741824
v_cndmask_b32 v52, v60, v52, vcc
s_mul_i32 s53, s63, 18432
s_add_u32 s53, s53, 2359296
v_lshl_add_u32 v53, v2, 4, s53
s_lshr_b32 s53, s49, 2
s_add_u32 s53, s53, 1
s_sub_u32 s54, 0, s53
s_bitcmp1_b32 s49, 1
s_cselect_b32 s53, s54, s53
s_lshl_b32 s52, s63, 4
s_add_u32 s52, s52, s53
v_add_u32 v54, s52, v2
v_xor_b32 v5, v1, v7
v_lshl_add_u32 v66, v5, 4, v6
v_xor_b32 v5, 4, v5
v_lshl_add_u32 v67, v5, 4, v6
s_waitcnt vmcnt(1)
ds_read_b128 v[112:115], v66 offset:0
ds_read_b128 v[116:119], v67 offset:0
ds_read_b128 v[120:123], v66 offset:128
ds_read_b128 v[124:127], v67 offset:128
ds_read_b128 v[128:131], v66 offset:256
ds_read_b128 v[132:135], v67 offset:256
ds_read_b128 v[136:139], v66 offset:384
ds_read_b128 v[140:143], v67 offset:384
ds_read_b128 v[144:147], v66 offset:512
ds_read_b128 v[148:151], v67 offset:512
ds_read_b128 v[152:155], v66 offset:640
ds_read_b128 v[156:159], v67 offset:640
ds_read_b128 v[160:163], v66 offset:768
ds_read_b128 v[164:167], v67 offset:768
ds_read_b128 v[168:171], v66 offset:896
s_waitcnt lgkmcnt(13)
ds_read_b128 v[172:175], v67 offset:896
ds_read_b128 v[176:179], v66 offset:1024
s_waitcnt lgkmcnt(13)
ds_read_b128 v[180:183], v67 offset:1024
ds_read_b128 v[40:43], v62
s_waitcnt lgkmcnt(13)
ds_read_b128 v[44:47], v63
ds_read_b64 v[48:49], v64
s_add_u32 s59, s64, s60
s_add_u32 s59, s59, 0
s_add_u32 m0, s65, 0
s_nop 0
buffer_load_dwordx4 v110, s[16:19], s59 offen offset:0 lds
s_add_u32 s59, s59, 3584
buffer_load_dwordx4 v110, s[16:19], s59 offen offset:1024 lds
s_add_u32 s59, s59, 3584
buffer_load_dwordx4 v111, s[16:19], s59 offen offset:2048 lds
s_add_u32 s59, s59, 3584
buffer_load_dwordx4 v111, s[16:19], s59 offen offset:3072 lds
s_add_u32 s59, s64, s60
s_add_u32 s59, s59, 73728
s_add_u32 m0, s65, 16384
s_nop 0
buffer_load_dwordx4 v110, s[16:19], s59 offen offset:0 lds
s_add_u32 s59, s59, 3584
buffer_load_dwordx4 v110, s[16:19], s59 offen offset:1024 lds
s_add_u32 s59, s59, 3584
buffer_load_dwordx4 v111, s[16:19], s59 offen offset:2048 lds
s_add_u32 s59, s59, 3584
buffer_load_dwordx4 v111, s[16:19], s59 offen offset:3072 lds
s_add_u32 s59, s64, s60
s_add_u32 s59, s59, 147456
s_add_u32 m0, s65, 32768
s_nop 0
buffer_load_dwordx4 v110, s[16:19], s59 offen offset:0 lds
s_add_u32 s59, s59, 3584
buffer_load_dwordx4 v110, s[16:19], s59 offen offset:1024 lds
s_add_u32 s59, s59, 3584
buffer_load_dwordx4 v111, s[16:19], s59 offen offset:2048 lds
s_add_u32 s59, s59, 3584
buffer_load_dwordx4 v111, s[16:19], s59 offen offset:3072 lds
s_and_b32 s52, s48, 15
s_lshl_b32 s52, s52, 2
s_add_u32 s52, s52, s50
s_mul_i32 s52, s52, 12
v_min_u32 v1, 11, v0
v_add_u32 v1, s52, v1
v_lshrrev_b32 v2, 1, v1
v_mul_u32_u24 v2, 1152, v2
v_and_b32 v1, 1, v1
v_lshl_add_u32 v1, v1, 7, v2
s_add_u32 s52, s60, 221184
s_mov_b64 exec, 4095
buffer_load_dword a252, v1, s[16:19], s52 offen
s_mov_b64 exec, -1
s_waitcnt vmcnt(13)
s_waitcnt lgkmcnt(0)
s_barrier
s_cmp_ge_u32 s90, 1000
s_cbranch_scc1 L_skip_4
s_mov_b32 s53, s90
s_mul_i32 s70, s53, 3641
s_lshr_b32 s70, s70, 16
s_mul_i32 s52, s70, 18
s_sub_u32 s71, s53, s52
s_lshl_b32 s52, s50, 13
s_add_u32 s52, s52, 49152
v_add_u32 v100, s52, v105
v_add_u32 v101, s52, v106
v_add_u32 v102, s52, v107
v_add_u32 v103, s52, v108
v_add_u32 v104, s52, v109
s_waitcnt vmcnt(13)
ds_read_b64_tr_b16 v[8:9], v100
ds_read_b64_tr_b16 v[10:11], v100 offset:1024
ds_read_b64_tr_b16 v[12:13], v101
ds_read_b64_tr_b16 v[14:15], v101 offset:1024
ds_read_b64_tr_b16 v[16:17], v102
ds_read_b64_tr_b16 v[18:19], v102 offset:1024
ds_read_b64_tr_b16 v[20:21], v103
ds_read_b64_tr_b16 v[22:23], v103 offset:1024
ds_read_b64_tr_b16 v[24:25], v104
ds_read_b64_tr_b16 v[26:27], v104 offset:1024
v_lshrrev_b32 v2, 4, v0
s_cmp_eq_u32 s70, 1
s_cselect_b32 s52, 18432, 0
s_cmp_eq_u32 s70, 2
s_cselect_b32 s52, 46080, s52
s_lshl_b32 s53, s71, 10
s_add_u32 s52, s52, s53
s_mul_i32 s54, s70, 423936
s_lshr_b32 s53, s53, 1
s_add_u32 s54, s54, s53
s_add_u32 s54, s54, 36864
s_mul_i32 s53, s71, 4608
s_add_u32 s53, s53, 1695744
s_add_u32 s55, s53, 4096
s_cmp_eq_u32 s70, 3
s_cselect_b32 s52, s53, s52
s_cselect_b32 s54, s55, s54
s_mov_b32 s72, 423936
s_cselect_b32 s72, 1024, s72
s_add_u32 s52, s52, s67
s_add_u32 s54, s54, s67
v_and_b32 v4, 15, v0
v_lshl_add_u32 v5, v2, 3, v4
v_lshlrev_b32 v5, 4, v5
v_mov_b32 v6, 1073741824
v_cmp_gt_u32 vcc, 8, v4
s_nop 1
v_cndmask_b32 v5, v6, v5, vcc
s_waitcnt lgkmcnt(8)
buffer_store_dwordx4 v[8:11], v59, s[44:47], s52 offen sc0 sc1
s_add_u32 s52, s52, s72
s_waitcnt lgkmcnt(6)
buffer_store_dwordx4 v[12:15], v59, s[44:47], s52 offen sc0 sc1
s_add_u32 s52, s52, s72
s_waitcnt lgkmcnt(4)
buffer_store_dwordx4 v[16:19], v59, s[44:47], s52 offen sc0 sc1
s_add_u32 s52, s52, s72
s_waitcnt lgkmcnt(2)
buffer_store_dwordx4 v[20:23], v59, s[44:47], s52 offen sc0 sc1
s_add_u32 s52, s52, s72
s_waitcnt lgkmcnt(0)
buffer_store_dwordx4 v[24:27], v5, s[44:47], s54 offen sc0 sc1
L_skip_4:
v_mov_b32 v55, 0
buffer_load_dword v55, v55, s[40:43], 0 offen sc0 sc1
v_lshrrev_b32 v68, 4, v0
v_lshlrev_b32 v68, 4, v68
v_add_u32 v68, 160000, v68
ds_read_b128 v[8:11], v68 offset:0
ds_read_b128 v[12:15], v68 offset:64
ds_read_b128 v[16:19], v68 offset:128
ds_read_b128 v[20:23], v68 offset:192
ds_read_b128 v[24:27], v68 offset:256
ds_read_b128 v[28:31], v68 offset:320
v_mov_b32 v60, 0
v_mov_b32 v61, 0
v_mov_b32 v62, 0
v_mov_b32 v63, 0
v_mov_b32 v64, 0
v_mov_b32 v65, 0
s_mov_b32 s52, s63
s_mul_i32 s71, s52, 3641
s_lshr_b32 s71, s71, 16
s_mul_i32 s53, s71, 18
s_sub_u32 s72, s52, s53
s_lshl_b32 s55, s71, 7
v_lshrrev_b32 v2, 3, v0
v_and_b32 v3, 7, v0
s_mul_i32 s80, s72, 294912
s_mul_i32 s53, s49, 1152
s_add_u32 s80, s80, s53
s_add_u32 s80, s80, s55
v_mul_u32_u24 v1, 9216, v2
v_bfe_u32 v4, v0, 4, 1
v_lshlrev_b32 v4, 1, v4
v_xor_b32 v3, v3, v4
v_lshl_add_u32 v32, v3, 4, v1
v_xor_b32 v3, 4, v3
v_lshl_add_u32 v33, v3, 4, v1
s_lshl_b32 s84, s50, 13
s_add_u32 s84, s84, 49152
s_waitcnt lgkmcnt(5)
v_dot2_f32_bf16 v60, v112, s61, v60
v_dot2_f32_bf16 v61, v112, v112, v61
v_dot2_f32_bf16 v62, v112, v8, v62
v_dot2_f32_bf16 v63, v113, s61, v63
v_dot2_f32_bf16 v64, v113, v113, v64
v_dot2_f32_bf16 v65, v113, v9, v65
v_dot2_f32_bf16 v60, v114, s61, v60
v_dot2_f32_bf16 v61, v114, v114, v61
v_dot2_f32_bf16 v62, v114, v10, v62
v_dot2_f32_bf16 v63, v115, s61, v63
v_dot2_f32_bf16 v64, v115, v115, v64
v_dot2_f32_bf16 v65, v115, v11, v65
ds_read_b128 v[8:11], v68 offset:384
s_mov_b32 m0, s84
s_nop 0
buffer_load_dwordx4 v32, s[24:27], s80 offen offset:0 nt lds
s_waitcnt lgkmcnt(5)
v_dot2_f32_bf16 v60, v116, s61, v60
v_dot2_f32_bf16 v61, v116, v116, v61
v_dot2_f32_bf16 v62, v116, v12, v62
v_dot2_f32_bf16 v63, v117, s61, v63
v_dot2_f32_bf16 v64, v117, v117, v64
v_dot2_f32_bf16 v65, v117, v13, v65
v_dot2_f32_bf16 v60, v118, s61, v60
v_dot2_f32_bf16 v61, v118, v118, v61
v_dot2_f32_bf16 v62, v118, v14, v62
v_dot2_f32_bf16 v63, v119, s61, v63
v_dot2_f32_bf16 v64, v119, v119, v64
v_dot2_f32_bf16 v65, v119, v15, v65
ds_read_b128 v[12:15], v68 offset:448
s_mov_b32 m0, s84
s_add_u32 s80, s80, 72704
buffer_load_dwordx4 v33, s[24:27], s80 offen offset:1024 nt lds
s_waitcnt lgkmcnt(5)
v_dot2_f32_bf16 v60, v120, s61, v60
v_dot2_f32_bf16 v61, v120, v120, v61
v_dot2_f32_bf16 v62, v120, v16, v62
v_dot2_f32_bf16 v63, v121, s61, v63
v_dot2_f32_bf16 v64, v121, v121, v64
v_dot2_f32_bf16 v65, v121, v17, v65
v_dot2_f32_bf16 v60, v122, s61, v60
v_dot2_f32_bf16 v61, v122, v122, v61
v_dot2_f32_bf16 v62, v122, v18, v62
v_dot2_f32_bf16 v63, v123, s61, v63
v_dot2_f32_bf16 v64, v123, v123, v64
v_dot2_f32_bf16 v65, v123, v19, v65
ds_read_b128 v[16:19], v68 offset:512
s_mov_b32 m0, s84
s_add_u32 s80, s80, 72704
buffer_load_dwordx4 v32, s[24:27], s80 offen offset:2048 nt lds
s_waitcnt lgkmcnt(5)
v_dot2_f32_bf16 v60, v124, s61, v60
v_dot2_f32_bf16 v61, v124, v124, v61
v_dot2_f32_bf16 v62, v124, v20, v62
v_dot2_f32_bf16 v63, v125, s61, v63
v_dot2_f32_bf16 v64, v125, v125, v64
v_dot2_f32_bf16 v65, v125, v21, v65
v_dot2_f32_bf16 v60, v126, s61, v60
v_dot2_f32_bf16 v61, v126, v126, v61
v_dot2_f32_bf16 v62, v126, v22, v62
v_dot2_f32_bf16 v63, v127, s61, v63
v_dot2_f32_bf16 v64, v127, v127, v64
v_dot2_f32_bf16 v65, v127, v23, v65
ds_read_b128 v[20:23], v68 offset:576
s_mov_b32 m0, s84
s_add_u32 s80, s80, 72704
buffer_load_dwordx4 v33, s[24:27], s80 offen offset:3072 nt lds
s_waitcnt lgkmcnt(5)
v_dot2_f32_bf16 v60, v128, s61, v60
v_dot2_f32_bf16 v61, v128, v128, v61
v_dot2_f32_bf16 v62, v128, v24, v62
v_dot2_f32_bf16 v63, v129, s61, v63
v_dot2_f32_bf16 v64, v129, v129, v64
v_dot2_f32_bf16 v65, v129, v25, v65
v_dot2_f32_bf16 v60, v130, s61, v60
v_dot2_f32_bf16 v61, v130, v130, v61
v_dot2_f32_bf16 v62, v130, v26, v62
v_dot2_f32_bf16 v63, v131, s61, v63
v_dot2_f32_bf16 v64, v131, v131, v64
v_dot2_f32_bf16 v65, v131, v27, v65
ds_read_b128 v[24:27], v68 offset:640
s_cmp_ge_u32 s91, 1000
s_cbranch_scc1 L_skip_5
s_mov_b32 s52, s91
s_mul_i32 s71, s52, 3641
s_lshr_b32 s71, s71, 16
s_mul_i32 s53, s71, 18
s_sub_u32 s72, s52, s53
s_lshl_b32 s55, s71, 7
v_lshrrev_b32 v2, 3, v0
v_and_b32 v3, 7, v0
s_mul_i32 s81, s72, 294912
s_mul_i32 s53, s49, 1152
s_add_u32 s81, s81, s53
s_add_u32 s81, s81, s55
v_mul_u32_u24 v1, 9216, v2
v_bfe_u32 v4, v0, 4, 1
v_lshlrev_b32 v4, 1, v4
v_xor_b32 v3, v3, v4
v_lshl_add_u32 v34, v3, 4, v1
v_xor_b32 v3, 4, v3
v_lshl_add_u32 v35, v3, 4, v1
s_lshl_b32 s85, s50, 13
s_add_u32 s85, s85, 53248
s_mov_b32 m0, s85
s_nop 0
buffer_load_dwordx4 v34, s[24:27], s81 offen offset:0 nt lds
s_mov_b32 m0, s85
s_add_u32 s81, s81, 72704
buffer_load_dwordx4 v35, s[24:27], s81 offen offset:1024 nt lds
s_mov_b32 m0, s85
s_add_u32 s81, s81, 72704
buffer_load_dwordx4 v34, s[24:27], s81 offen offset:2048 nt lds
s_mov_b32 m0, s85
s_add_u32 s81, s81, 72704
buffer_load_dwordx4 v35, s[24:27], s81 offen offset:3072 nt lds
L_skip_5:
s_waitcnt lgkmcnt(5)
v_dot2_f32_bf16 v60, v132, s61, v60
v_dot2_f32_bf16 v61, v132, v132, v61
v_dot2_f32_bf16 v62, v132, v28, v62
v_dot2_f32_bf16 v63, v133, s61, v63
v_dot2_f32_bf16 v64, v133, v133, v64
v_dot2_f32_bf16 v65, v133, v29, v65
v_dot2_f32_bf16 v60, v134, s61, v60
v_dot2_f32_bf16 v61, v134, v134, v61
v_dot2_f32_bf16 v62, v134, v30, v62
v_dot2_f32_bf16 v63, v135, s61, v63
v_dot2_f32_bf16 v64, v135, v135, v64
v_dot2_f32_bf16 v65, v135, v31, v65
ds_read_b128 v[28:31], v68 offset:704
s_waitcnt lgkmcnt(5)
v_dot2_f32_bf16 v60, v136, s61, v60
v_dot2_f32_bf16 v61, v136, v136, v61
v_dot2_f32_bf16 v62, v136, v8, v62
v_dot2_f32_bf16 v63, v137, s61, v63
v_dot2_f32_bf16 v64, v137, v137, v64
v_dot2_f32_bf16 v65, v137, v9, v65
v_dot2_f32_bf16 v60, v138, s61, v60
v_dot2_f32_bf16 v61, v138, v138, v61
v_dot2_f32_bf16 v62, v138, v10, v62
v_dot2_f32_bf16 v63, v139, s61, v63
v_dot2_f32_bf16 v64, v139, v139, v64
v_dot2_f32_bf16 v65, v139, v11, v65
ds_read_b128 v[8:11], v68 offset:768
s_waitcnt lgkmcnt(5)
v_dot2_f32_bf16 v60, v140, s61, v60
v_dot2_f32_bf16 v61, v140, v140, v61
v_dot2_f32_bf16 v62, v140, v12, v62
v_dot2_f32_bf16 v63, v141, s61, v63
v_dot2_f32_bf16 v64, v141, v141, v64
v_dot2_f32_bf16 v65, v141, v13, v65
v_dot2_f32_bf16 v60, v142, s61, v60
v_dot2_f32_bf16 v61, v142, v142, v61
v_dot2_f32_bf16 v62, v142, v14, v62
v_dot2_f32_bf16 v63, v143, s61, v63
v_dot2_f32_bf16 v64, v143, v143, v64
v_dot2_f32_bf16 v65, v143, v15, v65
ds_read_b128 v[12:15], v68 offset:832
s_waitcnt lgkmcnt(5)
v_dot2_f32_bf16 v60, v144, s61, v60
v_dot2_f32_bf16 v61, v144, v144, v61
v_dot2_f32_bf16 v62, v144, v16, v62
v_dot2_f32_bf16 v63, v145, s61, v63
v_dot2_f32_bf16 v64, v145, v145, v64
v_dot2_f32_bf16 v65, v145, v17, v65
v_dot2_f32_bf16 v60, v146, s61, v60
v_dot2_f32_bf16 v61, v146, v146, v61
v_dot2_f32_bf16 v62, v146, v18, v62
v_dot2_f32_bf16 v63, v147, s61, v63
v_dot2_f32_bf16 v64, v147, v147, v64
v_dot2_f32_bf16 v65, v147, v19, v65
ds_read_b128 v[16:19], v68 offset:896
s_waitcnt lgkmcnt(5)
v_dot2_f32_bf16 v60, v148, s61, v60
v_dot2_f32_bf16 v61, v148, v148, v61
v_dot2_f32_bf16 v62, v148, v20, v62
v_dot2_f32_bf16 v63, v149, s61, v63
v_dot2_f32_bf16 v64, v149, v149, v64
v_dot2_f32_bf16 v65, v149, v21, v65
v_dot2_f32_bf16 v60, v150, s61, v60
v_dot2_f32_bf16 v61, v150, v150, v61
v_dot2_f32_bf16 v62, v150, v22, v62
v_dot2_f32_bf16 v63, v151, s61, v63
v_dot2_f32_bf16 v64, v151, v151, v64
v_dot2_f32_bf16 v65, v151, v23, v65
ds_read_b128 v[20:23], v68 offset:960
s_waitcnt lgkmcnt(5)
v_dot2_f32_bf16 v60, v152, s61, v60
v_dot2_f32_bf16 v61, v152, v152, v61
v_dot2_f32_bf16 v62, v152, v24, v62
v_dot2_f32_bf16 v63, v153, s61, v63
v_dot2_f32_bf16 v64, v153, v153, v64
v_dot2_f32_bf16 v65, v153, v25, v65
v_dot2_f32_bf16 v60, v154, s61, v60
v_dot2_f32_bf16 v61, v154, v154, v61
v_dot2_f32_bf16 v62, v154, v26, v62
v_dot2_f32_bf16 v63, v155, s61, v63
v_dot2_f32_bf16 v64, v155, v155, v64
v_dot2_f32_bf16 v65, v155, v27, v65
ds_read_b128 v[24:27], v68 offset:1024
s_waitcnt lgkmcnt(5)
v_dot2_f32_bf16 v60, v156, s61, v60
v_dot2_f32_bf16 v61, v156, v156, v61
v_dot2_f32_bf16 v62, v156, v28, v62
v_dot2_f32_bf16 v63, v157, s61, v63
v_dot2_f32_bf16 v64, v157, v157, v64
v_dot2_f32_bf16 v65, v157, v29, v65
v_dot2_f32_bf16 v60, v158, s61, v60
v_dot2_f32_bf16 v61, v158, v158, v61
v_dot2_f32_bf16 v62, v158, v30, v62
v_dot2_f32_bf16 v63, v159, s61, v63
v_dot2_f32_bf16 v64, v159, v159, v64
v_dot2_f32_bf16 v65, v159, v31, v65
ds_read_b128 v[28:31], v68 offset:1088
s_waitcnt lgkmcnt(5)
v_dot2_f32_bf16 v60, v160, s61, v60
v_dot2_f32_bf16 v61, v160, v160, v61
v_dot2_f32_bf16 v62, v160, v8, v62
v_dot2_f32_bf16 v63, v161, s61, v63
v_dot2_f32_bf16 v64, v161, v161, v64
v_dot2_f32_bf16 v65, v161, v9, v65
v_dot2_f32_bf16 v60, v162, s61, v60
v_dot2_f32_bf16 v61, v162, v162, v61
v_dot2_f32_bf16 v62, v162, v10, v62
v_dot2_f32_bf16 v63, v163, s61, v63
v_dot2_f32_bf16 v64, v163, v163, v64
v_dot2_f32_bf16 v65, v163, v11, v65
s_waitcnt lgkmcnt(4)
v_dot2_f32_bf16 v60, v164, s61, v60
v_dot2_f32_bf16 v61, v164, v164, v61
v_dot2_f32_bf16 v62, v164, v12, v62
v_dot2_f32_bf16 v63, v165, s61, v63
v_dot2_f32_bf16 v64, v165, v165, v64
v_dot2_f32_bf16 v65, v165, v13, v65
v_dot2_f32_bf16 v60, v166, s61, v60
v_dot2_f32_bf16 v61, v166, v166, v61
v_dot2_f32_bf16 v62, v166, v14, v62
v_dot2_f32_bf16 v63, v167, s61, v63
v_dot2_f32_bf16 v64, v167, v167, v64
v_dot2_f32_bf16 v65, v167, v15, v65
s_waitcnt lgkmcnt(3)
v_dot2_f32_bf16 v60, v168, s61, v60
v_dot2_f32_bf16 v61, v168, v168, v61
v_dot2_f32_bf16 v62, v168, v16, v62
v_dot2_f32_bf16 v63, v169, s61, v63
v_dot2_f32_bf16 v64, v169, v169, v64
v_dot2_f32_bf16 v65, v169, v17, v65
v_dot2_f32_bf16 v60, v170, s61, v60
v_dot2_f32_bf16 v61, v170, v170, v61
v_dot2_f32_bf16 v62, v170, v18, v62
v_dot2_f32_bf16 v63, v171, s61, v63
v_dot2_f32_bf16 v64, v171, v171, v64
v_dot2_f32_bf16 v65, v171, v19, v65
s_waitcnt lgkmcnt(2)
v_dot2_f32_bf16 v60, v172, s61, v60
v_dot2_f32_bf16 v61, v172, v172, v61
v_dot2_f32_bf16 v62, v172, v20, v62
v_dot2_f32_bf16 v63, v173, s61, v63
v_dot2_f32_bf16 v64, v173, v173, v64
v_dot2_f32_bf16 v65, v173, v21, v65
v_dot2_f32_bf16 v60, v174, s61, v60
v_dot2_f32_bf16 v61, v174, v174, v61
v_dot2_f32_bf16 v62, v174, v22, v62
v_dot2_f32_bf16 v63, v175, s61, v63
v_dot2_f32_bf16 v64, v175, v175, v64
v_dot2_f32_bf16 v65, v175, v23, v65
s_waitcnt lgkmcnt(1)
v_dot2_f32_bf16 v60, v176, s61, v60
v_dot2_f32_bf16 v61, v176, v176, v61
v_dot2_f32_bf16 v62, v176, v24, v62
v_dot2_f32_bf16 v63, v177, s61, v63
v_dot2_f32_bf16 v64, v177, v177, v64
v_dot2_f32_bf16 v65, v177, v25, v65
v_dot2_f32_bf16 v60, v178, s61, v60
v_dot2_f32_bf16 v61, v178, v178, v61
v_dot2_f32_bf16 v62, v178, v26, v62
v_dot2_f32_bf16 v63, v179, s61, v63
v_dot2_f32_bf16 v64, v179, v179, v64
v_dot2_f32_bf16 v65, v179, v27, v65
s_waitcnt lgkmcnt(0)
v_dot2_f32_bf16 v60, v180, s61, v60
v_dot2_f32_bf16 v61, v180, v180, v61
v_dot2_f32_bf16 v62, v180, v28, v62
v_dot2_f32_bf16 v63, v181, s61, v63
v_dot2_f32_bf16 v64, v181, v181, v64
v_dot2_f32_bf16 v65, v181, v29, v65
v_dot2_f32_bf16 v60, v182, s61, v60
v_dot2_f32_bf16 v61, v182, v182, v61
v_dot2_f32_bf16 v62, v182, v30, v62
v_dot2_f32_bf16 v63, v183, s61, v63
v_dot2_f32_bf16 v64, v183, v183, v64
v_dot2_f32_bf16 v65, v183, v31, v65
s_nop 0
v_add_f32 v60, v60, v63
v_add_f32 v61, v61, v64
v_add_f32 v62, v62, v65
v_mov_b32 v63, v60
v_mov_b32 v64, v61
v_mov_b32 v65, v62
v_permlane16_swap_b32 v60, v63
v_permlane16_swap_b32 v61, v64
v_permlane16_swap_b32 v62, v65
v_add_f32 v60, v60, v63
v_add_f32 v61, v61, v64
v_add_f32 v62, v62, v65
v_mov_b32 v63, v60
v_mov_b32 v64, v61
v_mov_b32 v65, v62
v_permlane32_swap_b32 v60, v63
v_permlane32_swap_b32 v61, v64
v_permlane32_swap_b32 v62, v65
v_add_f32 v60, v60, v63
v_add_f32 v61, v61, v64
v_add_f32 v62, v62, v65
v_mul_f32 v60, 0xbae38e39, v60
v_mul_f32 v61, 0x3ae38e39, v61
v_fma_f32 v61, -v60, v60, v61
v_max_f32 v61, 0, v61
v_add_f32 v61, 0x3727c5ac, v61
v_rsq_f32 v70, v61
s_nop 0
v_mul_f32 v71, v70, v58
v_mul_f32 v72, v70, v70
v_mul_f32 v72, v72, v70
v_mul_f32 v72, s66, v72
v_rcp_f32 v73, v70
v_min_f32 v62, 0x425c0000, v62
v_mul_f32 v62, 0x3fb8aa3b, v62
v_exp_f32 v62, v62
v_and_b32 v63, 15, v0
s_lshl_b32 s52, s50, 6
s_add_u32 s52, s52, 159744
v_lshl_add_u32 v63, v63, 2, s52
ds_write_b32 v63, v62
v_dot2_f32_bf16 v80, v112, s88, v60
v_dot2_f32_bf16 v81, v112, s89, v60
v_dot2_f32_bf16 v82, v113, s88, v60
v_dot2_f32_bf16 v83, v113, s89, v60
v_dot2_f32_bf16 v84, v114, s88, v60
v_dot2_f32_bf16 v85, v114, s89, v60
v_dot2_f32_bf16 v86, v115, s88, v60
v_dot2_f32_bf16 v87, v115, s89, v60
v_cvt_pk_bf16_f32 v184, v80, v81
v_cvt_pk_bf16_f32 v185, v82, v83
v_cvt_pk_bf16_f32 v186, v84, v85
v_cvt_pk_bf16_f32 v187, v86, v87
v_dot2_f32_bf16 v88, v116, s88, v60
v_dot2_f32_bf16 v89, v116, s89, v60
v_dot2_f32_bf16 v90, v117, s88, v60
v_dot2_f32_bf16 v91, v117, s89, v60
v_dot2_f32_bf16 v92, v118, s88, v60
v_dot2_f32_bf16 v93, v118, s89, v60
v_dot2_f32_bf16 v94, v119, s88, v60
v_dot2_f32_bf16 v95, v119, s89, v60
v_cvt_pk_bf16_f32 v188, v88, v89
v_cvt_pk_bf16_f32 v189, v90, v91
v_cvt_pk_bf16_f32 v190, v92, v93
v_cvt_pk_bf16_f32 v191, v94, v95
v_dot2_f32_bf16 v80, v120, s88, v60
v_dot2_f32_bf16 v81, v120, s89, v60
v_dot2_f32_bf16 v82, v121, s88, v60
v_dot2_f32_bf16 v83, v121, s89, v60
v_dot2_f32_bf16 v84, v122, s88, v60
v_dot2_f32_bf16 v85, v122, s89, v60
v_dot2_f32_bf16 v86, v123, s88, v60
v_dot2_f32_bf16 v87, v123, s89, v60
v_cvt_pk_bf16_f32 v192, v80, v81
v_cvt_pk_bf16_f32 v193, v82, v83
v_cvt_pk_bf16_f32 v194, v84, v85
v_cvt_pk_bf16_f32 v195, v86, v87
v_dot2_f32_bf16 v88, v124, s88, v60
v_dot2_f32_bf16 v89, v124, s89, v60
v_dot2_f32_bf16 v90, v125, s88, v60
v_dot2_f32_bf16 v91, v125, s89, v60
v_dot2_f32_bf16 v92, v126, s88, v60
v_dot2_f32_bf16 v93, v126, s89, v60
v_dot2_f32_bf16 v94, v127, s88, v60
v_dot2_f32_bf16 v95, v127, s89, v60
v_cvt_pk_bf16_f32 v196, v88, v89
v_cvt_pk_bf16_f32 v197, v90, v91
v_cvt_pk_bf16_f32 v198, v92, v93
v_cvt_pk_bf16_f32 v199, v94, v95
v_dot2_f32_bf16 v80, v128, s88, v60
v_dot2_f32_bf16 v81, v128, s89, v60
v_dot2_f32_bf16 v82, v129, s88, v60
v_dot2_f32_bf16 v83, v129, s89, v60
v_dot2_f32_bf16 v84, v130, s88, v60
v_dot2_f32_bf16 v85, v130, s89, v60
v_dot2_f32_bf16 v86, v131, s88, v60
v_dot2_f32_bf16 v87, v131, s89, v60
v_cvt_pk_bf16_f32 v200, v80, v81
v_cvt_pk_bf16_f32 v201, v82, v83
v_cvt_pk_bf16_f32 v202, v84, v85
v_cvt_pk_bf16_f32 v203, v86, v87
v_dot2_f32_bf16 v88, v132, s88, v60
v_dot2_f32_bf16 v89, v132, s89, v60
v_dot2_f32_bf16 v90, v133, s88, v60
v_dot2_f32_bf16 v91, v133, s89, v60
v_dot2_f32_bf16 v92, v134, s88, v60
v_dot2_f32_bf16 v93, v134, s89, v60
v_dot2_f32_bf16 v94, v135, s88, v60
v_dot2_f32_bf16 v95, v135, s89, v60
v_cvt_pk_bf16_f32 v204, v88, v89
v_cvt_pk_bf16_f32 v205, v90, v91
v_cvt_pk_bf16_f32 v206, v92, v93
v_cvt_pk_bf16_f32 v207, v94, v95
v_dot2_f32_bf16 v80, v136, s88, v60
v_dot2_f32_bf16 v81, v136, s89, v60
v_dot2_f32_bf16 v82, v137, s88, v60
v_dot2_f32_bf16 v83, v137, s89, v60
v_dot2_f32_bf16 v84, v138, s88, v60
v_dot2_f32_bf16 v85, v138, s89, v60
v_dot2_f32_bf16 v86, v139, s88, v60
v_dot2_f32_bf16 v87, v139, s89, v60
v_cvt_pk_bf16_f32 v208, v80, v81
v_cvt_pk_bf16_f32 v209, v82, v83
v_cvt_pk_bf16_f32 v210, v84, v85
v_cvt_pk_bf16_f32 v211, v86, v87
v_dot2_f32_bf16 v88, v140, s88, v60
v_dot2_f32_bf16 v89, v140, s89, v60
v_dot2_f32_bf16 v90, v141, s88, v60
v_dot2_f32_bf16 v91, v141, s89, v60
v_dot2_f32_bf16 v92, v142, s88, v60
v_dot2_f32_bf16 v93, v142, s89, v60
v_dot2_f32_bf16 v94, v143, s88, v60
v_dot2_f32_bf16 v95, v143, s89, v60
v_cvt_pk_bf16_f32 v212, v88, v89
v_cvt_pk_bf16_f32 v213, v90, v91
v_cvt_pk_bf16_f32 v214, v92, v93
v_cvt_pk_bf16_f32 v215, v94, v95
v_dot2_f32_bf16 v80, v144, s88, v60
v_dot2_f32_bf16 v81, v144, s89, v60
v_dot2_f32_bf16 v82, v145, s88, v60
v_dot2_f32_bf16 v83, v145, s89, v60
v_dot2_f32_bf16 v84, v146, s88, v60
v_dot2_f32_bf16 v85, v146, s89, v60
v_dot2_f32_bf16 v86, v147, s88, v60
v_dot2_f32_bf16 v87, v147, s89, v60
v_cvt_pk_bf16_f32 v216, v80, v81
v_cvt_pk_bf16_f32 v217, v82, v83
v_cvt_pk_bf16_f32 v218, v84, v85
v_cvt_pk_bf16_f32 v219, v86, v87
s_waitcnt vmcnt(4)
s_barrier
v_readfirstlane_b32 s51, v55
s_nop 0
s_cmp_lg_u32 s51, 0
s_cbranch_scc1 L_nonce_ok_6
s_mov_b32 s58, 100000
L_nonce_poll_7:
v_mov_b32 v55, 0
buffer_load_dword v55, v55, s[40:43], 0 offen sc0 sc1
s_waitcnt vmcnt(0)
v_readfirstlane_b32 s51, v55
s_sub_u32 s58, s58, 1
s_cmp_eq_u32 s58, 0
s_cbranch_scc1 L_nonce_ok_6
s_cmp_eq_u32 s51, 0
s_cbranch_scc1 L_nonce_poll_7
L_nonce_ok_6:
s_lshl_b32 s51, s51, 3
s_add_u32 s51, s51, 7
s_cmp_lg_u32 s50, 0
s_cbranch_scc1 L_nofl_8
v_mov_b32 v2, s51
s_mov_b64 exec, 1
s_lshl_b32 s52, s49, 5
s_add_u32 s52, s52, s48
s_lshl_b32 s52, s52, 2
s_add_u32 s52, s52, 37955584
v_mov_b32 v1, s52
buffer_store_dword v2, v1, s[44:47], 0 offen sc0 sc1
s_mov_b64 exec, -1
L_nofl_8:
v_dot2_f32_bf16 v88, v148, s88, v60
v_dot2_f32_bf16 v89, v148, s89, v60
v_dot2_f32_bf16 v90, v149, s88, v60
v_dot2_f32_bf16 v91, v149, s89, v60
v_dot2_f32_bf16 v92, v150, s88, v60
v_dot2_f32_bf16 v93, v150, s89, v60
v_dot2_f32_bf16 v94, v151, s88, v60
v_dot2_f32_bf16 v95, v151, s89, v60
v_cvt_pk_bf16_f32 v220, v88, v89
v_cvt_pk_bf16_f32 v221, v90, v91
v_cvt_pk_bf16_f32 v222, v92, v93
v_cvt_pk_bf16_f32 v223, v94, v95
v_dot2_f32_bf16 v80, v152, s88, v60
v_dot2_f32_bf16 v81, v152, s89, v60
v_dot2_f32_bf16 v82, v153, s88, v60
v_dot2_f32_bf16 v83, v153, s89, v60
v_dot2_f32_bf16 v84, v154, s88, v60
v_dot2_f32_bf16 v85, v154, s89, v60
v_dot2_f32_bf16 v86, v155, s88, v60
v_dot2_f32_bf16 v87, v155, s89, v60
v_cvt_pk_bf16_f32 v224, v80, v81
v_cvt_pk_bf16_f32 v225, v82, v83
v_cvt_pk_bf16_f32 v226, v84, v85
v_cvt_pk_bf16_f32 v227, v86, v87
v_dot2_f32_bf16 v88, v156, s88, v60
v_dot2_f32_bf16 v89, v156, s89, v60
v_dot2_f32_bf16 v90, v157, s88, v60
v_dot2_f32_bf16 v91, v157, s89, v60
v_dot2_f32_bf16 v92, v158, s88, v60
v_dot2_f32_bf16 v93, v158, s89, v60
v_dot2_f32_bf16 v94, v159, s88, v60
v_dot2_f32_bf16 v95, v159, s89, v60
v_cvt_pk_bf16_f32 v228, v88, v89
v_cvt_pk_bf16_f32 v229, v90, v91
v_cvt_pk_bf16_f32 v230, v92, v93
v_cvt_pk_bf16_f32 v231, v94, v95
s_mov_b32 s52, s63
s_mul_i32 s71, s52, 3641
s_lshr_b32 s71, s71, 16
s_mul_i32 s53, s71, 18
s_sub_u32 s72, s52, s53
s_lshl_b32 s52, s50, 13
s_add_u32 s52, s52, 49152
v_lshrrev_b32 v2, 4, v0
v_bfe_u32 v3, v0, 2, 2
v_lshl_add_u32 v1, v2, 3, v3
v_lshlrev_b32 v1, 7, v1
v_lshrrev_b32 v3, 1, v3
v_and_b32 v2, 1, v2
v_lshl_or_b32 v2, v2, 1, v3
v_lshl_add_u32 v1, v2, 5, v1
v_and_b32 v3, 3, v0
v_lshl_add_u32 v1, v3, 3, v1
v_add_u32 v4, s52, v1
s_mul_i32 s86, s71, 18
s_add_u32 s86, s86, s72
s_lshl_b32 s86, s86, 10
s_add_u32 s86, s86, 64512
s_add_u32 s86, s86, s67
s_waitcnt vmcnt(0)
ds_read_b64_tr_b16 v[8:9], v4
ds_read_b64_tr_b16 v[10:11], v4 offset:512
v_xor_b32 v5, 32, v4
ds_read_b64_tr_b16 v[12:13], v5
ds_read_b64_tr_b16 v[14:15], v5 offset:512
v_xor_b32 v5, 64, v4
ds_read_b64_tr_b16 v[16:17], v5
ds_read_b64_tr_b16 v[18:19], v5 offset:512
v_xor_b32 v5, 96, v4
ds_read_b64_tr_b16 v[20:21], v5
ds_read_b64_tr_b16 v[22:23], v5 offset:512
s_waitcnt lgkmcnt(6)
buffer_store_dwordx4 v[8:11], v59, s[44:47], s86 offen sc0 sc1
s_waitcnt lgkmcnt(4)
s_add_u32 s86, s86, 423936
buffer_store_dwordx4 v[12:15], v59, s[44:47], s86 offen sc0 sc1
s_waitcnt lgkmcnt(2)
s_add_u32 s86, s86, 423936
buffer_store_dwordx4 v[16:19], v59, s[44:47], s86 offen sc0 sc1
s_waitcnt lgkmcnt(0)
s_add_u32 s86, s86, 423936
buffer_store_dwordx4 v[20:23], v59, s[44:47], s86 offen sc0 sc1
v_dot2_f32_bf16 v80, v160, s88, v60
v_dot2_f32_bf16 v81, v160, s89, v60
v_dot2_f32_bf16 v82, v161, s88, v60
v_dot2_f32_bf16 v83, v161, s89, v60
v_dot2_f32_bf16 v84, v162, s88, v60
v_dot2_f32_bf16 v85, v162, s89, v60
v_dot2_f32_bf16 v86, v163, s88, v60
v_dot2_f32_bf16 v87, v163, s89, v60
v_cvt_pk_bf16_f32 v232, v80, v81
v_cvt_pk_bf16_f32 v233, v82, v83
v_cvt_pk_bf16_f32 v234, v84, v85
v_cvt_pk_bf16_f32 v235, v86, v87
v_dot2_f32_bf16 v88, v164, s88, v60
v_dot2_f32_bf16 v89, v164, s89, v60
v_dot2_f32_bf16 v90, v165, s88, v60
v_dot2_f32_bf16 v91, v165, s89, v60
v_dot2_f32_bf16 v92, v166, s88, v60
v_dot2_f32_bf16 v93, v166, s89, v60
v_dot2_f32_bf16 v94, v167, s88, v60
v_dot2_f32_bf16 v95, v167, s89, v60
v_cvt_pk_bf16_f32 v236, v88, v89
v_cvt_pk_bf16_f32 v237, v90, v91
v_cvt_pk_bf16_f32 v238, v92, v93
v_cvt_pk_bf16_f32 v239, v94, v95
v_dot2_f32_bf16 v80, v168, s88, v60
v_dot2_f32_bf16 v81, v168, s89, v60
v_dot2_f32_bf16 v82, v169, s88, v60
v_dot2_f32_bf16 v83, v169, s89, v60
v_dot2_f32_bf16 v84, v170, s88, v60
v_dot2_f32_bf16 v85, v170, s89, v60
v_dot2_f32_bf16 v86, v171, s88, v60
v_dot2_f32_bf16 v87, v171, s89, v60
v_cvt_pk_bf16_f32 v240, v80, v81
v_cvt_pk_bf16_f32 v241, v82, v83
v_cvt_pk_bf16_f32 v242, v84, v85
v_cvt_pk_bf16_f32 v243, v86, v87
v_dot2_f32_bf16 v88, v172, s88, v60
v_dot2_f32_bf16 v89, v172, s89, v60
v_dot2_f32_bf16 v90, v173, s88, v60
v_dot2_f32_bf16 v91, v173, s89, v60
v_dot2_f32_bf16 v92, v174, s88, v60
v_dot2_f32_bf16 v93, v174, s89, v60
v_dot2_f32_bf16 v94, v175, s88, v60
v_dot2_f32_bf16 v95, v175, s89, v60
v_cvt_pk_bf16_f32 v244, v88, v89
v_cvt_pk_bf16_f32 v245, v90, v91
v_cvt_pk_bf16_f32 v246, v92, v93
v_cvt_pk_bf16_f32 v247, v94, v95
v_dot2_f32_bf16 v80, v176, s88, v60
v_dot2_f32_bf16 v81, v176, s89, v60
v_dot2_f32_bf16 v82, v177, s88, v60
v_dot2_f32_bf16 v83, v177, s89, v60
v_dot2_f32_bf16 v84, v178, s88, v60
v_dot2_f32_bf16 v85, v178, s89, v60
v_dot2_f32_bf16 v86, v179, s88, v60
v_dot2_f32_bf16 v87, v179, s89, v60
v_cvt_pk_bf16_f32 v248, v80, v81
v_cvt_pk_bf16_f32 v249, v82, v83
v_cvt_pk_bf16_f32 v250, v84, v85
v_cvt_pk_bf16_f32 v251, v86, v87
v_dot2_f32_bf16 v88, v180, s88, v60
v_dot2_f32_bf16 v89, v180, s89, v60
v_dot2_f32_bf16 v90, v181, s88, v60
v_dot2_f32_bf16 v91, v181, s89, v60
v_dot2_f32_bf16 v92, v182, s88, v60
v_dot2_f32_bf16 v93, v182, s89, v60
v_dot2_f32_bf16 v94, v183, s88, v60
v_dot2_f32_bf16 v95, v183, s89, v60
v_cvt_pk_bf16_f32 v252, v88, v89
v_cvt_pk_bf16_f32 v253, v90, v91
v_cvt_pk_bf16_f32 v254, v92, v93
v_cvt_pk_bf16_f32 v255, v94, v95
s_cmp_ge_u32 s91, 1000
s_cbranch_scc1 L_skip_9
s_mov_b32 s52, s91
s_mul_i32 s71, s52, 3641
s_lshr_b32 s71, s71, 16
s_mul_i32 s53, s71, 18
s_sub_u32 s72, s52, s53
s_lshl_b32 s52, s50, 13
s_add_u32 s52, s52, 53248
v_lshrrev_b32 v2, 4, v0
v_bfe_u32 v3, v0, 2, 2
v_lshl_add_u32 v1, v2, 3, v3
v_lshlrev_b32 v1, 7, v1
v_lshrrev_b32 v3, 1, v3
v_and_b32 v2, 1, v2
v_lshl_or_b32 v2, v2, 1, v3
v_lshl_add_u32 v1, v2, 5, v1
v_and_b32 v3, 3, v0
v_lshl_add_u32 v1, v3, 3, v1
v_add_u32 v4, s52, v1
s_mul_i32 s87, s71, 18
s_add_u32 s87, s87, s72
s_lshl_b32 s87, s87, 10
s_add_u32 s87, s87, 64512
s_add_u32 s87, s87, s67
s_waitcnt vmcnt(4)
ds_read_b64_tr_b16 v[24:25], v4
ds_read_b64_tr_b16 v[26:27], v4 offset:512
v_xor_b32 v5, 32, v4
ds_read_b64_tr_b16 v[28:29], v5
ds_read_b64_tr_b16 v[30:31], v5 offset:512
v_xor_b32 v5, 64, v4
ds_read_b64_tr_b16 v[32:33], v5
ds_read_b64_tr_b16 v[34:35], v5 offset:512
v_xor_b32 v5, 96, v4
ds_read_b64_tr_b16 v[36:37], v5
ds_read_b64_tr_b16 v[38:39], v5 offset:512
s_waitcnt lgkmcnt(6)
buffer_store_dwordx4 v[24:27], v59, s[44:47], s87 offen sc0 sc1
s_waitcnt lgkmcnt(4)
s_add_u32 s87, s87, 423936
buffer_store_dwordx4 v[28:31], v59, s[44:47], s87 offen sc0 sc1
s_waitcnt lgkmcnt(2)
s_add_u32 s87, s87, 423936
buffer_store_dwordx4 v[32:35], v59, s[44:47], s87 offen sc0 sc1
s_waitcnt lgkmcnt(0)
s_add_u32 s87, s87, 423936
buffer_store_dwordx4 v[36:39], v59, s[44:47], s87 offen sc0 sc1
L_skip_9:
s_barrier
v_add_u32 v100, 0, v105
v_add_u32 v101, 0, v106
v_add_u32 v102, 0, v107
v_add_u32 v103, 0, v108
v_add_u32 v104, 0, v109
ds_read_b64_tr_b16 a[128:129], v100 offset:0
ds_read_b64_tr_b16 a[130:131], v100 offset:1024
ds_read_b64_tr_b16 a[132:133], v101 offset:0
ds_read_b64_tr_b16 a[134:135], v101 offset:1024
ds_read_b64_tr_b16 a[136:137], v102 offset:0
ds_read_b64_tr_b16 a[138:139], v102 offset:1024
ds_read_b64_tr_b16 a[140:141], v103 offset:0
ds_read_b64_tr_b16 a[142:143], v103 offset:1024
ds_read_b64_tr_b16 a[144:145], v104 offset:0
ds_read_b64_tr_b16 a[146:147], v104 offset:1024
ds_read_b64_tr_b16 a[148:149], v100 offset:8192
ds_read_b64_tr_b16 a[150:151], v100 offset:9216
ds_read_b64_tr_b16 a[152:153], v101 offset:8192
ds_read_b64_tr_b16 a[154:155], v101 offset:9216
ds_read_b64_tr_b16 a[156:157], v102 offset:8192
s_waitcnt lgkmcnt(13)
ds_read_b64_tr_b16 a[158:159], v102 offset:9216
s_add_u32 s59, s64, s60
s_add_u32 s59, s59, 221184
s_add_u32 m0, s65, 49152
v_mfma_f32_16x16x32_bf16 v[80:83], a[128:131], v[184:187], 0
ds_read_b64_tr_b16 a[128:129], v103 offset:8192
s_waitcnt lgkmcnt(13)
ds_read_b64_tr_b16 a[130:131], v103 offset:9216
buffer_load_dwordx4 v110, s[16:19], s59 offen offset:0 lds
v_mfma_f32_16x16x32_bf16 v[84:87], a[132:135], v[184:187], 0
ds_read_b64_tr_b16 a[132:133], v104 offset:8192
s_waitcnt lgkmcnt(13)
ds_read_b64_tr_b16 a[134:135], v104 offset:9216
s_add_u32 s59, s59, 3584
buffer_load_dwordx4 v110, s[16:19], s59 offen offset:1024 lds
v_mfma_f32_16x16x32_bf16 v[88:91], a[136:139], v[184:187], 0
s_barrier
v_add_u32 v100, 16384, v105
v_add_u32 v101, 16384, v106
v_add_u32 v102, 16384, v107
v_add_u32 v103, 16384, v108
v_add_u32 v104, 16384, v109
ds_read_b64_tr_b16 a[136:137], v100 offset:0
s_waitcnt lgkmcnt(13)
ds_read_b64_tr_b16 a[138:139], v100 offset:1024
s_add_u32 s59, s59, 3584
buffer_load_dwordx4 v111, s[16:19], s59 offen offset:2048 lds
v_mfma_f32_16x16x32_bf16 v[92:95], a[140:143], v[184:187], 0
ds_read_b64_tr_b16 a[140:141], v101 offset:0
s_waitcnt lgkmcnt(13)
ds_read_b64_tr_b16 a[142:143], v101 offset:1024
s_add_u32 s59, s59, 3584
buffer_load_dwordx4 v111, s[16:19], s59 offen offset:3072 lds
v_mfma_f32_16x16x32_bf16 v[96:99], a[144:147], v[184:187], 0
ds_read_b64_tr_b16 a[144:145], v102 offset:0
s_waitcnt lgkmcnt(13)
ds_read_b64_tr_b16 a[146:147], v102 offset:1024
s_add_u32 s59, s64, s60
s_add_u32 s59, s59, 294912
s_add_u32 m0, s65, 65536
v_mfma_f32_16x16x32_bf16 v[80:83], a[148:151], v[188:191], v[80:83]
ds_read_b64_tr_b16 a[148:149], v103 offset:0
s_waitcnt lgkmcnt(13)
ds_read_b64_tr_b16 a[150:151], v103 offset:1024
buffer_load_dwordx4 v110, s[16:19], s59 offen offset:0 lds
v_mfma_f32_16x16x32_bf16 v[84:87], a[152:155], v[188:191], v[84:87]
ds_read_b64_tr_b16 a[152:153], v104 offset:0
s_waitcnt lgkmcnt(13)
ds_read_b64_tr_b16 a[154:155], v104 offset:1024
s_add_u32 s59, s59, 3584
buffer_load_dwordx4 v110, s[16:19], s59 offen offset:1024 lds
v_mfma_f32_16x16x32_bf16 v[88:91], a[156:159], v[188:191], v[88:91]
ds_read_b64_tr_b16 a[156:157], v100 offset:8192
s_waitcnt lgkmcnt(13)
ds_read_b64_tr_b16 a[158:159], v100 offset:9216
s_add_u32 s59, s59, 3584
buffer_load_dwordx4 v111, s[16:19], s59 offen offset:2048 lds
v_mfma_f32_16x16x32_bf16 v[92:95], a[128:131], v[188:191], v[92:95]
ds_read_b64_tr_b16 a[128:129], v101 offset:8192
s_waitcnt lgkmcnt(13)
ds_read_b64_tr_b16 a[130:131], v101 offset:9216
s_add_u32 s59, s59, 3584
buffer_load_dwordx4 v111, s[16:19], s59 offen offset:3072 lds
v_mfma_f32_16x16x32_bf16 v[96:99], a[132:135], v[188:191], v[96:99]
ds_read_b64_tr_b16 a[132:133], v102 offset:8192
s_waitcnt lgkmcnt(13)
ds_read_b64_tr_b16 a[134:135], v102 offset:9216
v_mfma_f32_16x16x32_bf16 v[80:83], a[136:139], v[192:195], v[80:83]
ds_read_b64_tr_b16 a[136:137], v103 offset:8192
s_waitcnt lgkmcnt(13)
ds_read_b64_tr_b16 a[138:139], v103 offset:9216
v_mfma_f32_16x16x32_bf16 v[84:87], a[140:143], v[192:195], v[84:87]
ds_read_b64_tr_b16 a[140:141], v104 offset:8192
s_waitcnt lgkmcnt(13)
ds_read_b64_tr_b16 a[142:143], v104 offset:9216
v_mfma_f32_16x16x32_bf16 v[88:91], a[144:147], v[192:195], v[88:91]
s_barrier
v_add_u32 v100, 32768, v105
v_add_u32 v101, 32768, v106
v_add_u32 v102, 32768, v107
v_add_u32 v103, 32768, v108
v_add_u32 v104, 32768, v109
ds_read_b64_tr_b16 a[144:145], v100 offset:0
s_waitcnt lgkmcnt(13)
ds_read_b64_tr_b16 a[146:147], v100 offset:1024
s_add_u32 s59, s64, s60
s_add_u32 s59, s59, 368640
s_add_u32 m0, s65, 0
v_mfma_f32_16x16x32_bf16 v[92:95], a[148:151], v[192:195], v[92:95]
ds_read_b64_tr_b16 a[148:149], v101 offset:0
s_waitcnt lgkmcnt(13)
ds_read_b64_tr_b16 a[150:151], v101 offset:1024
buffer_load_dwordx4 v110, s[16:19], s59 offen offset:0 lds
v_mfma_f32_16x16x32_bf16 v[96:99], a[152:155], v[192:195], v[96:99]
ds_read_b64_tr_b16 a[152:153], v102 offset:0
s_waitcnt lgkmcnt(13)
ds_read_b64_tr_b16 a[154:155], v102 offset:1024
s_add_u32 s59, s59, 3584
buffer_load_dwordx4 v110, s[16:19], s59 offen offset:1024 lds
v_mfma_f32_16x16x32_bf16 v[80:83], a[156:159], v[196:199], v[80:83]
ds_read_b64_tr_b16 a[156:157], v103 offset:0
s_waitcnt lgkmcnt(13)
ds_read_b64_tr_b16 a[158:159], v103 offset:1024
s_add_u32 s59, s59, 3584
buffer_load_dwordx4 v111, s[16:19], s59 offen offset:2048 lds
v_mfma_f32_16x16x32_bf16 v[84:87], a[128:131], v[196:199], v[84:87]
ds_read_b64_tr_b16 a[128:129], v104 offset:0
s_waitcnt lgkmcnt(13)
ds_read_b64_tr_b16 a[130:131], v104 offset:1024
s_add_u32 s59, s59, 3584
buffer_load_dwordx4 v111, s[16:19], s59 offen offset:3072 lds
v_mfma_f32_16x16x32_bf16 v[88:91], a[132:135], v[196:199], v[88:91]
ds_read_b64_tr_b16 a[132:133], v100 offset:8192
s_waitcnt lgkmcnt(13)
ds_read_b64_tr_b16 a[134:135], v100 offset:9216
v_mfma_f32_16x16x32_bf16 v[92:95], a[136:139], v[196:199], v[92:95]
ds_read_b64_tr_b16 a[136:137], v101 offset:8192
s_waitcnt lgkmcnt(13)
ds_read_b64_tr_b16 a[138:139], v101 offset:9216
v_mfma_f32_16x16x32_bf16 v[96:99], a[140:143], v[196:199], v[96:99]
ds_read_b64_tr_b16 a[140:141], v102 offset:8192
s_waitcnt lgkmcnt(13)
ds_read_b64_tr_b16 a[142:143], v102 offset:9216
v_mfma_f32_16x16x32_bf16 v[80:83], a[144:147], v[200:203], v[80:83]
ds_read_b64_tr_b16 a[144:145], v103 offset:8192
s_waitcnt lgkmcnt(13)
ds_read_b64_tr_b16 a[146:147], v103 offset:9216
v_mfma_f32_16x16x32_bf16 v[84:87], a[148:151], v[200:203], v[84:87]
ds_read_b64_tr_b16 a[148:149], v104 offset:8192
s_waitcnt lgkmcnt(13)
ds_read_b64_tr_b16 a[150:151], v104 offset:9216
v_mfma_f32_16x16x32_bf16 v[88:91], a[152:155], v[200:203], v[88:91]
s_waitcnt vmcnt(8)
s_barrier
v_add_u32 v100, 49152, v105
v_add_u32 v101, 49152, v106
v_add_u32 v102, 49152, v107
v_add_u32 v103, 49152, v108
v_add_u32 v104, 49152, v109
ds_read_b64_tr_b16 a[152:153], v100 offset:0
s_waitcnt lgkmcnt(13)
ds_read_b64_tr_b16 a[154:155], v100 offset:1024
s_add_u32 s59, s64, s60
s_add_u32 s59, s59, 442368
s_add_u32 m0, s65, 16384
v_mfma_f32_16x16x32_bf16 v[92:95], a[156:159], v[200:203], v[92:95]
ds_read_b64_tr_b16 a[156:157], v101 offset:0
s_waitcnt lgkmcnt(13)
ds_read_b64_tr_b16 a[158:159], v101 offset:1024
buffer_load_dwordx4 v110, s[16:19], s59 offen offset:0 lds
v_mfma_f32_16x16x32_bf16 v[96:99], a[128:131], v[200:203], v[96:99]
ds_read_b64_tr_b16 a[128:129], v102 offset:0
s_waitcnt lgkmcnt(13)
ds_read_b64_tr_b16 a[130:131], v102 offset:1024
s_add_u32 s59, s59, 3584
buffer_load_dwordx4 v110, s[16:19], s59 offen offset:1024 lds
v_mfma_f32_16x16x32_bf16 v[80:83], a[132:135], v[204:207], v[80:83]
ds_read_b64_tr_b16 a[132:133], v103 offset:0
s_waitcnt lgkmcnt(13)
ds_read_b64_tr_b16 a[134:135], v103 offset:1024
s_add_u32 s59, s59, 3584
buffer_load_dwordx4 v111, s[16:19], s59 offen offset:2048 lds
v_mfma_f32_16x16x32_bf16 v[84:87], a[136:139], v[204:207], v[84:87]
ds_read_b64_tr_b16 a[136:137], v104 offset:0
s_waitcnt lgkmcnt(13)
ds_read_b64_tr_b16 a[138:139], v104 offset:1024
s_add_u32 s59, s59, 3584
buffer_load_dwordx4 v111, s[16:19], s59 offen offset:3072 lds
v_mfma_f32_16x16x32_bf16 v[88:91], a[140:143], v[204:207], v[88:91]
ds_read_b64_tr_b16 a[140:141], v100 offset:8192
s_waitcnt lgkmcnt(13)
ds_read_b64_tr_b16 a[142:143], v100 offset:9216
v_mfma_f32_16x16x32_bf16 v[92:95], a[144:147], v[204:207], v[92:95]
ds_read_b64_tr_b16 a[144:145], v101 offset:8192
s_waitcnt lgkmcnt(13)
ds_read_b64_tr_b16 a[146:147], v101 offset:9216
v_mfma_f32_16x16x32_bf16 v[96:99], a[148:151], v[204:207], v[96:99]
ds_read_b64_tr_b16 a[148:149], v102 offset:8192
s_waitcnt lgkmcnt(13)
ds_read_b64_tr_b16 a[150:151], v102 offset:9216
v_mfma_f32_16x16x32_bf16 v[80:83], a[152:155], v[208:211], v[80:83]
ds_read_b64_tr_b16 a[152:153], v103 offset:8192
s_waitcnt lgkmcnt(13)
ds_read_b64_tr_b16 a[154:155], v103 offset:9216
v_mfma_f32_16x16x32_bf16 v[84:87], a[156:159], v[208:211], v[84:87]
ds_read_b64_tr_b16 a[156:157], v104 offset:8192
s_waitcnt lgkmcnt(13)
ds_read_b64_tr_b16 a[158:159], v104 offset:9216
v_mfma_f32_16x16x32_bf16 v[88:91], a[128:131], v[208:211], v[88:91]
s_waitcnt vmcnt(8)
s_barrier
v_add_u32 v100, 65536, v105
v_add_u32 v101, 65536, v106
v_add_u32 v102, 65536, v107
v_add_u32 v103, 65536, v108
v_add_u32 v104, 65536, v109
ds_read_b64_tr_b16 a[128:129], v100 offset:0
s_waitcnt lgkmcnt(13)
ds_read_b64_tr_b16 a[130:131], v100 offset:1024
s_add_u32 s59, s64, s60
s_add_u32 s59, s59, 516096
s_add_u32 m0, s65, 32768
v_mfma_f32_16x16x32_bf16 v[92:95], a[132:135], v[208:211], v[92:95]
ds_read_b64_tr_b16 a[132:133], v101 offset:0
s_waitcnt lgkmcnt(13)
ds_read_b64_tr_b16 a[134:135], v101 offset:1024
buffer_load_dwordx4 v110, s[16:19], s59 offen offset:0 lds
v_mfma_f32_16x16x32_bf16 v[96:99], a[136:139], v[208:211], v[96:99]
ds_read_b64_tr_b16 a[136:137], v102 offset:0
s_waitcnt lgkmcnt(13)
ds_read_b64_tr_b16 a[138:139], v102 offset:1024
s_add_u32 s59, s59, 3584
buffer_load_dwordx4 v110, s[16:19], s59 offen offset:1024 lds
v_mfma_f32_16x16x32_bf16 v[80:83], a[140:143], v[212:215], v[80:83]
ds_read_b64_tr_b16 a[140:141], v103 offset:0
s_waitcnt lgkmcnt(13)
ds_read_b64_tr_b16 a[142:143], v103 offset:1024
s_add_u32 s59, s59, 3584
buffer_load_dwordx4 v111, s[16:19], s59 offen offset:2048 lds
v_mfma_f32_16x16x32_bf16 v[84:87], a[144:147], v[212:215], v[84:87]
ds_read_b64_tr_b16 a[144:145], v104 offset:0
s_waitcnt lgkmcnt(13)
ds_read_b64_tr_b16 a[146:147], v104 offset:1024
s_add_u32 s59, s59, 3584
buffer_load_dwordx4 v111, s[16:19], s59 offen offset:3072 lds
v_mfma_f32_16x16x32_bf16 v[88:91], a[148:151], v[212:215], v[88:91]
ds_read_b64_tr_b16 a[148:149], v100 offset:8192
s_waitcnt lgkmcnt(13)
ds_read_b64_tr_b16 a[150:151], v100 offset:9216
v_mfma_f32_16x16x32_bf16 v[92:95], a[152:155], v[212:215], v[92:95]
ds_read_b64_tr_b16 a[152:153], v101 offset:8192
s_waitcnt lgkmcnt(13)
ds_read_b64_tr_b16 a[154:155], v101 offset:9216
v_mfma_f32_16x16x32_bf16 v[96:99], a[156:159], v[212:215], v[96:99]
ds_read_b64_tr_b16 a[156:157], v102 offset:8192
s_waitcnt lgkmcnt(13)
ds_read_b64_tr_b16 a[158:159], v102 offset:9216
v_mfma_f32_16x16x32_bf16 v[80:83], a[128:131], v[216:219], v[80:83]
ds_read_b64_tr_b16 a[128:129], v103 offset:8192
s_waitcnt lgkmcnt(13)
ds_read_b64_tr_b16 a[130:131], v103 offset:9216
v_mfma_f32_16x16x32_bf16 v[84:87], a[132:135], v[216:219], v[84:87]
ds_read_b64_tr_b16 a[132:133], v104 offset:8192
s_waitcnt lgkmcnt(13)
ds_read_b64_tr_b16 a[134:135], v104 offset:9216
v_mfma_f32_16x16x32_bf16 v[88:91], a[136:139], v[216:219], v[88:91]
s_waitcnt vmcnt(8)
s_barrier
v_add_u32 v100, 0, v105
v_add_u32 v101, 0, v106
v_add_u32 v102, 0, v107
v_add_u32 v103, 0, v108
v_add_u32 v104, 0, v109
ds_read_b64_tr_b16 a[136:137], v100 offset:0
s_waitcnt lgkmcnt(13)
ds_read_b64_tr_b16 a[138:139], v100 offset:1024
s_add_u32 s59, s64, s60
s_add_u32 s59, s59, 589824
s_add_u32 m0, s65, 49152
v_mfma_f32_16x16x32_bf16 v[92:95], a[140:143], v[216:219], v[92:95]
ds_read_b64_tr_b16 a[140:141], v101 offset:0
s_waitcnt lgkmcnt(13)
ds_read_b64_tr_b16 a[142:143], v101 offset:1024
buffer_load_dwordx4 v110, s[16:19], s59 offen offset:0 lds
v_mfma_f32_16x16x32_bf16 v[96:99], a[144:147], v[216:219], v[96:99]
ds_read_b64_tr_b16 a[144:145], v102 offset:0
s_waitcnt lgkmcnt(13)
ds_read_b64_tr_b16 a[146:147], v102 offset:1024
s_add_u32 s59, s59, 3584
buffer_load_dwordx4 v110, s[16:19], s59 offen offset:1024 lds
v_mfma_f32_16x16x32_bf16 v[80:83], a[148:151], v[220:223], v[80:83]
ds_read_b64_tr_b16 a[148:149], v103 offset:0
s_waitcnt lgkmcnt(13)
ds_read_b64_tr_b16 a[150:151], v103 offset:1024
s_add_u32 s59, s59, 3584
buffer_load_dwordx4 v111, s[16:19], s59 offen offset:2048 lds
v_mfma_f32_16x16x32_bf16 v[84:87], a[152:155], v[220:223], v[84:87]
ds_read_b64_tr_b16 a[152:153], v104 offset:0
s_waitcnt lgkmcnt(13)
ds_read_b64_tr_b16 a[154:155], v104 offset:1024
s_add_u32 s59, s59, 3584
buffer_load_dwordx4 v111, s[16:19], s59 offen offset:3072 lds
v_mfma_f32_16x16x32_bf16 v[88:91], a[156:159], v[220:223], v[88:91]
ds_read_b64_tr_b16 a[156:157], v100 offset:8192
s_waitcnt lgkmcnt(13)
ds_read_b64_tr_b16 a[158:159], v100 offset:9216
v_mfma_f32_16x16x32_bf16 v[92:95], a[128:131], v[220:223], v[92:95]
ds_read_b64_tr_b16 a[128:129], v101 offset:8192
s_waitcnt lgkmcnt(13)
ds_read_b64_tr_b16 a[130:131], v101 offset:9216
v_mfma_f32_16x16x32_bf16 v[96:99], a[132:135], v[220:223], v[96:99]
ds_read_b64_tr_b16 a[132:133], v102 offset:8192
s_waitcnt lgkmcnt(13)
ds_read_b64_tr_b16 a[134:135], v102 offset:9216
v_mfma_f32_16x16x32_bf16 v[80:83], a[136:139], v[224:227], v[80:83]
ds_read_b64_tr_b16 a[136:137], v103 offset:8192
s_waitcnt lgkmcnt(13)
ds_read_b64_tr_b16 a[138:139], v103 offset:9216
v_mfma_f32_16x16x32_bf16 v[84:87], a[140:143], v[224:227], v[84:87]
ds_read_b64_tr_b16 a[140:141], v104 offset:8192
s_waitcnt lgkmcnt(13)
ds_read_b64_tr_b16 a[142:143], v104 offset:9216
v_mfma_f32_16x16x32_bf16 v[88:91], a[144:147], v[224:227], v[88:91]
s_waitcnt vmcnt(8)
s_barrier
s_lshl_b32 s52, s49, 7
s_add_u32 s52, s52, 37955584
v_and_b32 v1, 31, v0
v_min_u32 v1, 17, v1
v_lshl_add_u32 v76, v1, 2, s52
buffer_load_dword v77, v76, s[44:47], 0 offen sc0 sc1
v_add_u32 v100, 16384, v105
v_add_u32 v101, 16384, v106
v_add_u32 v102, 16384, v107
v_add_u32 v103, 16384, v108
v_add_u32 v104, 16384, v109
ds_read_b64_tr_b16 a[144:145], v100 offset:0
s_waitcnt lgkmcnt(13)
ds_read_b64_tr_b16 a[146:147], v100 offset:1024
v_mfma_f32_16x16x32_bf16 v[92:95], a[148:151], v[224:227], v[92:95]
ds_read_b64_tr_b16 a[148:149], v101 offset:0
s_waitcnt lgkmcnt(13)
ds_read_b64_tr_b16 a[150:151], v101 offset:1024
v_mfma_f32_16x16x32_bf16 v[96:99], a[152:155], v[224:227], v[96:99]
ds_read_b64_tr_b16 a[152:153], v102 offset:0
s_waitcnt lgkmcnt(13)
ds_read_b64_tr_b16 a[154:155], v102 offset:1024
v_mfma_f32_16x16x32_bf16 v[80:83], a[156:159], v[228:231], v[80:83]
ds_read_b64_tr_b16 a[156:157], v103 offset:0
s_waitcnt lgkmcnt(13)
ds_read_b64_tr_b16 a[158:159], v103 offset:1024
v_mfma_f32_16x16x32_bf16 v[84:87], a[128:131], v[228:231], v[84:87]
ds_read_b64_tr_b16 a[128:129], v104 offset:0
s_waitcnt lgkmcnt(13)
ds_read_b64_tr_b16 a[130:131], v104 offset:1024
v_mfma_f32_16x16x32_bf16 v[88:91], a[132:135], v[228:231], v[88:91]
ds_read_b64_tr_b16 a[132:133], v100 offset:8192
s_waitcnt lgkmcnt(13)
ds_read_b64_tr_b16 a[134:135], v100 offset:9216
v_mfma_f32_16x16x32_bf16 v[92:95], a[136:139], v[228:231], v[92:95]
ds_read_b64_tr_b16 a[136:137], v101 offset:8192
s_waitcnt lgkmcnt(13)
ds_read_b64_tr_b16 a[138:139], v101 offset:9216
v_mfma_f32_16x16x32_bf16 v[96:99], a[140:143], v[228:231], v[96:99]
ds_read_b64_tr_b16 a[140:141], v102 offset:8192
s_waitcnt lgkmcnt(13)
ds_read_b64_tr_b16 a[142:143], v102 offset:9216
v_mfma_f32_16x16x32_bf16 v[80:83], a[144:147], v[232:235], v[80:83]
ds_read_b64_tr_b16 a[144:145], v103 offset:8192
s_waitcnt lgkmcnt(13)
ds_read_b64_tr_b16 a[146:147], v103 offset:9216
v_mfma_f32_16x16x32_bf16 v[84:87], a[148:151], v[232:235], v[84:87]
ds_read_b64_tr_b16 a[148:149], v104 offset:8192
s_waitcnt lgkmcnt(13)
ds_read_b64_tr_b16 a[150:151], v104 offset:9216
v_mfma_f32_16x16x32_bf16 v[88:91], a[152:155], v[232:235], v[88:91]
s_waitcnt vmcnt(5)
s_barrier
v_add_u32 v100, 32768, v105
v_add_u32 v101, 32768, v106
v_add_u32 v102, 32768, v107
v_add_u32 v103, 32768, v108
v_add_u32 v104, 32768, v109
ds_read_b64_tr_b16 a[152:153], v100 offset:0
s_waitcnt lgkmcnt(13)
ds_read_b64_tr_b16 a[154:155], v100 offset:1024
v_mfma_f32_16x16x32_bf16 v[92:95], a[156:159], v[232:235], v[92:95]
ds_read_b64_tr_b16 a[156:157], v101 offset:0
s_waitcnt lgkmcnt(13)
ds_read_b64_tr_b16 a[158:159], v101 offset:1024
v_mfma_f32_16x16x32_bf16 v[96:99], a[128:131], v[232:235], v[96:99]
ds_read_b64_tr_b16 a[128:129], v102 offset:0
s_waitcnt lgkmcnt(13)
ds_read_b64_tr_b16 a[130:131], v102 offset:1024
v_mfma_f32_16x16x32_bf16 v[80:83], a[132:135], v[236:239], v[80:83]
ds_read_b64_tr_b16 a[132:133], v103 offset:0
s_waitcnt lgkmcnt(13)
ds_read_b64_tr_b16 a[134:135], v103 offset:1024
v_mfma_f32_16x16x32_bf16 v[84:87], a[136:139], v[236:239], v[84:87]
ds_read_b64_tr_b16 a[136:137], v104 offset:0
s_waitcnt lgkmcnt(13)
ds_read_b64_tr_b16 a[138:139], v104 offset:1024
v_mfma_f32_16x16x32_bf16 v[88:91], a[140:143], v[236:239], v[88:91]
ds_read_b64_tr_b16 a[140:141], v100 offset:8192
s_waitcnt lgkmcnt(13)
ds_read_b64_tr_b16 a[142:143], v100 offset:9216
v_mfma_f32_16x16x32_bf16 v[92:95], a[144:147], v[236:239], v[92:95]
ds_read_b64_tr_b16 a[144:145], v101 offset:8192
s_waitcnt lgkmcnt(13)
ds_read_b64_tr_b16 a[146:147], v101 offset:9216
v_mfma_f32_16x16x32_bf16 v[96:99], a[148:151], v[236:239], v[96:99]
ds_read_b64_tr_b16 a[148:149], v102 offset:8192
s_waitcnt lgkmcnt(13)
ds_read_b64_tr_b16 a[150:151], v102 offset:9216
v_mfma_f32_16x16x32_bf16 v[80:83], a[152:155], v[240:243], v[80:83]
ds_read_b64_tr_b16 a[152:153], v103 offset:8192
s_waitcnt lgkmcnt(13)
ds_read_b64_tr_b16 a[154:155], v103 offset:9216
v_mfma_f32_16x16x32_bf16 v[84:87], a[156:159], v[240:243], v[84:87]
ds_read_b64_tr_b16 a[156:157], v104 offset:8192
s_waitcnt lgkmcnt(13)
ds_read_b64_tr_b16 a[158:159], v104 offset:9216
v_mfma_f32_16x16x32_bf16 v[88:91], a[128:131], v[240:243], v[88:91]
s_waitcnt vmcnt(1)
s_barrier
s_lshl_b32 s52, s48, 6
s_sub_u32 s52, s52, 16
s_mul_i32 s52, s52, 1152
s_cmp_eq_u32 s48, 0
s_cselect_b32 s52, 1073741824, s52
s_lshl_b32 s53, s50, 6
s_lshl_b32 s54, s50, 10
v_add_u32 v1, s53, v0
v_mul_u32_u24 v2, 911, v1
v_lshrrev_b32 v2, 17, v2
v_xor_b32 v1, v1, v2
v_lshlrev_b32 v1, 4, v1
s_add_u32 m0, s54, 0
s_nop 0
buffer_load_dwordx4 v1, s[4:7], s52 offen lds
v_add_u32 v1, s53, v0
v_add_u32 v1, 256, v1
v_mul_u32_u24 v2, 911, v1
v_lshrrev_b32 v2, 17, v2
v_xor_b32 v1, v1, v2
v_lshlrev_b32 v1, 4, v1
s_add_u32 m0, s54, 4096
s_nop 0
buffer_load_dwordx4 v1, s[4:7], s52 offen lds
v_add_u32 v1, s53, v0
v_add_u32 v1, 512, v1
v_mul_u32_u24 v2, 911, v1
v_lshrrev_b32 v2, 17, v2
v_xor_b32 v1, v1, v2
v_lshlrev_b32 v1, 4, v1
s_add_u32 m0, s54, 8192
s_nop 0
buffer_load_dwordx4 v1, s[4:7], s52 offen lds
v_add_u32 v1, s53, v0
v_add_u32 v1, 768, v1
v_mul_u32_u24 v2, 911, v1
v_lshrrev_b32 v2, 17, v2
v_xor_b32 v1, v1, v2
v_lshlrev_b32 v1, 4, v1
s_add_u32 m0, s54, 12288
s_nop 0
buffer_load_dwordx4 v1, s[4:7], s52 offen lds
v_add_u32 v1, s53, v0
v_add_u32 v1, 1024, v1
v_mul_u32_u24 v2, 911, v1
v_lshrrev_b32 v2, 17, v2
v_xor_b32 v1, v1, v2
v_lshlrev_b32 v1, 4, v1
s_add_u32 m0, s54, 16384
s_nop 0
buffer_load_dwordx4 v1, s[4:7], s52 offen lds
v_add_u32 v100, 49152, v105
v_add_u32 v101, 49152, v106
v_add_u32 v102, 49152, v107
v_add_u32 v103, 49152, v108
v_add_u32 v104, 49152, v109
ds_read_b64_tr_b16 a[128:129], v100 offset:0
s_waitcnt lgkmcnt(13)
ds_read_b64_tr_b16 a[130:131], v100 offset:1024
v_mfma_f32_16x16x32_bf16 v[92:95], a[132:135], v[240:243], v[92:95]
ds_read_b64_tr_b16 a[132:133], v101 offset:0
s_waitcnt lgkmcnt(13)
ds_read_b64_tr_b16 a[134:135], v101 offset:1024
v_mfma_f32_16x16x32_bf16 v[96:99], a[136:139], v[240:243], v[96:99]
ds_read_b64_tr_b16 a[136:137], v102 offset:0
s_waitcnt lgkmcnt(13)
ds_read_b64_tr_b16 a[138:139], v102 offset:1024
v_mfma_f32_16x16x32_bf16 v[80:83], a[140:143], v[244:247], v[80:83]
ds_read_b64_tr_b16 a[140:141], v103 offset:0
s_waitcnt lgkmcnt(13)
ds_read_b64_tr_b16 a[142:143], v103 offset:1024
v_mfma_f32_16x16x32_bf16 v[84:87], a[144:147], v[244:247], v[84:87]
ds_read_b64_tr_b16 a[144:145], v104 offset:0
s_waitcnt lgkmcnt(13)
ds_read_b64_tr_b16 a[146:147], v104 offset:1024
v_mfma_f32_16x16x32_bf16 v[88:91], a[148:151], v[244:247], v[88:91]
ds_read_b64_tr_b16 a[148:149], v100 offset:8192
s_waitcnt lgkmcnt(13)
ds_read_b64_tr_b16 a[150:151], v100 offset:9216
v_mfma_f32_16x16x32_bf16 v[92:95], a[152:155], v[244:247], v[92:95]
ds_read_b64_tr_b16 a[152:153], v101 offset:8192
s_waitcnt lgkmcnt(13)
ds_read_b64_tr_b16 a[154:155], v101 offset:9216
v_mfma_f32_16x16x32_bf16 v[96:99], a[156:159], v[244:247], v[96:99]
ds_read_b64_tr_b16 a[156:157], v102 offset:8192
s_waitcnt lgkmcnt(13)
ds_read_b64_tr_b16 a[158:159], v102 offset:9216
v_mfma_f32_16x16x32_bf16 v[80:83], a[128:131], v[248:251], v[80:83]
ds_read_b64_tr_b16 a[128:129], v103 offset:8192
s_waitcnt lgkmcnt(13)
ds_read_b64_tr_b16 a[130:131], v103 offset:9216
v_mfma_f32_16x16x32_bf16 v[84:87], a[132:135], v[248:251], v[84:87]
ds_read_b64_tr_b16 a[132:133], v104 offset:8192
s_waitcnt lgkmcnt(13)
ds_read_b64_tr_b16 a[134:135], v104 offset:9216
v_mfma_f32_16x16x32_bf16 v[88:91], a[136:139], v[248:251], v[88:91]
s_waitcnt lgkmcnt(12)
v_mfma_f32_16x16x32_bf16 v[92:95], a[140:143], v[248:251], v[92:95]
s_waitcnt lgkmcnt(10)
v_mfma_f32_16x16x32_bf16 v[96:99], a[144:147], v[248:251], v[96:99]
s_waitcnt lgkmcnt(8)
v_mfma_f32_16x16x32_bf16 v[80:83], a[148:151], v[252:255], v[80:83]
s_waitcnt lgkmcnt(6)
v_mfma_f32_16x16x32_bf16 v[84:87], a[152:155], v[252:255], v[84:87]
s_waitcnt lgkmcnt(4)
v_mfma_f32_16x16x32_bf16 v[88:91], a[156:159], v[252:255], v[88:91]
s_waitcnt lgkmcnt(2)
v_mfma_f32_16x16x32_bf16 v[92:95], a[128:131], v[252:255], v[92:95]
s_waitcnt lgkmcnt(0)
v_mfma_f32_16x16x32_bf16 v[96:99], a[132:135], v[252:255], v[96:99]
s_waitcnt vmcnt(5)
v_cmp_ne_u32 vcc, s51, v77
s_nop 3
s_cbranch_vccz L_fl_ok_10
s_mov_b32 s58, 100000
L_fl_poll_11:
buffer_load_dword v77, v76, s[44:47], 0 offen sc0 sc1
s_waitcnt vmcnt(0)
v_cmp_ne_u32 vcc, s51, v77
s_sub_u32 s58, s58, 1
s_cmp_eq_u32 s58, 0
s_cbranch_scc1 L_fl_ok_10
s_nop 1
s_cbranch_vccnz L_fl_poll_11
L_fl_ok_10:
s_mul_i32 s68, s50, 423936
s_add_u32 s68, s68, s67
v_lshrrev_b32 v1, 4, v0
v_and_b32 v2, 15, v0
v_lshl_add_u32 v1, v1, 3, v2
v_lshlrev_b32 v1, 4, v1
s_cmp_eq_u32 s50, 3
s_cselect_b32 s52, 0, 8
v_cmp_gt_u32 vcc, s52, v2
v_mov_b32 v2, 1073741824
s_nop 0
v_cndmask_b32 v75, v2, v1, vcc
buffer_load_dwordx4 v[188:191], v59, s[44:47], s68 offen offset:0 sc1
v_mul_f32 v112, v80, v80
v_mul_f32 v113, v81, v81
v_mul_f32 v114, v82, v82
v_mul_f32 v115, v83, v83
v_mul_f32 v116, v84, v84
v_mul_f32 v117, v85, v85
v_mul_f32 v118, v86, v86
v_mul_f32 v119, v87, v87
v_mul_f32 v120, v88, v88
buffer_load_dwordx4 v[192:195], v59, s[44:47], s68 offen offset:1024 sc1
v_mul_f32 v121, v89, v89
v_mul_f32 v122, v90, v90
v_mul_f32 v123, v91, v91
v_mul_f32 v124, v92, v92
v_mul_f32 v125, v93, v93
v_mul_f32 v126, v94, v94
v_mul_f32 v127, v95, v95
v_mul_f32 v128, v96, v96
v_mul_f32 v129, v97, v97
buffer_load_dwordx4 v[196:199], v59, s[44:47], s68 offen offset:2048 sc1
v_mul_f32 v130, v98, v98
v_mul_f32 v131, v99, v99
v_fma_f32 v112, v112, v72, v71
v_fma_f32 v113, v113, v72, v71
v_fma_f32 v114, v114, v72, v71
v_fma_f32 v115, v115, v72, v71
v_fma_f32 v116, v116, v72, v71
v_fma_f32 v117, v117, v72, v71
v_fma_f32 v118, v118, v72, v71
buffer_load_dwordx4 v[200:203], v59, s[44:47], s68 offen offset:3072 sc1
v_fma_f32 v119, v119, v72, v71
v_fma_f32 v120, v120, v72, v71
v_fma_f32 v121, v121, v72, v71
v_fma_f32 v122, v122, v72, v71
v_fma_f32 v123, v123, v72, v71
v_fma_f32 v124, v124, v72, v71
v_fma_f32 v125, v125, v72, v71
v_fma_f32 v126, v126, v72, v71
v_fma_f32 v127, v127, v72, v71
s_add_u32 s68, s68, 4096
buffer_load_dwordx4 v[204:207], v59, s[44:47], s68 offen offset:0 sc1
v_fma_f32 v128, v128, v72, v71
v_fma_f32 v129, v129, v72, v71
v_fma_f32 v130, v130, v72, v71
v_fma_f32 v131, v131, v72, v71
v_mul_f32 v112, v112, v80
v_mul_f32 v113, v113, v81
v_mul_f32 v114, v114, v82
v_mul_f32 v115, v115, v83
v_mul_f32 v116, v116, v84
buffer_load_dwordx4 v[208:211], v59, s[44:47], s68 offen offset:1024 sc1
v_mul_f32 v117, v117, v85
v_mul_f32 v118, v118, v86
v_mul_f32 v119, v119, v87
v_mul_f32 v120, v120, v88
v_mul_f32 v121, v121, v89
v_mul_f32 v122, v122, v90
v_mul_f32 v123, v123, v91
v_mul_f32 v124, v124, v92
v_mul_f32 v125, v125, v93
buffer_load_dwordx4 v[212:215], v59, s[44:47], s68 offen offset:2048 sc1
v_mul_f32 v126, v126, v94
v_mul_f32 v127, v127, v95
v_mul_f32 v128, v128, v96
v_mul_f32 v129, v129, v97
v_mul_f32 v130, v130, v98
v_mul_f32 v131, v131, v99
v_exp_f32 v112, v112
v_exp_f32 v113, v113
v_exp_f32 v114, v114
buffer_load_dwordx4 v[216:219], v59, s[44:47], s68 offen offset:3072 sc1
v_exp_f32 v115, v115
v_exp_f32 v116, v116
v_exp_f32 v117, v117
v_exp_f32 v118, v118
v_exp_f32 v119, v119
v_exp_f32 v120, v120
v_exp_f32 v121, v121
v_exp_f32 v122, v122
v_exp_f32 v123, v123
s_add_u32 s68, s68, 4096
buffer_load_dwordx4 v[220:223], v59, s[44:47], s68 offen offset:0 sc1
v_exp_f32 v124, v124
v_exp_f32 v125, v125
v_exp_f32 v126, v126
v_exp_f32 v127, v127
v_exp_f32 v128, v128
v_exp_f32 v129, v129
v_exp_f32 v130, v130
v_exp_f32 v131, v131
v_fma_f32 v112, v112, v73, v73
buffer_load_dwordx4 v[224:227], v59, s[44:47], s68 offen offset:1024 sc1
v_fma_f32 v113, v113, v73, v73
v_fma_f32 v114, v114, v73, v73
v_fma_f32 v115, v115, v73, v73
v_fma_f32 v116, v116, v73, v73
v_fma_f32 v117, v117, v73, v73
v_fma_f32 v118, v118, v73, v73
v_fma_f32 v119, v119, v73, v73
v_fma_f32 v120, v120, v73, v73
v_fma_f32 v121, v121, v73, v73
buffer_load_dwordx4 v[228:231], v59, s[44:47], s68 offen offset:2048 sc1
v_fma_f32 v122, v122, v73, v73
v_fma_f32 v123, v123, v73, v73
v_fma_f32 v124, v124, v73, v73
v_fma_f32 v125, v125, v73, v73
v_fma_f32 v126, v126, v73, v73
v_fma_f32 v127, v127, v73, v73
v_fma_f32 v128, v128, v73, v73
v_fma_f32 v129, v129, v73, v73
v_fma_f32 v130, v130, v73, v73
buffer_load_dwordx4 v[232:235], v59, s[44:47], s68 offen offset:3072 sc1
v_fma_f32 v131, v131, v73, v73
v_rcp_f32 v112, v112
v_rcp_f32 v113, v113
v_rcp_f32 v114, v114
v_rcp_f32 v115, v115
v_rcp_f32 v116, v116
v_rcp_f32 v117, v117
v_rcp_f32 v118, v118
v_rcp_f32 v119, v119
s_add_u32 s68, s68, 4096
buffer_load_dwordx4 v[236:239], v59, s[44:47], s68 offen offset:0 sc1
v_rcp_f32 v120, v120
v_rcp_f32 v121, v121
v_rcp_f32 v122, v122
v_rcp_f32 v123, v123
v_rcp_f32 v124, v124
v_rcp_f32 v125, v125
v_rcp_f32 v126, v126
v_rcp_f32 v127, v127
v_rcp_f32 v128, v128
buffer_load_dwordx4 v[240:243], v59, s[44:47], s68 offen offset:1024 sc1
v_rcp_f32 v129, v129
v_rcp_f32 v130, v130
v_rcp_f32 v131, v131
v_mul_f32 v112, v112, v80
v_mul_f32 v113, v113, v81
v_mul_f32 v114, v114, v82
v_mul_f32 v115, v115, v83
v_mul_f32 v116, v116, v84
v_mul_f32 v117, v117, v85
buffer_load_dwordx4 v[244:247], v59, s[44:47], s68 offen offset:2048 sc1
v_mul_f32 v118, v118, v86
v_mul_f32 v119, v119, v87
v_mul_f32 v120, v120, v88
v_mul_f32 v121, v121, v89
v_mul_f32 v122, v122, v90
v_mul_f32 v123, v123, v91
v_mul_f32 v124, v124, v92
v_mul_f32 v125, v125, v93
v_mul_f32 v126, v126, v94
v_mul_f32 v127, v127, v95
v_mul_f32 v128, v128, v96
v_mul_f32 v129, v129, v97
v_mul_f32 v130, v130, v98
v_mul_f32 v131, v131, v99
v_cvt_pk_bf16_f32 v132, v112, v113
v_cvt_pk_bf16_f32 v133, v114, v115
v_cvt_pk_bf16_f32 v134, v116, v117
v_cvt_pk_bf16_f32 v135, v118, v119
v_cvt_pk_bf16_f32 v136, v120, v121
v_cvt_pk_bf16_f32 v137, v122, v123
v_cvt_pk_bf16_f32 v138, v124, v125
v_cvt_pk_bf16_f32 v139, v126, v127
v_cvt_pk_bf16_f32 v140, v128, v129
v_cvt_pk_bf16_f32 v141, v130, v131
v_permlane16_swap_b32 v132, v134
v_permlane16_swap_b32 v133, v135
v_permlane16_swap_b32 v136, v138
v_permlane16_swap_b32 v137, v139
v_cmp_gt_u32 vcc, 2048, v54
s_nop 1
v_cndmask_b32 v132, 0, v132, vcc
v_cndmask_b32 v133, 0, v133, vcc
v_cndmask_b32 v134, 0, v134, vcc
v_cndmask_b32 v135, 0, v135, vcc
v_cndmask_b32 v136, 0, v136, vcc
v_cndmask_b32 v137, 0, v137, vcc
v_cndmask_b32 v138, 0, v138, vcc
v_cndmask_b32 v139, 0, v139, vcc
v_cndmask_b32 v140, 0, v140, vcc
v_cndmask_b32 v141, 0, v141, vcc
v_and_b32 v54, 2047, v54
v_lshrrev_b32 v4, 4, v54
v_mul_u32_u24 v4, 18432, v4
v_and_b32 v54, 15, v54
v_lshl_add_u32 v54, v54, 4, v4
v_add_u32 v1, v50, v54
v_add_u32 v2, v51, v54
v_add_u32 v3, v52, v54
buffer_store_dwordx4 v[132:135], v1, s[44:47], 0 offen sc0 sc1
buffer_store_dwordx4 v[136:139], v2, s[44:47], 0 offen sc0 sc1
buffer_store_dwordx2 v[140:141], v3, s[44:47], 0 offen sc0 sc1
v_mov_b32 v144, -1
v_mov_b32 v145, -1
s_lshl_b32 s52, s63, 3
s_add_u32 s52, s52, s49
s_lshl_b32 s52, s52, 7
s_add_u32 s52, s52, 23592960
v_lshlrev_b32 v1, 3, v0
s_mov_b64 exec, 0xffff
buffer_store_dwordx2 v[144:145], v1, s[44:47], s52 offen sc0 sc1
s_mov_b64 exec, -1
s_waitcnt vmcnt(19)
s_barrier
v_and_b32 v2, 15, v0
v_lshrrev_b32 v1, 4, v0
v_mul_u32_u24 v6, 1152, v2
v_add_u32 v6, 86016, v6
v_lshrrev_b32 v7, 1, v2
v_xor_b32 v5, v1, v7
v_lshl_add_u32 v66, v5, 4, v6
v_xor_b32 v5, 4, v5
v_lshl_add_u32 v67, v5, 4, v6
v_subrev_u32 v68, 86016, v66
v_subrev_u32 v69, 86016, v67
v_mul_u32_u24 v5, 208, v2
v_add_u32 v5, 86016, v5
s_lshl_b32 s52, s50, 4
v_lshl_add_u32 v6, v1, 2, s52
v_add_u32 v3, 0, v6
v_mul_u32_u24 v4, 3641, v3
v_lshrrev_b32 v4, 16, v4
v_mul_u32_u24 v4, 12, v4
v_lshl_add_u32 v3, v3, 1, v4
v_add_u32 v184, v5, v3
v_add_u32 v3, 2, v6
v_mul_u32_u24 v4, 3641, v3
v_lshrrev_b32 v4, 16, v4
v_mul_u32_u24 v4, 12, v4
v_lshl_add_u32 v3, v3, 1, v4
v_add_u32 v185, v5, v3
s_cmp_eq_u32 s50, 1
s_cselect_b32 s52, 16640, 0
s_cmp_eq_u32 s50, 2
s_cselect_b32 s52, 29952, s52
s_add_u32 s52, s52, 164
v_lshl_add_u32 v3, v1, 3, s52
v_mov_b32 v4, 192
s_cmp_ge_u32 s50, 3
s_cselect_b32 s53, 0, 2
v_cmp_gt_u32 vcc, s53, v1
s_nop 1
v_cndmask_b32 v186, v4, v3, vcc
v_add_u32 v186, v5, v186
v_add_u32 v187, 4, v186
s_cmp_ge_u32 s50, 2
s_cselect_b32 s53, 0, 2
v_cmp_gt_u32 vcc, s53, v1
s_nop 1
v_cndmask_b32 v6, v4, v3, vcc
v_add_u32 v6, v5, v6
v_add_u32 v7, 4, v6
ds_read_b128 a[0:3], v66 offset:0
ds_read_b128 a[72:75], v66 offset:18432
ds_read_b128 a[144:147], v66 offset:36864
ds_read_b128 a[216:219], v66 offset:55296
ds_read_b128 v[112:115], v68 offset:0
ds_read_b128 a[4:7], v67 offset:0
ds_read_b128 a[76:79], v67 offset:18432
ds_read_b128 a[148:151], v67 offset:36864
ds_read_b128 a[220:223], v67 offset:55296
ds_read_b128 v[116:119], v69 offset:0
ds_read_b128 a[8:11], v66 offset:128
ds_read_b128 a[80:83], v66 offset:18560
ds_read_b128 a[152:155], v66 offset:36992
ds_read_b128 a[224:227], v66 offset:55424
ds_read_b128 v[120:123], v68 offset:128
s_waitcnt vmcnt(18) lgkmcnt(10)
v_mfma_f32_16x16x32_bf16 v[80:83], v[188:191], a[0:3], 0
buffer_load_dwordx4 v[248:251], v59, s[44:47], s68 offen offset:3072 sc1
ds_read_b128 a[12:15], v67 offset:128
ds_read_b128 a[84:87], v67 offset:18560
ds_read_b128 a[156:159], v67 offset:36992
ds_read_b128 a[228:231], v67 offset:55424
ds_read_b128 v[124:127], v69 offset:128
v_mfma_f32_16x16x32_bf16 v[84:87], v[188:191], a[72:75], 0
v_mfma_f32_16x16x32_bf16 v[88:91], v[188:191], a[144:147], 0
v_mfma_f32_16x16x32_bf16 v[92:95], v[188:191], a[216:219], 0
v_mfma_f32_16x16x32_bf16 v[252:255], v[188:191], v[112:115], 0
s_waitcnt vmcnt(18) lgkmcnt(10)
v_mfma_f32_16x16x32_bf16 v[80:83], v[192:195], a[4:7], v[80:83]
s_add_u32 s68, s68, 4096
buffer_load_dwordx4 v[188:191], v59, s[44:47], s68 offen offset:0 sc1
ds_read_b128 a[16:19], v66 offset:256
ds_read_b128 a[88:91], v66 offset:18688
ds_read_b128 a[160:163], v66 offset:37120
ds_read_b128 a[232:235], v66 offset:55552
ds_read_b128 v[128:131], v68 offset:256
v_mfma_f32_16x16x32_bf16 v[84:87], v[192:195], a[76:79], v[84:87]
v_mfma_f32_16x16x32_bf16 v[88:91], v[192:195], a[148:151], v[88:91]
v_mfma_f32_16x16x32_bf16 v[92:95], v[192:195], a[220:223], v[92:95]
v_mfma_f32_16x16x32_bf16 v[252:255], v[192:195], v[116:119], v[252:255]
s_waitcnt vmcnt(18) lgkmcnt(10)
v_mfma_f32_16x16x32_bf16 v[80:83], v[196:199], a[8:11], v[80:83]
buffer_load_dwordx4 v[192:195], v59, s[44:47], s68 offen offset:1024 sc1
ds_read_b128 a[20:23], v67 offset:256
ds_read_b128 a[92:95], v67 offset:18688
ds_read_b128 a[164:167], v67 offset:37120
ds_read_b128 a[236:239], v67 offset:55552
ds_read_b128 v[132:135], v69 offset:256
v_mfma_f32_16x16x32_bf16 v[84:87], v[196:199], a[80:83], v[84:87]
v_mfma_f32_16x16x32_bf16 v[88:91], v[196:199], a[152:155], v[88:91]
v_mfma_f32_16x16x32_bf16 v[92:95], v[196:199], a[224:227], v[92:95]
v_mfma_f32_16x16x32_bf16 v[252:255], v[196:199], v[120:123], v[252:255]
s_waitcnt vmcnt(18) lgkmcnt(10)
v_mfma_f32_16x16x32_bf16 v[80:83], v[200:203], a[12:15], v[80:83]
buffer_load_dwordx4 v[196:199], v59, s[44:47], s68 offen offset:2048 sc1
ds_read_b128 a[24:27], v66 offset:384
ds_read_b128 a[96:99], v66 offset:18816
ds_read_b128 a[168:171], v66 offset:37248
ds_read_b128 a[240:243], v66 offset:55680
ds_read_b128 v[136:139], v68 offset:384
v_mfma_f32_16x16x32_bf16 v[84:87], v[200:203], a[84:87], v[84:87]
v_mfma_f32_16x16x32_bf16 v[88:91], v[200:203], a[156:159], v[88:91]
v_mfma_f32_16x16x32_bf16 v[92:95], v[200:203], a[228:231], v[92:95]
v_mfma_f32_16x16x32_bf16 v[252:255], v[200:203], v[124:127], v[252:255]
s_waitcnt vmcnt(18) lgkmcnt(10)
v_mfma_f32_16x16x32_bf16 v[80:83], v[204:207], a[16:19], v[80:83]
buffer_load_dwordx4 v[200:203], v59, s[44:47], s68 offen offset:3072 sc1
ds_read_b128 a[28:31], v67 offset:384
ds_read_b128 a[100:103], v67 offset:18816
ds_read_b128 a[172:175], v67 offset:37248
ds_read_b128 a[244:247], v67 offset:55680
ds_read_b128 v[140:143], v69 offset:384
v_mfma_f32_16x16x32_bf16 v[84:87], v[204:207], a[88:91], v[84:87]
v_mfma_f32_16x16x32_bf16 v[88:91], v[204:207], a[160:163], v[88:91]
v_mfma_f32_16x16x32_bf16 v[92:95], v[204:207], a[232:235], v[92:95]
v_mfma_f32_16x16x32_bf16 v[252:255], v[204:207], v[128:131], v[252:255]
s_waitcnt vmcnt(18) lgkmcnt(10)
v_mfma_f32_16x16x32_bf16 v[80:83], v[208:211], a[20:23], v[80:83]
s_add_u32 s68, s68, 4096
buffer_load_dwordx4 v[204:207], v59, s[44:47], s68 offen offset:0 sc1
ds_read_b128 a[32:35], v66 offset:512
ds_read_b128 a[104:107], v66 offset:18944
ds_read_b128 a[176:179], v66 offset:37376
ds_read_b128 a[248:251], v66 offset:55808
ds_read_b128 v[144:147], v68 offset:512
v_mfma_f32_16x16x32_bf16 v[84:87], v[208:211], a[92:95], v[84:87]
v_mfma_f32_16x16x32_bf16 v[88:91], v[208:211], a[164:167], v[88:91]
v_mfma_f32_16x16x32_bf16 v[92:95], v[208:211], a[236:239], v[92:95]
v_mfma_f32_16x16x32_bf16 v[252:255], v[208:211], v[132:135], v[252:255]
s_waitcnt vmcnt(18) lgkmcnt(10)
v_mfma_f32_16x16x32_bf16 v[80:83], v[212:215], a[24:27], v[80:83]
buffer_load_dwordx4 v[208:211], v59, s[44:47], s68 offen offset:1024 sc1
ds_read_b128 a[36:39], v67 offset:512
ds_read_b128 a[108:111], v67 offset:18944
ds_read_b128 a[180:183], v67 offset:37376
ds_read_b128 a[252:255], v67 offset:55808
ds_read_b128 v[148:151], v69 offset:512
v_mfma_f32_16x16x32_bf16 v[84:87], v[212:215], a[96:99], v[84:87]
v_mfma_f32_16x16x32_bf16 v[88:91], v[212:215], a[168:171], v[88:91]
v_mfma_f32_16x16x32_bf16 v[92:95], v[212:215], a[240:243], v[92:95]
v_mfma_f32_16x16x32_bf16 v[252:255], v[212:215], v[136:139], v[252:255]
s_waitcnt vmcnt(18) lgkmcnt(10)
v_mfma_f32_16x16x32_bf16 v[80:83], v[216:219], a[28:31], v[80:83]
buffer_load_dwordx4 v[212:215], v59, s[44:47], s68 offen offset:2048 sc1
ds_read_b128 a[40:43], v66 offset:640
ds_read_b128 a[112:115], v66 offset:19072
ds_read_b128 a[184:187], v66 offset:37504
ds_read_b128 v[8:11], v66 offset:55936
ds_read_b128 v[152:155], v68 offset:640
v_mfma_f32_16x16x32_bf16 v[84:87], v[216:219], a[100:103], v[84:87]
v_mfma_f32_16x16x32_bf16 v[88:91], v[216:219], a[172:175], v[88:91]
v_mfma_f32_16x16x32_bf16 v[92:95], v[216:219], a[244:247], v[92:95]
v_mfma_f32_16x16x32_bf16 v[252:255], v[216:219], v[140:143], v[252:255]
s_waitcnt vmcnt(18) lgkmcnt(10)
v_mfma_f32_16x16x32_bf16 v[80:83], v[220:223], a[32:35], v[80:83]
buffer_load_dwordx4 v[216:219], v59, s[44:47], s68 offen offset:3072 sc1
ds_read_b128 a[44:47], v67 offset:640
ds_read_b128 a[116:119], v67 offset:19072
ds_read_b128 a[188:191], v67 offset:37504
ds_read_b128 v[12:15], v67 offset:55936
ds_read_b128 v[156:159], v69 offset:640
v_mfma_f32_16x16x32_bf16 v[84:87], v[220:223], a[104:107], v[84:87]
v_mfma_f32_16x16x32_bf16 v[88:91], v[220:223], a[176:179], v[88:91]
v_mfma_f32_16x16x32_bf16 v[92:95], v[220:223], a[248:251], v[92:95]
v_mfma_f32_16x16x32_bf16 v[252:255], v[220:223], v[144:147], v[252:255]
s_waitcnt vmcnt(18) lgkmcnt(10)
v_mfma_f32_16x16x32_bf16 v[80:83], v[224:227], a[36:39], v[80:83]
s_add_u32 s68, s68, 4096
buffer_load_dwordx4 v[220:223], v59, s[44:47], s68 offen offset:0 sc1
ds_read_b128 a[48:51], v66 offset:768
ds_read_b128 a[120:123], v66 offset:19200
ds_read_b128 a[192:195], v66 offset:37632
ds_read_b128 v[16:19], v66 offset:56064
ds_read_b128 v[160:163], v68 offset:768
v_mfma_f32_16x16x32_bf16 v[84:87], v[224:227], a[108:111], v[84:87]
v_mfma_f32_16x16x32_bf16 v[88:91], v[224:227], a[180:183], v[88:91]
v_mfma_f32_16x16x32_bf16 v[92:95], v[224:227], a[252:255], v[92:95]
v_mfma_f32_16x16x32_bf16 v[252:255], v[224:227], v[148:151], v[252:255]
s_waitcnt vmcnt(18) lgkmcnt(10)
v_mfma_f32_16x16x32_bf16 v[80:83], v[228:231], a[40:43], v[80:83]
buffer_load_dwordx4 v[224:227], v59, s[44:47], s68 offen offset:1024 sc1
ds_read_b128 a[52:55], v67 offset:768
ds_read_b128 a[124:127], v67 offset:19200
ds_read_b128 a[196:199], v67 offset:37632
ds_read_b128 v[20:23], v67 offset:56064
ds_read_b128 v[164:167], v69 offset:768
v_mfma_f32_16x16x32_bf16 v[84:87], v[228:231], a[112:115], v[84:87]
v_mfma_f32_16x16x32_bf16 v[88:91], v[228:231], a[184:187], v[88:91]
v_mfma_f32_16x16x32_bf16 v[92:95], v[228:231], v[8:11], v[92:95]
v_mfma_f32_16x16x32_bf16 v[252:255], v[228:231], v[152:155], v[252:255]
s_waitcnt vmcnt(18) lgkmcnt(10)
v_mfma_f32_16x16x32_bf16 v[80:83], v[232:235], a[44:47], v[80:83]
buffer_load_dwordx4 v[228:231], v59, s[44:47], s68 offen offset:2048 sc1
ds_read_b128 a[56:59], v66 offset:896
ds_read_b128 a[128:131], v66 offset:19328
ds_read_b128 a[200:203], v66 offset:37760
ds_read_b128 v[24:27], v66 offset:56192
ds_read_b128 v[168:171], v68 offset:896
v_mfma_f32_16x16x32_bf16 v[84:87], v[232:235], a[116:119], v[84:87]
v_mfma_f32_16x16x32_bf16 v[88:91], v[232:235], a[188:191], v[88:91]
v_mfma_f32_16x16x32_bf16 v[92:95], v[232:235], v[12:15], v[92:95]
v_mfma_f32_16x16x32_bf16 v[252:255], v[232:235], v[156:159], v[252:255]
s_waitcnt vmcnt(18) lgkmcnt(10)
v_mfma_f32_16x16x32_bf16 v[80:83], v[236:239], a[48:51], v[80:83]
buffer_load_dwordx4 v[232:235], v59, s[44:47], s68 offen offset:3072 sc1
ds_read_b128 a[60:63], v67 offset:896
ds_read_b128 a[132:135], v67 offset:19328
ds_read_b128 a[204:207], v67 offset:37760
ds_read_b128 v[28:31], v67 offset:56192
ds_read_b128 v[172:175], v69 offset:896
v_mfma_f32_16x16x32_bf16 v[84:87], v[236:239], a[120:123], v[84:87]
v_mfma_f32_16x16x32_bf16 v[88:91], v[236:239], a[192:195], v[88:91]
v_mfma_f32_16x16x32_bf16 v[92:95], v[236:239], v[16:19], v[92:95]
v_mfma_f32_16x16x32_bf16 v[252:255], v[236:239], v[160:163], v[252:255]
s_waitcnt vmcnt(18) lgkmcnt(10)
v_mfma_f32_16x16x32_bf16 v[80:83], v[240:243], a[52:55], v[80:83]
s_add_u32 s68, s68, 4096
buffer_load_dwordx4 v[236:239], v59, s[44:47], s68 offen offset:0 sc1
ds_read_b128 a[64:67], v66 offset:1024
ds_read_b128 a[136:139], v66 offset:19456
ds_read_b128 a[208:211], v66 offset:37888
ds_read_b128 v[32:35], v66 offset:56320
ds_read_b128 v[176:179], v68 offset:1024
v_mfma_f32_16x16x32_bf16 v[84:87], v[240:243], a[124:127], v[84:87]
v_mfma_f32_16x16x32_bf16 v[88:91], v[240:243], a[196:199], v[88:91]
v_mfma_f32_16x16x32_bf16 v[92:95], v[240:243], v[20:23], v[92:95]
v_mfma_f32_16x16x32_bf16 v[252:255], v[240:243], v[164:167], v[252:255]
s_waitcnt vmcnt(18) lgkmcnt(10)
v_mfma_f32_16x16x32_bf16 v[80:83], v[244:247], a[56:59], v[80:83]
buffer_load_dwordx4 v[240:243], v59, s[44:47], s68 offen offset:1024 sc1
ds_read_b128 a[68:71], v67 offset:1024
ds_read_b128 a[140:143], v67 offset:19456
ds_read_b128 a[212:215], v67 offset:37888
ds_read_b128 v[36:39], v67 offset:56320
ds_read_b128 v[180:183], v69 offset:1024
v_mfma_f32_16x16x32_bf16 v[84:87], v[244:247], a[128:131], v[84:87]
v_mfma_f32_16x16x32_bf16 v[88:91], v[244:247], a[200:203], v[88:91]
v_mfma_f32_16x16x32_bf16 v[92:95], v[244:247], v[24:27], v[92:95]
v_mfma_f32_16x16x32_bf16 v[252:255], v[244:247], v[168:171], v[252:255]
s_waitcnt vmcnt(14) lgkmcnt(10)
v_mfma_f32_16x16x32_bf16 v[80:83], v[248:251], a[60:63], v[80:83]
buffer_load_dwordx4 v[244:247], v59, s[44:47], s68 offen offset:2048 sc1
v_mfma_f32_16x16x32_bf16 v[84:87], v[248:251], a[132:135], v[84:87]
v_mfma_f32_16x16x32_bf16 v[88:91], v[248:251], a[204:207], v[88:91]
v_mfma_f32_16x16x32_bf16 v[92:95], v[248:251], v[28:31], v[92:95]
v_mfma_f32_16x16x32_bf16 v[252:255], v[248:251], v[172:175], v[252:255]
s_waitcnt vmcnt(14) lgkmcnt(5)
v_mfma_f32_16x16x32_bf16 v[80:83], v[188:191], a[64:67], v[80:83]
buffer_load_dwordx4 v[248:251], v59, s[44:47], s68 offen offset:3072 sc1
v_mfma_f32_16x16x32_bf16 v[84:87], v[188:191], a[136:139], v[84:87]
v_mfma_f32_16x16x32_bf16 v[88:91], v[188:191], a[208:211], v[88:91]
v_mfma_f32_16x16x32_bf16 v[92:95], v[188:191], v[32:35], v[92:95]
v_mfma_f32_16x16x32_bf16 v[252:255], v[188:191], v[176:179], v[252:255]
s_waitcnt vmcnt(14) lgkmcnt(0)
v_mfma_f32_16x16x32_bf16 v[80:83], v[192:195], a[68:71], v[80:83]
s_add_u32 s68, s68, 4096
buffer_load_dwordx4 v[188:191], v59, s[44:47], s68 offen offset:0 sc1
v_mfma_f32_16x16x32_bf16 v[84:87], v[192:195], a[140:143], v[84:87]
v_mfma_f32_16x16x32_bf16 v[88:91], v[192:195], a[212:215], v[88:91]
v_mfma_f32_16x16x32_bf16 v[92:95], v[192:195], v[36:39], v[92:95]
v_mfma_f32_16x16x32_bf16 v[252:255], v[192:195], v[180:183], v[252:255]
s_waitcnt vmcnt(14)
v_mfma_f32_16x16x32_bf16 v[96:99], v[196:199], a[0:3], 0
buffer_load_dwordx4 v[192:195], v59, s[44:47], s68 offen offset:1024 sc1
v_mfma_f32_16x16x32_bf16 v[100:103], v[196:199], a[72:75], 0
v_mfma_f32_16x16x32_bf16 v[104:107], v[196:199], a[144:147], 0
v_mfma_f32_16x16x32_bf16 v[108:111], v[196:199], a[216:219], 0
v_mfma_f32_16x16x32_bf16 v[54:57], v[196:199], v[112:115], 0
s_barrier
s_cmp_lg_u32 s50, 0
s_cbranch_scc1 L_nofl_12
v_mov_b32 v2, s51
s_mov_b64 exec, 1
s_lshl_b32 s52, s48, 3
s_add_u32 s52, s52, s49
s_lshl_b32 s52, s52, 2
s_add_u32 s52, s52, 37953536
v_mov_b32 v1, s52
buffer_store_dword v2, v1, s[44:47], 0 offen sc0 sc1
s_lshl_b32 s52, s49, 5
s_add_u32 s52, s52, s48
s_lshl_b32 s52, s52, 2
s_add_u32 s52, s52, 37956608
v_mov_b32 v1, s52
buffer_store_dword v2, v1, s[44:47], 0 offen sc0 sc1
s_mov_b64 exec, -1
L_nofl_12:
s_waitcnt vmcnt(14)
v_mfma_f32_16x16x32_bf16 v[96:99], v[200:203], a[4:7], v[96:99]
buffer_load_dwordx4 v[196:199], v59, s[44:47], s68 offen offset:2048 sc1
v_mfma_f32_16x16x32_bf16 v[100:103], v[200:203], a[76:79], v[100:103]
v_mfma_f32_16x16x32_bf16 v[104:107], v[200:203], a[148:151], v[104:107]
v_mfma_f32_16x16x32_bf16 v[108:111], v[200:203], a[220:223], v[108:111]
v_mfma_f32_16x16x32_bf16 v[54:57], v[200:203], v[116:119], v[54:57]
s_waitcnt vmcnt(14)
v_mfma_f32_16x16x32_bf16 v[96:99], v[204:207], a[8:11], v[96:99]
buffer_load_dwordx4 v[200:203], v59, s[44:47], s68 offen offset:3072 sc1
v_mfma_f32_16x16x32_bf16 v[100:103], v[204:207], a[80:83], v[100:103]
v_cvt_pk_bf16_f32 v62, v252, v253
v_mfma_f32_16x16x32_bf16 v[104:107], v[204:207], a[152:155], v[104:107]
ds_write_b32 v184, v62 offset:0
v_cvt_pk_bf16_f32 v63, v254, v255
v_mfma_f32_16x16x32_bf16 v[108:111], v[204:207], a[224:227], v[108:111]
ds_write_b32 v185, v63 offset:0
v_cvt_pk_bf16_f32 v60, v80, v81
v_mfma_f32_16x16x32_bf16 v[54:57], v[204:207], v[120:123], v[54:57]
ds_write_b32 v184, v60 offset:3328
s_waitcnt vmcnt(14)
v_mfma_f32_16x16x32_bf16 v[96:99], v[208:211], a[12:15], v[96:99]
s_add_u32 s68, s68, 4096
buffer_load_dwordx4 v[204:207], v75, s[44:47], s68 offen offset:0 sc1
v_mfma_f32_16x16x32_bf16 v[100:103], v[208:211], a[84:87], v[100:103]
v_cvt_pk_bf16_f32 v61, v82, v83
v_mfma_f32_16x16x32_bf16 v[104:107], v[208:211], a[156:159], v[104:107]
ds_write_b32 v185, v61 offset:3328
v_cvt_pk_bf16_f32 v62, v84, v85
v_mfma_f32_16x16x32_bf16 v[108:111], v[208:211], a[228:231], v[108:111]
ds_write_b32 v184, v62 offset:6656
v_cvt_pk_bf16_f32 v63, v86, v87
v_mfma_f32_16x16x32_bf16 v[54:57], v[208:211], v[124:127], v[54:57]
ds_write_b32 v185, v63 offset:6656
s_waitcnt vmcnt(14)
v_mfma_f32_16x16x32_bf16 v[96:99], v[212:215], a[16:19], v[96:99]
buffer_load_dwordx4 v[208:211], v75, s[44:47], s68 offen offset:512 sc1
v_mfma_f32_16x16x32_bf16 v[100:103], v[212:215], a[88:91], v[100:103]
v_cvt_pk_bf16_f32 v60, v88, v89
v_mfma_f32_16x16x32_bf16 v[104:107], v[212:215], a[160:163], v[104:107]
ds_write_b32 v184, v60 offset:9984
v_cvt_pk_bf16_f32 v61, v90, v91
v_mfma_f32_16x16x32_bf16 v[108:111], v[212:215], a[232:235], v[108:111]
ds_write_b32 v185, v61 offset:9984
v_cvt_pk_bf16_f32 v62, v92, v93
v_mfma_f32_16x16x32_bf16 v[54:57], v[212:215], v[128:131], v[54:57]
ds_write_b32 v184, v62 offset:13312
s_waitcnt vmcnt(14)
v_mfma_f32_16x16x32_bf16 v[96:99], v[216:219], a[20:23], v[96:99]
buffer_load_dwordx4 v[212:215], v75, s[44:47], s68 offen offset:1024 sc1
v_mfma_f32_16x16x32_bf16 v[100:103], v[216:219], a[92:95], v[100:103]
v_cvt_pk_bf16_f32 v63, v94, v95
v_mfma_f32_16x16x32_bf16 v[104:107], v[216:219], a[164:167], v[104:107]
ds_write_b32 v185, v63 offset:13312
v_mfma_f32_16x16x32_bf16 v[108:111], v[216:219], a[236:239], v[108:111]
v_mfma_f32_16x16x32_bf16 v[54:57], v[216:219], v[132:135], v[54:57]
s_waitcnt vmcnt(14)
v_mfma_f32_16x16x32_bf16 v[96:99], v[220:223], a[24:27], v[96:99]
buffer_load_dwordx4 v[216:219], v75, s[44:47], s68 offen offset:1536 sc1
v_mfma_f32_16x16x32_bf16 v[100:103], v[220:223], a[96:99], v[100:103]
s_mul_i32 s75, s50, 20480
s_add_u32 s69, s67, 1695744
s_add_u32 s69, s69, s75
s_mov_b32 m0, s75
s_nop 0
buffer_load_dwordx4 v59, s[44:47], s69 offen offset:0 sc1 lds
v_mfma_f32_16x16x32_bf16 v[104:107], v[220:223], a[168:171], v[104:107]
v_mfma_f32_16x16x32_bf16 v[108:111], v[220:223], a[240:243], v[108:111]
v_mfma_f32_16x16x32_bf16 v[54:57], v[220:223], v[136:139], v[54:57]
s_waitcnt vmcnt(15)
v_mfma_f32_16x16x32_bf16 v[96:99], v[224:227], a[28:31], v[96:99]
buffer_load_dwordx4 v[220:223], v75, s[44:47], s68 offen offset:2048 sc1
v_mfma_f32_16x16x32_bf16 v[100:103], v[224:227], a[100:103], v[100:103]
buffer_load_dwordx4 v59, s[44:47], s69 offen offset:1024 sc1 lds
v_mfma_f32_16x16x32_bf16 v[104:107], v[224:227], a[172:175], v[104:107]
v_mfma_f32_16x16x32_bf16 v[108:111], v[224:227], a[244:247], v[108:111]
v_mfma_f32_16x16x32_bf16 v[54:57], v[224:227], v[140:143], v[54:57]
s_waitcnt vmcnt(16)
v_mfma_f32_16x16x32_bf16 v[96:99], v[228:231], a[32:35], v[96:99]
buffer_load_dwordx4 v[224:227], v75, s[44:47], s68 offen offset:2560 sc1
v_mfma_f32_16x16x32_bf16 v[100:103], v[228:231], a[104:107], v[100:103]
buffer_load_dwordx4 v59, s[44:47], s69 offen offset:2048 sc1 lds
v_mfma_f32_16x16x32_bf16 v[104:107], v[228:231], a[176:179], v[104:107]
v_mfma_f32_16x16x32_bf16 v[108:111], v[228:231], a[248:251], v[108:111]
v_mfma_f32_16x16x32_bf16 v[54:57], v[228:231], v[144:147], v[54:57]
s_waitcnt vmcnt(17)
v_mfma_f32_16x16x32_bf16 v[96:99], v[232:235], a[36:39], v[96:99]
buffer_load_dwordx4 v[228:231], v75, s[44:47], s68 offen offset:3072 sc1
v_mfma_f32_16x16x32_bf16 v[100:103], v[232:235], a[108:111], v[100:103]
buffer_load_dwordx4 v59, s[44:47], s69 offen offset:3072 sc1 lds
v_mfma_f32_16x16x32_bf16 v[104:107], v[232:235], a[180:183], v[104:107]
v_mfma_f32_16x16x32_bf16 v[108:111], v[232:235], a[252:255], v[108:111]
v_mfma_f32_16x16x32_bf16 v[54:57], v[232:235], v[148:151], v[54:57]
s_waitcnt vmcnt(18)
v_mfma_f32_16x16x32_bf16 v[96:99], v[236:239], a[40:43], v[96:99]
buffer_load_dwordx4 v[232:235], v75, s[44:47], s68 offen offset:3584 sc1
v_mfma_f32_16x16x32_bf16 v[100:103], v[236:239], a[112:115], v[100:103]
s_add_u32 s69, s69, 4096
s_add_u32 m0, s75, 4096
s_nop 0
buffer_load_dwordx4 v59, s[44:47], s69 offen offset:0 sc1 lds
v_mfma_f32_16x16x32_bf16 v[104:107], v[236:239], a[184:187], v[104:107]
v_mfma_f32_16x16x32_bf16 v[108:111], v[236:239], v[8:11], v[108:111]
v_mfma_f32_16x16x32_bf16 v[54:57], v[236:239], v[152:155], v[54:57]
s_waitcnt vmcnt(19)
v_mfma_f32_16x16x32_bf16 v[96:99], v[240:243], a[44:47], v[96:99]
s_add_u32 s68, s68, 4096
buffer_load_dwordx4 v[236:239], v75, s[44:47], s68 offen offset:0 sc1
v_mfma_f32_16x16x32_bf16 v[100:103], v[240:243], a[116:119], v[100:103]
buffer_load_dwordx4 v59, s[44:47], s69 offen offset:1024 sc1 lds
v_mfma_f32_16x16x32_bf16 v[104:107], v[240:243], a[188:191], v[104:107]
v_mfma_f32_16x16x32_bf16 v[108:111], v[240:243], v[12:15], v[108:111]
v_mfma_f32_16x16x32_bf16 v[54:57], v[240:243], v[156:159], v[54:57]
s_waitcnt vmcnt(20)
v_mfma_f32_16x16x32_bf16 v[96:99], v[244:247], a[48:51], v[96:99]
buffer_load_dwordx4 v[240:243], v75, s[44:47], s68 offen offset:512 sc1
v_mfma_f32_16x16x32_bf16 v[100:103], v[244:247], a[120:123], v[100:103]
buffer_load_dwordx4 v59, s[44:47], s69 offen offset:2048 sc1 lds
v_mfma_f32_16x16x32_bf16 v[104:107], v[244:247], a[192:195], v[104:107]
v_mfma_f32_16x16x32_bf16 v[108:111], v[244:247], v[16:19], v[108:111]
v_mfma_f32_16x16x32_bf16 v[54:57], v[244:247], v[160:163], v[54:57]
s_waitcnt vmcnt(21)
v_mfma_f32_16x16x32_bf16 v[96:99], v[248:251], a[52:55], v[96:99]
buffer_load_dwordx4 v[244:247], v75, s[44:47], s68 offen offset:1024 sc1
v_mfma_f32_16x16x32_bf16 v[100:103], v[248:251], a[124:127], v[100:103]
buffer_load_dwordx4 v59, s[44:47], s69 offen offset:3072 sc1 lds
v_mfma_f32_16x16x32_bf16 v[104:107], v[248:251], a[196:199], v[104:107]
v_mfma_f32_16x16x32_bf16 v[108:111], v[248:251], v[20:23], v[108:111]
v_mfma_f32_16x16x32_bf16 v[54:57], v[248:251], v[164:167], v[54:57]
s_waitcnt vmcnt(22)
v_mfma_f32_16x16x32_bf16 v[96:99], v[188:191], a[56:59], v[96:99]
buffer_load_dwordx4 v[248:251], v75, s[44:47], s68 offen offset:1536 sc1
v_mfma_f32_16x16x32_bf16 v[100:103], v[188:191], a[128:131], v[100:103]
s_add_u32 s69, s69, 4096
s_add_u32 m0, s75, 8192
s_nop 0
buffer_load_dwordx4 v59, s[44:47], s69 offen offset:0 sc1 lds
v_mfma_f32_16x16x32_bf16 v[104:107], v[188:191], a[200:203], v[104:107]
v_mfma_f32_16x16x32_bf16 v[108:111], v[188:191], v[24:27], v[108:111]
v_mfma_f32_16x16x32_bf16 v[54:57], v[188:191], v[168:171], v[54:57]
s_waitcnt vmcnt(23)
v_mfma_f32_16x16x32_bf16 v[96:99], v[192:195], a[60:63], v[96:99]
buffer_load_dwordx4 v[188:191], v75, s[44:47], s68 offen offset:2048 sc1
v_mfma_f32_16x16x32_bf16 v[100:103], v[192:195], a[132:135], v[100:103]
buffer_load_dwordx4 v59, s[44:47], s69 offen offset:1024 sc1 lds
v_mfma_f32_16x16x32_bf16 v[104:107], v[192:195], a[204:207], v[104:107]
v_mfma_f32_16x16x32_bf16 v[108:111], v[192:195], v[28:31], v[108:111]
v_mfma_f32_16x16x32_bf16 v[54:57], v[192:195], v[172:175], v[54:57]
s_waitcnt vmcnt(24)
v_mfma_f32_16x16x32_bf16 v[96:99], v[196:199], a[64:67], v[96:99]
buffer_load_dwordx4 v[192:195], v75, s[44:47], s68 offen offset:2560 sc1
v_mfma_f32_16x16x32_bf16 v[100:103], v[196:199], a[136:139], v[100:103]
buffer_load_dwordx4 v59, s[44:47], s69 offen offset:2048 sc1 lds
v_mfma_f32_16x16x32_bf16 v[104:107], v[196:199], a[208:211], v[104:107]
v_mfma_f32_16x16x32_bf16 v[108:111], v[196:199], v[32:35], v[108:111]
v_mfma_f32_16x16x32_bf16 v[54:57], v[196:199], v[176:179], v[54:57]
s_waitcnt vmcnt(25)
v_mfma_f32_16x16x32_bf16 v[96:99], v[200:203], a[68:71], v[96:99]
buffer_load_dwordx4 v[196:199], v75, s[44:47], s68 offen offset:3072 sc1
v_mfma_f32_16x16x32_bf16 v[100:103], v[200:203], a[140:143], v[100:103]
buffer_load_dwordx4 v59, s[44:47], s69 offen offset:3072 sc1 lds
v_mfma_f32_16x16x32_bf16 v[104:107], v[200:203], a[212:215], v[104:107]
v_mfma_f32_16x16x32_bf16 v[108:111], v[200:203], v[36:39], v[108:111]
v_mfma_f32_16x16x32_bf16 v[54:57], v[200:203], v[180:183], v[54:57]
s_waitcnt vmcnt(26)
v_mfma_f32_16x16x32_bf16 v[80:83], v[204:207], a[0:3], 0
buffer_load_dwordx4 v[200:203], v75, s[44:47], s68 offen offset:3584 sc1
v_mfma_f32_16x16x32_bf16 v[84:87], v[204:207], a[72:75], 0
s_add_u32 s69, s69, 4096
s_add_u32 m0, s75, 12288
s_nop 0
buffer_load_dwordx4 v59, s[44:47], s69 offen offset:0 sc1 lds
v_mfma_f32_16x16x32_bf16 v[88:91], v[204:207], a[144:147], 0
v_mfma_f32_16x16x32_bf16 v[92:95], v[204:207], a[216:219], 0
v_mfma_f32_16x16x32_bf16 v[252:255], v[204:207], v[112:115], 0
s_waitcnt vmcnt(27)
v_mfma_f32_16x16x32_bf16 v[80:83], v[208:211], a[4:7], v[80:83]
s_add_u32 s68, s68, 4096
buffer_load_dwordx4 v[204:207], v75, s[44:47], s68 offen offset:0 sc1
v_mfma_f32_16x16x32_bf16 v[84:87], v[208:211], a[76:79], v[84:87]
buffer_load_dwordx4 v59, s[44:47], s69 offen offset:1024 sc1 lds
v_mfma_f32_16x16x32_bf16 v[88:91], v[208:211], a[148:151], v[88:91]
v_mfma_f32_16x16x32_bf16 v[92:95], v[208:211], a[220:223], v[92:95]
v_mfma_f32_16x16x32_bf16 v[252:255], v[208:211], v[116:119], v[252:255]
s_waitcnt vmcnt(28)
v_mfma_f32_16x16x32_bf16 v[80:83], v[212:215], a[8:11], v[80:83]
buffer_load_dwordx4 v[208:211], v75, s[44:47], s68 offen offset:512 sc1
v_mfma_f32_16x16x32_bf16 v[84:87], v[212:215], a[80:83], v[84:87]
buffer_load_dwordx4 v59, s[44:47], s69 offen offset:2048 sc1 lds
v_mfma_f32_16x16x32_bf16 v[88:91], v[212:215], a[152:155], v[88:91]
v_cvt_pk_bf16_f32 v62, v54, v55
ds_write_b32 v184, v62 offset:16640
v_mfma_f32_16x16x32_bf16 v[92:95], v[212:215], a[224:227], v[92:95]
v_cvt_pk_bf16_f32 v63, v56, v57
ds_write_b32 v185, v63 offset:16640
v_mfma_f32_16x16x32_bf16 v[252:255], v[212:215], v[120:123], v[252:255]
v_cvt_pk_bf16_f32 v60, v96, v97
s_waitcnt vmcnt(29)
v_mfma_f32_16x16x32_bf16 v[80:83], v[216:219], a[12:15], v[80:83]
buffer_load_dwordx4 v[212:215], v59, s[44:47], s68 offen offset:1024 sc1
v_mfma_f32_16x16x32_bf16 v[84:87], v[216:219], a[84:87], v[84:87]
ds_write_b32 v184, v60 offset:19968
v_mfma_f32_16x16x32_bf16 v[88:91], v[216:219], a[156:159], v[88:91]
v_cvt_pk_bf16_f32 v61, v98, v99
ds_write_b32 v185, v61 offset:19968
v_mfma_f32_16x16x32_bf16 v[92:95], v[216:219], a[228:231], v[92:95]
v_cvt_pk_bf16_f32 v62, v100, v101
ds_write_b32 v184, v62 offset:23296
v_mfma_f32_16x16x32_bf16 v[252:255], v[216:219], v[124:127], v[252:255]
v_cvt_pk_bf16_f32 v63, v102, v103
s_waitcnt vmcnt(28)
v_mfma_f32_16x16x32_bf16 v[80:83], v[220:223], a[16:19], v[80:83]
buffer_load_dwordx4 v[216:219], v59, s[44:47], s68 offen offset:2048 sc1
v_mfma_f32_16x16x32_bf16 v[84:87], v[220:223], a[88:91], v[84:87]
s_waitcnt lgkmcnt(13)
ds_write_b32 v185, v63 offset:23296
v_mfma_f32_16x16x32_bf16 v[88:91], v[220:223], a[160:163], v[88:91]
v_cvt_pk_bf16_f32 v60, v104, v105
ds_write_b32 v184, v60 offset:26624
v_mfma_f32_16x16x32_bf16 v[92:95], v[220:223], a[232:235], v[92:95]
v_cvt_pk_bf16_f32 v61, v106, v107
s_waitcnt lgkmcnt(13)
ds_write_b32 v185, v61 offset:26624
v_mfma_f32_16x16x32_bf16 v[252:255], v[220:223], v[128:131], v[252:255]
v_cvt_pk_bf16_f32 v62, v108, v109
s_waitcnt vmcnt(27)
v_mfma_f32_16x16x32_bf16 v[80:83], v[224:227], a[20:23], v[80:83]
buffer_load_dwordx4 v[220:223], v59, s[44:47], s68 offen offset:3072 sc1
v_mfma_f32_16x16x32_bf16 v[84:87], v[224:227], a[92:95], v[84:87]
ds_write_b32 v184, v62 offset:29952
v_mfma_f32_16x16x32_bf16 v[88:91], v[224:227], a[164:167], v[88:91]
v_cvt_pk_bf16_f32 v63, v110, v111
s_waitcnt lgkmcnt(13)
ds_write_b32 v185, v63 offset:29952
v_mfma_f32_16x16x32_bf16 v[92:95], v[224:227], a[236:239], v[92:95]
buffer_load_dwordx4 v59, s[44:47], s69 offen offset:3072 sc1 lds
s_add_u32 s69, s69, 4096
s_add_u32 m0, s75, 16384
s_nop 0
buffer_load_dwordx4 v59, s[44:47], s69 offen offset:0 sc1 lds
v_mfma_f32_16x16x32_bf16 v[252:255], v[224:227], v[132:135], v[252:255]
buffer_load_dwordx4 v59, s[44:47], s69 offen offset:1024 sc1 lds
s_waitcnt vmcnt(29)
v_mfma_f32_16x16x32_bf16 v[80:83], v[228:231], a[24:27], v[80:83]
s_add_u32 s68, s68, 4096
buffer_load_dwordx4 v[224:227], v59, s[44:47], s68 offen offset:0 sc1
v_mfma_f32_16x16x32_bf16 v[84:87], v[228:231], a[96:99], v[84:87]
buffer_load_dwordx4 v59, s[44:47], s69 offen offset:2048 sc1 lds
v_mfma_f32_16x16x32_bf16 v[88:91], v[228:231], a[168:171], v[88:91]
v_mfma_f32_16x16x32_bf16 v[92:95], v[228:231], a[240:243], v[92:95]
v_mfma_f32_16x16x32_bf16 v[252:255], v[228:231], v[136:139], v[252:255]
s_waitcnt vmcnt(29)
v_mfma_f32_16x16x32_bf16 v[80:83], v[232:235], a[28:31], v[80:83]
buffer_load_dwordx4 v[228:231], v59, s[44:47], s68 offen offset:1024 sc1
v_mfma_f32_16x16x32_bf16 v[84:87], v[232:235], a[100:103], v[84:87]
buffer_load_dwordx4 v59, s[44:47], s69 offen offset:3072 sc1 lds
v_mfma_f32_16x16x32_bf16 v[88:91], v[232:235], a[172:175], v[88:91]
v_mfma_f32_16x16x32_bf16 v[92:95], v[232:235], a[244:247], v[92:95]
v_mfma_f32_16x16x32_bf16 v[252:255], v[232:235], v[140:143], v[252:255]
s_waitcnt vmcnt(29)
v_mfma_f32_16x16x32_bf16 v[80:83], v[236:239], a[32:35], v[80:83]
buffer_load_dwordx4 v[232:235], v59, s[44:47], s68 offen offset:2048 sc1
v_mfma_f32_16x16x32_bf16 v[84:87], v[236:239], a[104:107], v[84:87]
s_add_u32 s69, s67, 1777664
s_cmp_eq_u32 s50, 0
s_cselect_b32 s69, s69, 1073741824
s_mov_b32 m0, 82944
s_cselect_b32 m0, 81920, m0
s_nop 0
buffer_load_dwordx4 v59, s[44:47], s69 offen offset:0 sc1 lds
v_mfma_f32_16x16x32_bf16 v[88:91], v[236:239], a[176:179], v[88:91]
v_mfma_f32_16x16x32_bf16 v[92:95], v[236:239], a[248:251], v[92:95]
v_mfma_f32_16x16x32_bf16 v[252:255], v[236:239], v[144:147], v[252:255]
s_waitcnt vmcnt(29)
v_mfma_f32_16x16x32_bf16 v[80:83], v[240:243], a[36:39], v[80:83]
buffer_load_dwordx4 v[236:239], v59, s[44:47], s68 offen offset:3072 sc1
v_mfma_f32_16x16x32_bf16 v[84:87], v[240:243], a[108:111], v[84:87]
v_mfma_f32_16x16x32_bf16 v[88:91], v[240:243], a[180:183], v[88:91]
v_mfma_f32_16x16x32_bf16 v[92:95], v[240:243], a[252:255], v[92:95]
v_mfma_f32_16x16x32_bf16 v[252:255], v[240:243], v[148:151], v[252:255]
s_waitcnt vmcnt(28)
v_mfma_f32_16x16x32_bf16 v[80:83], v[244:247], a[40:43], v[80:83]
s_add_u32 s68, s68, 4096
buffer_load_dwordx4 v[240:243], v59, s[44:47], s68 offen offset:0 sc1
v_mfma_f32_16x16x32_bf16 v[84:87], v[244:247], a[112:115], v[84:87]
v_mfma_f32_16x16x32_bf16 v[88:91], v[244:247], a[184:187], v[88:91]
v_mfma_f32_16x16x32_bf16 v[92:95], v[244:247], v[8:11], v[92:95]
v_mfma_f32_16x16x32_bf16 v[252:255], v[244:247], v[152:155], v[252:255]
s_waitcnt vmcnt(27)
v_mfma_f32_16x16x32_bf16 v[80:83], v[248:251], a[44:47], v[80:83]
buffer_load_dwordx4 v[244:247], v59, s[44:47], s68 offen offset:1024 sc1
v_mfma_f32_16x16x32_bf16 v[84:87], v[248:251], a[116:119], v[84:87]
v_mfma_f32_16x16x32_bf16 v[88:91], v[248:251], a[188:191], v[88:91]
v_mfma_f32_16x16x32_bf16 v[92:95], v[248:251], v[12:15], v[92:95]
v_mfma_f32_16x16x32_bf16 v[252:255], v[248:251], v[156:159], v[252:255]
s_waitcnt vmcnt(26)
v_mfma_f32_16x16x32_bf16 v[80:83], v[188:191], a[48:51], v[80:83]
buffer_load_dwordx4 v[248:251], v59, s[44:47], s68 offen offset:2048 sc1
v_mfma_f32_16x16x32_bf16 v[84:87], v[188:191], a[120:123], v[84:87]
v_and_b32 v1, 31, v0
v_lshrrev_b32 v2, 3, v1
v_bfe_u32 v3, v1, 1, 1
v_lshlrev_b32 v3, 1, v3
v_cmp_eq_u32 vcc, v2, v3
s_nop 1
v_cndmask_b32 v2, 1, v2, vcc
s_add_u32 s52, s48, 31
v_add_u32 v2, s52, v2
v_and_b32 v2, 31, v2
v_and_b32 v1, 7, v1
v_lshl_add_u32 v1, v2, 3, v1
v_lshlrev_b32 v1, 2, v1
v_add_u32 v76, 37953536, v1
buffer_load_dword v77, v76, s[44:47], 0 offen sc0 sc1
v_mfma_f32_16x16x32_bf16 v[88:91], v[188:191], a[192:195], v[88:91]
v_mfma_f32_16x16x32_bf16 v[92:95], v[188:191], v[16:19], v[92:95]
v_mfma_f32_16x16x32_bf16 v[252:255], v[188:191], v[160:163], v[252:255]
s_waitcnt vmcnt(26)
v_mfma_f32_16x16x32_bf16 v[80:83], v[192:195], a[52:55], v[80:83]
buffer_load_dwordx4 v[188:191], v59, s[44:47], s68 offen offset:3072 sc1
v_mfma_f32_16x16x32_bf16 v[84:87], v[192:195], a[124:127], v[84:87]
v_mfma_f32_16x16x32_bf16 v[88:91], v[192:195], a[196:199], v[88:91]
v_mfma_f32_16x16x32_bf16 v[92:95], v[192:195], v[20:23], v[92:95]
v_mfma_f32_16x16x32_bf16 v[252:255], v[192:195], v[164:167], v[252:255]
s_waitcnt vmcnt(25)
v_mfma_f32_16x16x32_bf16 v[80:83], v[196:199], a[56:59], v[80:83]
s_add_u32 s68, s68, 4096
buffer_load_dwordx4 v[192:195], v59, s[44:47], s68 offen offset:0 sc1
v_mfma_f32_16x16x32_bf16 v[84:87], v[196:199], a[128:131], v[84:87]
v_mfma_f32_16x16x32_bf16 v[88:91], v[196:199], a[200:203], v[88:91]
v_mfma_f32_16x16x32_bf16 v[92:95], v[196:199], v[24:27], v[92:95]
v_mfma_f32_16x16x32_bf16 v[252:255], v[196:199], v[168:171], v[252:255]
s_waitcnt vmcnt(24)
v_mfma_f32_16x16x32_bf16 v[80:83], v[200:203], a[60:63], v[80:83]
buffer_load_dwordx4 v[196:199], v59, s[44:47], s68 offen offset:1024 sc1
v_mfma_f32_16x16x32_bf16 v[84:87], v[200:203], a[132:135], v[84:87]
v_mfma_f32_16x16x32_bf16 v[88:91], v[200:203], a[204:207], v[88:91]
v_mfma_f32_16x16x32_bf16 v[92:95], v[200:203], v[28:31], v[92:95]
v_mfma_f32_16x16x32_bf16 v[252:255], v[200:203], v[172:175], v[252:255]
s_waitcnt vmcnt(23)
v_mfma_f32_16x16x32_bf16 v[80:83], v[204:207], a[64:67], v[80:83]
buffer_load_dwordx4 v[200:203], v59, s[44:47], s68 offen offset:2048 sc1
v_mfma_f32_16x16x32_bf16 v[84:87], v[204:207], a[136:139], v[84:87]
v_mfma_f32_16x16x32_bf16 v[88:91], v[204:207], a[208:211], v[88:91]
v_mfma_f32_16x16x32_bf16 v[92:95], v[204:207], v[32:35], v[92:95]
v_mfma_f32_16x16x32_bf16 v[252:255], v[204:207], v[176:179], v[252:255]
s_waitcnt vmcnt(4)
v_cmp_ne_u32 vcc, s51, v77
s_nop 3
s_cbranch_vccz L_fl_ok_13
s_mov_b32 s58, 100000
L_fl_poll_14:
buffer_load_dword v77, v76, s[44:47], 0 offen sc0 sc1
s_waitcnt vmcnt(0)
v_cmp_ne_u32 vcc, s51, v77
s_sub_u32 s58, s58, 1
s_cmp_eq_u32 s58, 0
s_cbranch_scc1 L_fl_ok_13
s_nop 1
s_cbranch_vccnz L_fl_poll_14
L_fl_ok_13:
s_mul_i32 s69, s63, 18432
s_add_u32 s69, s69, 0
v_mfma_f32_16x16x32_bf16 v[80:83], v[208:211], a[68:71], v[80:83]
buffer_load_dwordx4 v[204:207], v59, s[44:47], s68 offen offset:3072 sc1
v_mfma_f32_16x16x32_bf16 v[84:87], v[208:211], a[140:143], v[84:87]
buffer_load_dwordx4 v[112:115], v59, s[44:47], s69 offen offset:0 sc0 sc1
v_mfma_f32_16x16x32_bf16 v[88:91], v[208:211], a[212:215], v[88:91]
v_mfma_f32_16x16x32_bf16 v[92:95], v[208:211], v[36:39], v[92:95]
v_mfma_f32_16x16x32_bf16 v[252:255], v[208:211], v[180:183], v[252:255]
v_mfma_f32_16x16x32_bf16 v[96:99], v[212:215], a[0:3], 0
s_add_u32 s68, s68, 4096
buffer_load_dwordx4 v[208:211], v59, s[44:47], s68 offen offset:0 sc1
v_mfma_f32_16x16x32_bf16 v[100:103], v[212:215], a[72:75], 0
buffer_load_dwordx4 v[116:119], v59, s[44:47], s69 offen offset:1024 sc0 sc1
v_mfma_f32_16x16x32_bf16 v[104:107], v[212:215], a[144:147], 0
v_mfma_f32_16x16x32_bf16 v[108:111], v[212:215], a[216:219], 0
v_mfma_f32_16x16x32_bf16 v[96:99], v[216:219], a[4:7], v[96:99]
buffer_load_dwordx4 v[212:215], v59, s[44:47], s68 offen offset:1024 sc1
v_mfma_f32_16x16x32_bf16 v[100:103], v[216:219], a[76:79], v[100:103]
buffer_load_dwordx4 v[120:123], v59, s[44:47], s69 offen offset:2048 sc0 sc1
v_mfma_f32_16x16x32_bf16 v[104:107], v[216:219], a[148:151], v[104:107]
v_mfma_f32_16x16x32_bf16 v[108:111], v[216:219], a[220:223], v[108:111]
v_mfma_f32_16x16x32_bf16 v[96:99], v[220:223], a[8:11], v[96:99]
buffer_load_dwordx4 v[216:219], v59, s[44:47], s68 offen offset:2048 sc1
v_mfma_f32_16x16x32_bf16 v[100:103], v[220:223], a[80:83], v[100:103]
v_cvt_pk_bf16_f32 v62, v252, v253
v_mfma_f32_16x16x32_bf16 v[104:107], v[220:223], a[152:155], v[104:107]
ds_write_b32 v6, v62 offset:0
v_cvt_pk_bf16_f32 v63, v254, v255
v_mfma_f32_16x16x32_bf16 v[108:111], v[220:223], a[224:227], v[108:111]
s_waitcnt lgkmcnt(13)
ds_write_b32 v7, v63 offset:0
v_cvt_pk_bf16_f32 v60, v80, v81
v_mfma_f32_16x16x32_bf16 v[96:99], v[224:227], a[12:15], v[96:99]
v_mfma_f32_16x16x32_bf16 v[100:103], v[224:227], a[84:87], v[100:103]
ds_write_b32 v186, v60 offset:3328
v_mfma_f32_16x16x32_bf16 v[104:107], v[224:227], a[156:159], v[104:107]
v_cvt_pk_bf16_f32 v61, v82, v83
s_waitcnt lgkmcnt(13)
ds_write_b32 v187, v61 offset:3328
v_mfma_f32_16x16x32_bf16 v[108:111], v[224:227], a[228:231], v[108:111]
v_cvt_pk_bf16_f32 v62, v84, v85
ds_write_b32 v186, v62 offset:6656
v_mfma_f32_16x16x32_bf16 v[96:99], v[228:231], a[16:19], v[96:99]
v_mfma_f32_16x16x32_bf16 v[100:103], v[228:231], a[88:91], v[100:103]
v_cvt_pk_bf16_f32 v63, v86, v87
v_mfma_f32_16x16x32_bf16 v[104:107], v[228:231], a[160:163], v[104:107]
s_waitcnt lgkmcnt(13)
ds_write_b32 v187, v63 offset:6656
v_cvt_pk_bf16_f32 v60, v88, v89
v_mfma_f32_16x16x32_bf16 v[108:111], v[228:231], a[232:235], v[108:111]
ds_write_b32 v186, v60 offset:9984
v_cvt_pk_bf16_f32 v61, v90, v91
v_mfma_f32_16x16x32_bf16 v[96:99], v[232:235], a[20:23], v[96:99]
v_mfma_f32_16x16x32_bf16 v[100:103], v[232:235], a[92:95], v[100:103]
s_waitcnt lgkmcnt(13)
ds_write_b32 v187, v61 offset:9984
v_mfma_f32_16x16x32_bf16 v[104:107], v[232:235], a[164:167], v[104:107]
v_cvt_pk_bf16_f32 v62, v92, v93
ds_write_b32 v186, v62 offset:13312
v_mfma_f32_16x16x32_bf16 v[108:111], v[232:235], a[236:239], v[108:111]
v_cvt_pk_bf16_f32 v63, v94, v95
s_waitcnt lgkmcnt(13)
ds_write_b32 v187, v63 offset:13312
v_mfma_f32_16x16x32_bf16 v[96:99], v[236:239], a[24:27], v[96:99]
v_mfma_f32_16x16x32_bf16 v[100:103], v[236:239], a[96:99], v[100:103]
buffer_load_dwordx4 v[124:127], v59, s[44:47], s69 offen offset:3072 sc0 sc1
v_mfma_f32_16x16x32_bf16 v[104:107], v[236:239], a[168:171], v[104:107]
s_add_u32 s69, s69, 4096
buffer_load_dwordx4 v[128:131], v59, s[44:47], s69 offen offset:0 sc0 sc1
buffer_load_dwordx4 v[132:135], v59, s[44:47], s69 offen offset:1024 sc0 sc1
v_mfma_f32_16x16x32_bf16 v[108:111], v[236:239], a[240:243], v[108:111]
buffer_load_dwordx4 v[136:139], v59, s[44:47], s69 offen offset:2048 sc0 sc1
buffer_load_dwordx4 v[140:143], v59, s[44:47], s69 offen offset:3072 sc0 sc1
v_mfma_f32_16x16x32_bf16 v[96:99], v[240:243], a[28:31], v[96:99]
v_mfma_f32_16x16x32_bf16 v[100:103], v[240:243], a[100:103], v[100:103]
s_add_u32 s69, s69, 4096
buffer_load_dwordx4 v[144:147], v59, s[44:47], s69 offen offset:0 sc0 sc1
v_mfma_f32_16x16x32_bf16 v[104:107], v[240:243], a[172:175], v[104:107]
v_mfma_f32_16x16x32_bf16 v[108:111], v[240:243], a[244:247], v[108:111]
v_mfma_f32_16x16x32_bf16 v[96:99], v[244:247], a[32:35], v[96:99]
v_mfma_f32_16x16x32_bf16 v[100:103], v[244:247], a[104:107], v[100:103]
buffer_load_dwordx4 v[148:151], v59, s[44:47], s69 offen offset:1024 sc0 sc1
v_mfma_f32_16x16x32_bf16 v[104:107], v[244:247], a[176:179], v[104:107]
v_mfma_f32_16x16x32_bf16 v[108:111], v[244:247], a[248:251], v[108:111]
v_mfma_f32_16x16x32_bf16 v[96:99], v[248:251], a[36:39], v[96:99]
v_mfma_f32_16x16x32_bf16 v[100:103], v[248:251], a[108:111], v[100:103]
buffer_load_dwordx4 v[152:155], v59, s[44:47], s69 offen offset:2048 sc0 sc1
v_mfma_f32_16x16x32_bf16 v[104:107], v[248:251], a[180:183], v[104:107]
v_mfma_f32_16x16x32_bf16 v[108:111], v[248:251], a[252:255], v[108:111]
s_waitcnt vmcnt(18)
v_mfma_f32_16x16x32_bf16 v[96:99], v[188:191], a[40:43], v[96:99]
v_mfma_f32_16x16x32_bf16 v[100:103], v[188:191], a[112:115], v[100:103]
buffer_load_dwordx4 v[156:159], v59, s[44:47], s69 offen offset:3072 sc0 sc1
v_mfma_f32_16x16x32_bf16 v[104:107], v[188:191], a[184:187], v[104:107]
v_mfma_f32_16x16x32_bf16 v[108:111], v[188:191], v[8:11], v[108:111]
s_waitcnt vmcnt(18)
v_mfma_f32_16x16x32_bf16 v[96:99], v[192:195], a[44:47], v[96:99]
v_mfma_f32_16x16x32_bf16 v[100:103], v[192:195], a[116:119], v[100:103]
s_add_u32 s69, s69, 4096
buffer_load_dwordx4 v[160:163], v59, s[44:47], s69 offen offset:0 sc0 sc1
v_mfma_f32_16x16x32_bf16 v[104:107], v[192:195], a[188:191], v[104:107]
v_mfma_f32_16x16x32_bf16 v[108:111], v[192:195], v[12:15], v[108:111]
s_waitcnt vmcnt(18)
v_mfma_f32_16x16x32_bf16 v[96:99], v[196:199], a[48:51], v[96:99]
v_mfma_f32_16x16x32_bf16 v[100:103], v[196:199], a[120:123], v[100:103]
buffer_load_dwordx4 v[164:167], v59, s[44:47], s69 offen offset:1024 sc0 sc1
v_mfma_f32_16x16x32_bf16 v[104:107], v[196:199], a[192:195], v[104:107]
v_mfma_f32_16x16x32_bf16 v[108:111], v[196:199], v[16:19], v[108:111]
s_waitcnt vmcnt(18)
v_mfma_f32_16x16x32_bf16 v[96:99], v[200:203], a[52:55], v[96:99]
v_mfma_f32_16x16x32_bf16 v[100:103], v[200:203], a[124:127], v[100:103]
buffer_load_dwordx4 v[168:171], v59, s[44:47], s69 offen offset:2048 sc0 sc1
v_mfma_f32_16x16x32_bf16 v[104:107], v[200:203], a[196:199], v[104:107]
v_mfma_f32_16x16x32_bf16 v[108:111], v[200:203], v[20:23], v[108:111]
s_waitcnt vmcnt(18)
v_mfma_f32_16x16x32_bf16 v[96:99], v[204:207], a[56:59], v[96:99]
v_mfma_f32_16x16x32_bf16 v[100:103], v[204:207], a[128:131], v[100:103]
buffer_load_dwordx4 v[172:175], v59, s[44:47], s69 offen offset:3072 sc0 sc1
v_mfma_f32_16x16x32_bf16 v[104:107], v[204:207], a[200:203], v[104:107]
v_mfma_f32_16x16x32_bf16 v[108:111], v[204:207], v[24:27], v[108:111]
s_waitcnt vmcnt(17)
v_mfma_f32_16x16x32_bf16 v[96:99], v[208:211], a[60:63], v[96:99]
v_mfma_f32_16x16x32_bf16 v[100:103], v[208:211], a[132:135], v[100:103]
s_add_u32 s69, s69, 4096
buffer_load_dwordx4 v[176:179], v59, s[44:47], s69 offen offset:0 sc0 sc1
v_mfma_f32_16x16x32_bf16 v[104:107], v[208:211], a[204:207], v[104:107]
v_mfma_f32_16x16x32_bf16 v[108:111], v[208:211], v[28:31], v[108:111]
s_waitcnt vmcnt(16)
v_mfma_f32_16x16x32_bf16 v[96:99], v[212:215], a[64:67], v[96:99]
v_mfma_f32_16x16x32_bf16 v[100:103], v[212:215], a[136:139], v[100:103]
buffer_load_dwordx4 v[180:183], v59, s[44:47], s69 offen offset:1024 sc0 sc1
v_mfma_f32_16x16x32_bf16 v[104:107], v[212:215], a[208:211], v[104:107]
v_mfma_f32_16x16x32_bf16 v[108:111], v[212:215], v[32:35], v[108:111]
s_waitcnt vmcnt(15)
v_mfma_f32_16x16x32_bf16 v[96:99], v[216:219], a[68:71], v[96:99]
v_mfma_f32_16x16x32_bf16 v[100:103], v[216:219], a[140:143], v[100:103]
v_mfma_f32_16x16x32_bf16 v[104:107], v[216:219], a[212:215], v[104:107]
v_mfma_f32_16x16x32_bf16 v[108:111], v[216:219], v[36:39], v[108:111]
s_nop 4
v_cvt_pk_bf16_f32 v60, v96, v97
ds_write_b32 v184, v60 offset:33280
v_cvt_pk_bf16_f32 v61, v98, v99
s_waitcnt lgkmcnt(13)
ds_write_b32 v185, v61 offset:33280
v_cvt_pk_bf16_f32 v62, v100, v101
ds_write_b32 v184, v62 offset:36608
v_cvt_pk_bf16_f32 v63, v102, v103
s_waitcnt lgkmcnt(13)
ds_write_b32 v185, v63 offset:36608
v_cvt_pk_bf16_f32 v60, v104, v105
ds_write_b32 v184, v60 offset:39936
v_cvt_pk_bf16_f32 v61, v106, v107
s_waitcnt lgkmcnt(13)
ds_write_b32 v185, v61 offset:39936
v_cvt_pk_bf16_f32 v62, v108, v109
ds_write_b32 v184, v62 offset:43264
v_cvt_pk_bf16_f32 v63, v110, v111
s_waitcnt lgkmcnt(13)
ds_write_b32 v185, v63 offset:43264
s_mov_b32 s52, s63
s_mul_i32 s71, s52, 3641
s_lshr_b32 s71, s71, 16
s_mul_i32 s53, s71, 18
s_sub_u32 s72, s52, s53
s_mul_i32 s55, s49, 18
s_add_u32 s55, s55, s72
s_mul_i32 s55, s55, 36864
s_lshl_b32 s54, s71, 7
s_add_u32 s55, s55, s54
v_and_b32 v1, 31, v0
v_mul_u32_u24 v1, 1152, v1
v_add_u32 v2, s55, v1
s_add_u32 s52, s63, 34
s_cmp_ge_u32 s63, 94
s_cselect_b32 s70, 0, 2
s_cmp_lt_u32 s63, 67
s_cselect_b32 s70, 3, s70
s_mul_i32 s71, s52, 3641
s_lshr_b32 s71, s71, 16
s_mul_i32 s53, s71, 18
s_sub_u32 s72, s52, s53
s_sub_u32 s52, s63, 67
s_and_b32 s52, s52, 31
s_mul_i32 s53, s52, 21846
s_lshr_b32 s53, s53, 16
s_mul_i32 s54, s53, 3
s_sub_u32 s54, s52, s54
s_cmp_ge_u32 s70, 2
s_cselect_b32 s71, s53, s71
s_cselect_b32 s72, s54, s72
s_mul_i32 s55, s49, 18
s_add_u32 s55, s55, s72
s_mul_i32 s55, s55, 36864
s_lshl_b32 s54, s71, 7
s_add_u32 s55, s55, s54
s_cmp_eq_u32 s70, 0
s_cselect_b32 s55, s55, 1073741824
v_add_u32 v1, s55, v1
v_cmp_gt_u32 vcc, 32, v0
s_nop 1
v_cndmask_b32 v1, v1, v2, vcc
buffer_load_dword v78, v1, s[28:31], 0 offen
s_waitcnt lgkmcnt(0)
s_barrier
v_add_u32 v60, 41472, v59
v_lshrrev_b32 v1, 4, v0
v_and_b32 v2, 7, v0
v_lshl_add_u32 v1, v1, 3, v2
v_lshlrev_b32 v1, 4, v1
v_add_u32 v61, 4096, v1
v_add_u32 v62, 45568, v1
ds_read_b128 v[188:191], v59 offset:0
ds_read_b128 v[192:195], v59 offset:1024
ds_read_b128 v[196:199], v59 offset:2048
ds_read_b128 v[200:203], v59 offset:3072
ds_read_b128 v[204:207], v61 offset:0
ds_read_b128 v[208:211], v59 offset:4608
ds_read_b128 v[212:215], v59 offset:5632
ds_read_b128 v[216:219], v59 offset:6656
ds_read_b128 v[220:223], v59 offset:7680
s_waitcnt lgkmcnt(8)
v_mfma_f32_16x16x32_bf16 v[80:83], v[188:191], v[112:115], 0
ds_read_b128 v[224:227], v61 offset:4608
s_waitcnt lgkmcnt(8)
v_mfma_f32_16x16x32_bf16 v[84:87], v[192:195], v[112:115], 0
ds_read_b128 v[228:231], v59 offset:9216
s_waitcnt lgkmcnt(8)
v_mfma_f32_16x16x32_bf16 v[88:91], v[196:199], v[112:115], 0
ds_read_b128 v[232:235], v59 offset:10240
s_waitcnt lgkmcnt(8)
v_mfma_f32_16x16x32_bf16 v[92:95], v[200:203], v[112:115], 0
ds_read_b128 v[236:239], v59 offset:11264
s_waitcnt lgkmcnt(8)
v_mfma_f32_16x16x32_bf16 v[96:99], v[204:207], v[112:115], 0
ds_read_b128 v[240:243], v59 offset:12288
s_waitcnt lgkmcnt(8)
v_mfma_f32_16x16x32_bf16 v[80:83], v[208:211], v[116:119], v[80:83]
ds_read_b128 v[188:191], v61 offset:9216
s_waitcnt lgkmcnt(8)
v_mfma_f32_16x16x32_bf16 v[84:87], v[212:215], v[116:119], v[84:87]
ds_read_b128 v[192:195], v59 offset:13824
s_waitcnt lgkmcnt(8)
v_mfma_f32_16x16x32_bf16 v[88:91], v[216:219], v[116:119], v[88:91]
ds_read_b128 v[196:199], v59 offset:14848
s_waitcnt lgkmcnt(8)
v_mfma_f32_16x16x32_bf16 v[92:95], v[220:223], v[116:119], v[92:95]
ds_read_b128 v[200:203], v59 offset:15872
s_waitcnt lgkmcnt(8)
v_mfma_f32_16x16x32_bf16 v[96:99], v[224:227], v[116:119], v[96:99]
ds_read_b128 v[204:207], v59 offset:16896
s_waitcnt lgkmcnt(8)
v_mfma_f32_16x16x32_bf16 v[80:83], v[228:231], v[120:123], v[80:83]
ds_read_b128 v[208:211], v61 offset:13824
s_waitcnt lgkmcnt(8)
v_mfma_f32_16x16x32_bf16 v[84:87], v[232:235], v[120:123], v[84:87]
ds_read_b128 v[212:215], v59 offset:18432
s_waitcnt lgkmcnt(8)
v_mfma_f32_16x16x32_bf16 v[88:91], v[236:239], v[120:123], v[88:91]
ds_read_b128 v[216:219], v59 offset:19456
s_waitcnt lgkmcnt(8)
v_mfma_f32_16x16x32_bf16 v[92:95], v[240:243], v[120:123], v[92:95]
ds_read_b128 v[220:223], v59 offset:20480
s_waitcnt lgkmcnt(8)
v_mfma_f32_16x16x32_bf16 v[96:99], v[188:191], v[120:123], v[96:99]
ds_read_b128 v[224:227], v59 offset:21504
s_waitcnt vmcnt(15) lgkmcnt(8)
v_mfma_f32_16x16x32_bf16 v[80:83], v[192:195], v[124:127], v[80:83]
ds_read_b128 v[228:231], v61 offset:18432
s_waitcnt lgkmcnt(8)
v_mfma_f32_16x16x32_bf16 v[84:87], v[196:199], v[124:127], v[84:87]
ds_read_b128 v[232:235], v59 offset:23040
s_waitcnt lgkmcnt(8)
v_mfma_f32_16x16x32_bf16 v[88:91], v[200:203], v[124:127], v[88:91]
ds_read_b128 v[236:239], v59 offset:24064
s_waitcnt lgkmcnt(8)
v_mfma_f32_16x16x32_bf16 v[92:95], v[204:207], v[124:127], v[92:95]
ds_read_b128 v[240:243], v59 offset:25088
s_waitcnt lgkmcnt(8)
v_mfma_f32_16x16x32_bf16 v[96:99], v[208:211], v[124:127], v[96:99]
ds_read_b128 v[188:191], v59 offset:26112
s_waitcnt vmcnt(14) lgkmcnt(8)
v_mfma_f32_16x16x32_bf16 v[80:83], v[212:215], v[128:131], v[80:83]
ds_read_b128 v[192:195], v61 offset:23040
s_waitcnt lgkmcnt(8)
v_mfma_f32_16x16x32_bf16 v[84:87], v[216:219], v[128:131], v[84:87]
ds_read_b128 v[196:199], v59 offset:27648
s_waitcnt lgkmcnt(8)
v_mfma_f32_16x16x32_bf16 v[88:91], v[220:223], v[128:131], v[88:91]
ds_read_b128 v[200:203], v59 offset:28672
s_waitcnt lgkmcnt(8)
v_mfma_f32_16x16x32_bf16 v[92:95], v[224:227], v[128:131], v[92:95]
ds_read_b128 v[204:207], v59 offset:29696
s_waitcnt lgkmcnt(8)
v_mfma_f32_16x16x32_bf16 v[96:99], v[228:231], v[128:131], v[96:99]
ds_read_b128 v[208:211], v59 offset:30720
s_waitcnt vmcnt(13) lgkmcnt(8)
v_mfma_f32_16x16x32_bf16 v[80:83], v[232:235], v[132:135], v[80:83]
ds_read_b128 v[212:215], v61 offset:27648
s_waitcnt lgkmcnt(8)
v_mfma_f32_16x16x32_bf16 v[84:87], v[236:239], v[132:135], v[84:87]
ds_read_b128 v[216:219], v59 offset:32256
s_waitcnt lgkmcnt(8)
v_mfma_f32_16x16x32_bf16 v[88:91], v[240:243], v[132:135], v[88:91]
ds_read_b128 v[220:223], v59 offset:33280
s_waitcnt lgkmcnt(8)
v_mfma_f32_16x16x32_bf16 v[92:95], v[188:191], v[132:135], v[92:95]
ds_read_b128 v[224:227], v59 offset:34304
s_waitcnt lgkmcnt(8)
v_mfma_f32_16x16x32_bf16 v[96:99], v[192:195], v[132:135], v[96:99]
ds_read_b128 v[228:231], v59 offset:35328
s_waitcnt vmcnt(12) lgkmcnt(8)
v_mfma_f32_16x16x32_bf16 v[80:83], v[196:199], v[136:139], v[80:83]
ds_read_b128 v[232:235], v61 offset:32256
s_waitcnt lgkmcnt(8)
v_mfma_f32_16x16x32_bf16 v[84:87], v[200:203], v[136:139], v[84:87]
ds_read_b128 v[236:239], v59 offset:36864
s_waitcnt lgkmcnt(8)
v_mfma_f32_16x16x32_bf16 v[88:91], v[204:207], v[136:139], v[88:91]
ds_read_b128 v[240:243], v59 offset:37888
s_waitcnt lgkmcnt(8)
v_mfma_f32_16x16x32_bf16 v[92:95], v[208:211], v[136:139], v[92:95]
ds_read_b128 v[188:191], v59 offset:38912
s_waitcnt lgkmcnt(8)
v_mfma_f32_16x16x32_bf16 v[96:99], v[212:215], v[136:139], v[96:99]
ds_read_b128 v[192:195], v59 offset:39936
s_waitcnt vmcnt(11) lgkmcnt(8)
v_mfma_f32_16x16x32_bf16 v[80:83], v[216:219], v[140:143], v[80:83]
ds_read_b128 v[196:199], v61 offset:36864
s_waitcnt lgkmcnt(8)
v_mfma_f32_16x16x32_bf16 v[84:87], v[220:223], v[140:143], v[84:87]
ds_read_b128 v[200:203], v60 offset:0
s_waitcnt lgkmcnt(8)
v_mfma_f32_16x16x32_bf16 v[88:91], v[224:227], v[140:143], v[88:91]
ds_read_b128 v[204:207], v60 offset:1024
s_waitcnt lgkmcnt(8)
v_mfma_f32_16x16x32_bf16 v[92:95], v[228:231], v[140:143], v[92:95]
ds_read_b128 v[208:211], v60 offset:2048
s_waitcnt lgkmcnt(8)
v_mfma_f32_16x16x32_bf16 v[96:99], v[232:235], v[140:143], v[96:99]
ds_read_b128 v[212:215], v60 offset:3072
s_waitcnt vmcnt(10) lgkmcnt(8)
v_mfma_f32_16x16x32_bf16 v[80:83], v[236:239], v[144:147], v[80:83]
ds_read_b128 v[216:219], v62 offset:0
s_waitcnt lgkmcnt(8)
v_mfma_f32_16x16x32_bf16 v[84:87], v[240:243], v[144:147], v[84:87]
ds_read_b128 v[220:223], v60 offset:4608
s_waitcnt lgkmcnt(8)
v_mfma_f32_16x16x32_bf16 v[88:91], v[188:191], v[144:147], v[88:91]
ds_read_b128 v[224:227], v60 offset:5632
s_waitcnt lgkmcnt(8)
v_mfma_f32_16x16x32_bf16 v[92:95], v[192:195], v[144:147], v[92:95]
ds_read_b128 v[228:231], v60 offset:6656
s_waitcnt lgkmcnt(8)
v_mfma_f32_16x16x32_bf16 v[96:99], v[196:199], v[144:147], v[96:99]
ds_read_b128 v[232:235], v60 offset:7680
s_waitcnt vmcnt(9) lgkmcnt(8)
v_mfma_f32_16x16x32_bf16 v[80:83], v[200:203], v[148:151], v[80:83]
ds_read_b128 v[236:239], v62 offset:4608
s_waitcnt lgkmcnt(8)
v_mfma_f32_16x16x32_bf16 v[84:87], v[204:207], v[148:151], v[84:87]
ds_read_b128 v[240:243], v60 offset:9216
s_waitcnt lgkmcnt(8)
v_mfma_f32_16x16x32_bf16 v[88:91], v[208:211], v[148:151], v[88:91]
ds_read_b128 v[188:191], v60 offset:10240
s_waitcnt lgkmcnt(8)
v_mfma_f32_16x16x32_bf16 v[92:95], v[212:215], v[148:151], v[92:95]
ds_read_b128 v[192:195], v60 offset:11264
s_waitcnt lgkmcnt(8)
v_mfma_f32_16x16x32_bf16 v[96:99], v[216:219], v[148:151], v[96:99]
ds_read_b128 v[196:199], v60 offset:12288
s_waitcnt vmcnt(8) lgkmcnt(8)
v_mfma_f32_16x16x32_bf16 v[80:83], v[220:223], v[152:155], v[80:83]
ds_read_b128 v[200:203], v62 offset:9216
s_waitcnt lgkmcnt(8)
v_mfma_f32_16x16x32_bf16 v[84:87], v[224:227], v[152:155], v[84:87]
ds_read_b128 v[204:207], v60 offset:13824
s_waitcnt lgkmcnt(8)
v_mfma_f32_16x16x32_bf16 v[88:91], v[228:231], v[152:155], v[88:91]
ds_read_b128 v[208:211], v60 offset:14848
s_waitcnt lgkmcnt(8)
v_mfma_f32_16x16x32_bf16 v[92:95], v[232:235], v[152:155], v[92:95]
ds_read_b128 v[212:215], v60 offset:15872
s_waitcnt lgkmcnt(8)
v_mfma_f32_16x16x32_bf16 v[96:99], v[236:239], v[152:155], v[96:99]
ds_read_b128 v[216:219], v60 offset:16896
s_waitcnt vmcnt(7) lgkmcnt(8)
v_mfma_f32_16x16x32_bf16 v[80:83], v[240:243], v[156:159], v[80:83]
ds_read_b128 v[220:223], v62 offset:13824
s_waitcnt lgkmcnt(8)
v_mfma_f32_16x16x32_bf16 v[84:87], v[188:191], v[156:159], v[84:87]
ds_read_b128 v[224:227], v60 offset:18432
s_waitcnt lgkmcnt(8)
v_mfma_f32_16x16x32_bf16 v[88:91], v[192:195], v[156:159], v[88:91]
ds_read_b128 v[228:231], v60 offset:19456
s_waitcnt lgkmcnt(8)
v_mfma_f32_16x16x32_bf16 v[92:95], v[196:199], v[156:159], v[92:95]
ds_read_b128 v[232:235], v60 offset:20480
s_waitcnt lgkmcnt(8)
v_mfma_f32_16x16x32_bf16 v[96:99], v[200:203], v[156:159], v[96:99]
ds_read_b128 v[236:239], v60 offset:21504
s_waitcnt vmcnt(6) lgkmcnt(8)
v_mfma_f32_16x16x32_bf16 v[80:83], v[204:207], v[160:163], v[80:83]
ds_read_b128 v[240:243], v62 offset:18432
s_waitcnt lgkmcnt(8)
v_mfma_f32_16x16x32_bf16 v[84:87], v[208:211], v[160:163], v[84:87]
ds_read_b128 v[188:191], v60 offset:23040
s_waitcnt lgkmcnt(8)
v_mfma_f32_16x16x32_bf16 v[88:91], v[212:215], v[160:163], v[88:91]
ds_read_b128 v[192:195], v60 offset:24064
s_waitcnt lgkmcnt(8)
v_mfma_f32_16x16x32_bf16 v[92:95], v[216:219], v[160:163], v[92:95]
ds_read_b128 v[196:199], v60 offset:25088
s_waitcnt lgkmcnt(8)
v_mfma_f32_16x16x32_bf16 v[96:99], v[220:223], v[160:163], v[96:99]
ds_read_b128 v[200:203], v60 offset:26112
s_waitcnt vmcnt(5) lgkmcnt(8)
v_mfma_f32_16x16x32_bf16 v[80:83], v[224:227], v[164:167], v[80:83]
ds_read_b128 v[204:207], v62 offset:23040
s_waitcnt lgkmcnt(8)
v_mfma_f32_16x16x32_bf16 v[84:87], v[228:231], v[164:167], v[84:87]
ds_read_b128 v[208:211], v60 offset:27648
s_waitcnt lgkmcnt(8)
v_mfma_f32_16x16x32_bf16 v[88:91], v[232:235], v[164:167], v[88:91]
ds_read_b128 v[212:215], v60 offset:28672
s_waitcnt lgkmcnt(8)
v_mfma_f32_16x16x32_bf16 v[92:95], v[236:239], v[164:167], v[92:95]
ds_read_b128 v[216:219], v60 offset:29696
s_waitcnt lgkmcnt(8)
v_mfma_f32_16x16x32_bf16 v[96:99], v[240:243], v[164:167], v[96:99]
ds_read_b128 v[220:223], v60 offset:30720
s_waitcnt vmcnt(4) lgkmcnt(8)
v_mfma_f32_16x16x32_bf16 v[80:83], v[188:191], v[168:171], v[80:83]
ds_read_b128 v[224:227], v62 offset:27648
s_waitcnt lgkmcnt(8)
v_mfma_f32_16x16x32_bf16 v[84:87], v[192:195], v[168:171], v[84:87]
ds_read_b128 v[228:231], v60 offset:32256
s_waitcnt lgkmcnt(8)
v_mfma_f32_16x16x32_bf16 v[88:91], v[196:199], v[168:171], v[88:91]
ds_read_b128 v[232:235], v60 offset:33280
s_waitcnt lgkmcnt(8)
v_mfma_f32_16x16x32_bf16 v[92:95], v[200:203], v[168:171], v[92:95]
ds_read_b128 v[236:239], v60 offset:34304
s_waitcnt lgkmcnt(8)
v_mfma_f32_16x16x32_bf16 v[96:99], v[204:207], v[168:171], v[96:99]
ds_read_b128 v[240:243], v60 offset:35328
s_waitcnt vmcnt(3) lgkmcnt(8)
v_mfma_f32_16x16x32_bf16 v[80:83], v[208:211], v[172:175], v[80:83]
ds_read_b128 v[188:191], v62 offset:32256
s_waitcnt lgkmcnt(8)
v_mfma_f32_16x16x32_bf16 v[84:87], v[212:215], v[172:175], v[84:87]
ds_read_b128 v[192:195], v60 offset:36864
s_waitcnt lgkmcnt(8)
v_mfma_f32_16x16x32_bf16 v[88:91], v[216:219], v[172:175], v[88:91]
ds_read_b128 v[196:199], v60 offset:37888
s_waitcnt lgkmcnt(8)
v_mfma_f32_16x16x32_bf16 v[92:95], v[220:223], v[172:175], v[92:95]
ds_read_b128 v[200:203], v60 offset:38912
s_waitcnt lgkmcnt(8)
v_mfma_f32_16x16x32_bf16 v[96:99], v[224:227], v[172:175], v[96:99]
ds_read_b128 v[204:207], v60 offset:39936
s_waitcnt vmcnt(2) lgkmcnt(8)
v_mfma_f32_16x16x32_bf16 v[80:83], v[228:231], v[176:179], v[80:83]
ds_read_b128 v[208:211], v62 offset:36864
s_waitcnt lgkmcnt(8)
v_mfma_f32_16x16x32_bf16 v[84:87], v[232:235], v[176:179], v[84:87]
s_waitcnt lgkmcnt(7)
v_mfma_f32_16x16x32_bf16 v[88:91], v[236:239], v[176:179], v[88:91]
s_waitcnt lgkmcnt(6)
v_mfma_f32_16x16x32_bf16 v[92:95], v[240:243], v[176:179], v[92:95]
s_waitcnt lgkmcnt(5)
v_mfma_f32_16x16x32_bf16 v[96:99], v[188:191], v[176:179], v[96:99]
s_waitcnt vmcnt(1) lgkmcnt(4)
v_mfma_f32_16x16x32_bf16 v[80:83], v[192:195], v[180:183], v[80:83]
s_waitcnt lgkmcnt(3)
v_mfma_f32_16x16x32_bf16 v[84:87], v[196:199], v[180:183], v[84:87]
s_waitcnt lgkmcnt(2)
v_mfma_f32_16x16x32_bf16 v[88:91], v[200:203], v[180:183], v[88:91]
s_waitcnt lgkmcnt(1)
v_mfma_f32_16x16x32_bf16 v[92:95], v[204:207], v[180:183], v[92:95]
s_waitcnt lgkmcnt(0)
v_mfma_f32_16x16x32_bf16 v[96:99], v[208:211], v[180:183], v[96:99]
v_lshlrev_b32 v112, 16, v40
v_and_b32 v113, s62, v40
v_lshlrev_b32 v114, 16, v41
v_and_b32 v115, s62, v41
v_lshlrev_b32 v116, 16, v42
v_and_b32 v117, s62, v42
v_lshlrev_b32 v118, 16, v43
v_and_b32 v119, s62, v43
v_lshlrev_b32 v120, 16, v44
v_and_b32 v121, s62, v44
v_lshlrev_b32 v122, 16, v45
v_and_b32 v123, s62, v45
v_lshlrev_b32 v124, 16, v46
v_and_b32 v125, s62, v46
v_lshlrev_b32 v126, 16, v47
v_and_b32 v127, s62, v47
v_lshlrev_b32 v128, 16, v48
v_and_b32 v129, s62, v48
v_lshlrev_b32 v130, 16, v49
v_and_b32 v131, s62, v49
v_permlane16_swap_b32 v80, v84
v_permlane16_swap_b32 v81, v85
v_permlane16_swap_b32 v82, v86
v_permlane16_swap_b32 v83, v87
v_permlane16_swap_b32 v88, v92
v_permlane16_swap_b32 v89, v93
v_permlane16_swap_b32 v90, v94
v_permlane16_swap_b32 v91, v95
v_add_f32 v80, v80, v112
v_add_f32 v81, v81, v113
v_add_f32 v82, v82, v114
v_add_f32 v83, v83, v115
v_add_f32 v84, v84, v116
v_add_f32 v85, v85, v117
v_add_f32 v86, v86, v118
v_add_f32 v87, v87, v119
v_add_f32 v88, v88, v120
v_add_f32 v89, v89, v121
v_add_f32 v90, v90, v122
v_add_f32 v91, v91, v123
v_add_f32 v92, v92, v124
v_add_f32 v93, v93, v125
v_add_f32 v94, v94, v126
v_add_f32 v95, v95, v127
v_add_f32 v96, v96, v128
v_add_f32 v97, v97, v129
v_add_f32 v98, v98, v130
v_add_f32 v99, v99, v131
v_cvt_pk_bf16_f32 v132, v80, v81
v_cvt_pk_bf16_f32 v133, v82, v83
v_cvt_pk_bf16_f32 v134, v84, v85
v_cvt_pk_bf16_f32 v135, v86, v87
v_cvt_pk_bf16_f32 v136, v88, v89
v_cvt_pk_bf16_f32 v137, v90, v91
v_cvt_pk_bf16_f32 v138, v92, v93
v_cvt_pk_bf16_f32 v139, v94, v95
v_cvt_pk_bf16_f32 v140, v96, v97
v_cvt_pk_bf16_f32 v141, v98, v99
v_add_u32 v1, v50, v53
v_add_u32 v2, v51, v53
v_add_u32 v3, v52, v53
buffer_store_dwordx4 v[132:135], v1, s[44:47], 0 offen sc0 sc1
buffer_store_dwordx4 v[136:139], v2, s[44:47], 0 offen sc0 sc1
buffer_store_dwordx2 v[140:141], v3, s[44:47], 0 offen sc0 sc1
v_pk_add_f32 v[74:75], v[80:81], v[82:83]
v_pk_mul_f32 v[66:67], v[80:81], v[80:81]
v_pk_fma_f32 v[66:67], v[82:83], v[82:83], v[66:67]
v_cmp_gt_u32 vcc, 32, v0
s_nop 1
v_cndmask_b32 v96, 0, v96, vcc
v_cndmask_b32 v97, 0, v97, vcc
v_cndmask_b32 v98, 0, v98, vcc
v_cndmask_b32 v99, 0, v99, vcc
v_pk_add_f32 v[74:75], v[74:75], v[84:85]
v_pk_fma_f32 v[66:67], v[84:85], v[84:85], v[66:67]
v_pk_add_f32 v[74:75], v[74:75], v[86:87]
v_pk_fma_f32 v[66:67], v[86:87], v[86:87], v[66:67]
v_pk_add_f32 v[74:75], v[74:75], v[88:89]
v_pk_fma_f32 v[66:67], v[88:89], v[88:89], v[66:67]
v_pk_add_f32 v[74:75], v[74:75], v[90:91]
v_pk_fma_f32 v[66:67], v[90:91], v[90:91], v[66:67]
v_pk_add_f32 v[74:75], v[74:75], v[92:93]
v_pk_fma_f32 v[66:67], v[92:93], v[92:93], v[66:67]
v_pk_add_f32 v[74:75], v[74:75], v[94:95]
v_pk_fma_f32 v[66:67], v[94:95], v[94:95], v[66:67]
v_pk_add_f32 v[74:75], v[74:75], v[96:97]
v_pk_fma_f32 v[66:67], v[96:97], v[96:97], v[66:67]
v_pk_add_f32 v[74:75], v[74:75], v[98:99]
v_pk_fma_f32 v[66:67], v[98:99], v[98:99], v[66:67]
v_add_f32 v74, v74, v75
v_add_f32 v75, v66, v67
v_mov_b32 v66, v74
v_mov_b32 v67, v75
s_nop 0
v_permlane16_swap_b32 v74, v66
v_permlane16_swap_b32 v75, v67
v_add_f32 v74, v74, v66
v_add_f32 v75, v75, v67
v_mov_b32 v66, v74
v_mov_b32 v67, v75
s_nop 0
v_permlane32_swap_b32 v74, v66
v_permlane32_swap_b32 v75, v67
v_add_f32 v74, v74, v66
v_add_f32 v75, v75, v67
s_lshl_b32 s52, s49, 7
s_add_u32 s52, s52, 37956608
v_and_b32 v1, 31, v0
v_lshl_add_u32 v76, v1, 2, s52
buffer_load_dword v77, v76, s[44:47], 0 offen sc0 sc1
s_mul_i32 s52, s50, 48
s_add_u32 s52, s52, 86016
v_mul_u32_u24 v60, 208, v0
v_add_u32 v60, s52, v60
ds_read_b128 v[8:11], v60 offset:33280
ds_read_b128 v[12:15], v60 offset:33296
ds_read_b128 v[16:19], v60 offset:33312
ds_read_b128 v[20:23], v60 offset:3328
ds_read_b128 v[24:27], v60 offset:3344
ds_read_b128 v[28:31], v60 offset:3360
ds_read_b128 v[80:83], v60 offset:2912
ds_read_b128 v[84:87], v60 offset:2928
ds_read_b128 v[88:91], v60 offset:2944
ds_read_b128 v[92:95], v60 offset:2496
ds_read_b128 v[96:99], v60 offset:2512
ds_read_b128 v[100:103], v60 offset:2528
s_lshl_b32 s52, s48, 6
v_add_u32 v61, s52, v0
v_lshlrev_b32 v62, 2, v0
v_add_u32 v62, 159744, v62
ds_read_b32 v63, v62
v_mov_b32 v64, 0xff61b1e6
s_waitcnt lgkmcnt(7)
v_dot2_f32_bf16 v32, v8, v20, 0
v_dot2_f32_bf16 v32, v9, v21, v32
v_dot2_f32_bf16 v32, v10, v22, v32
v_dot2_f32_bf16 v32, v11, v23, v32
v_dot2_f32_bf16 v32, v12, v24, v32
v_dot2_f32_bf16 v32, v13, v25, v32
v_dot2_f32_bf16 v32, v14, v26, v32
v_dot2_f32_bf16 v32, v15, v27, v32
v_dot2_f32_bf16 v32, v16, v28, v32
ds_read_b128 v[20:23], v60 offset:2080
ds_read_b128 v[24:27], v60 offset:2096
ds_read_b128 v[28:31], v60 offset:2112
s_waitcnt lgkmcnt(7)
v_dot2_f32_bf16 v33, v8, v80, 0
v_dot2_f32_bf16 v33, v9, v81, v33
v_dot2_f32_bf16 v33, v10, v82, v33
v_dot2_f32_bf16 v33, v11, v83, v33
v_dot2_f32_bf16 v33, v12, v84, v33
v_dot2_f32_bf16 v33, v13, v85, v33
v_dot2_f32_bf16 v33, v14, v86, v33
v_dot2_f32_bf16 v33, v15, v87, v33
v_dot2_f32_bf16 v33, v16, v88, v33
ds_read_b128 v[80:83], v60 offset:1664
ds_read_b128 v[84:87], v60 offset:1680
ds_read_b128 v[88:91], v60 offset:1696
s_waitcnt lgkmcnt(7)
v_dot2_f32_bf16 v34, v8, v92, 0
v_dot2_f32_bf16 v34, v9, v93, v34
v_dot2_f32_bf16 v34, v10, v94, v34
v_dot2_f32_bf16 v34, v11, v95, v34
v_dot2_f32_bf16 v34, v12, v96, v34
v_dot2_f32_bf16 v34, v13, v97, v34
v_dot2_f32_bf16 v34, v14, v98, v34
v_dot2_f32_bf16 v34, v15, v99, v34
v_dot2_f32_bf16 v34, v16, v100, v34
ds_read_b128 v[92:95], v60 offset:1248
ds_read_b128 v[96:99], v60 offset:1264
ds_read_b128 v[100:103], v60 offset:1280
s_waitcnt lgkmcnt(6)
v_dot2_f32_bf16 v35, v8, v20, 0
v_dot2_f32_bf16 v35, v9, v21, v35
v_dot2_f32_bf16 v35, v10, v22, v35
v_dot2_f32_bf16 v35, v11, v23, v35
v_dot2_f32_bf16 v35, v12, v24, v35
v_dot2_f32_bf16 v35, v13, v25, v35
v_dot2_f32_bf16 v35, v14, v26, v35
v_dot2_f32_bf16 v35, v15, v27, v35
v_dot2_f32_bf16 v35, v16, v28, v35
ds_read_b128 v[20:23], v60 offset:832
ds_read_b128 v[24:27], v60 offset:848
ds_read_b128 v[28:31], v60 offset:864
s_waitcnt lgkmcnt(6)
v_dot2_f32_bf16 v36, v8, v80, 0
v_dot2_f32_bf16 v36, v9, v81, v36
v_dot2_f32_bf16 v36, v10, v82, v36
v_dot2_f32_bf16 v36, v11, v83, v36
v_dot2_f32_bf16 v36, v12, v84, v36
v_dot2_f32_bf16 v36, v13, v85, v36
v_dot2_f32_bf16 v36, v14, v86, v36
v_dot2_f32_bf16 v36, v15, v87, v36
v_dot2_f32_bf16 v36, v16, v88, v36
ds_read_b128 v[80:83], v60 offset:416
ds_read_b128 v[84:87], v60 offset:432
ds_read_b128 v[88:91], v60 offset:448
s_waitcnt lgkmcnt(6)
v_dot2_f32_bf16 v37, v8, v92, 0
v_dot2_f32_bf16 v37, v9, v93, v37
v_dot2_f32_bf16 v37, v10, v94, v37
v_dot2_f32_bf16 v37, v11, v95, v37
v_dot2_f32_bf16 v37, v12, v96, v37
v_dot2_f32_bf16 v37, v13, v97, v37
v_dot2_f32_bf16 v37, v14, v98, v37
v_dot2_f32_bf16 v37, v15, v99, v37
v_dot2_f32_bf16 v37, v16, v100, v37
ds_read_b128 v[92:95], v60 offset:19968
ds_read_b128 v[96:99], v60 offset:19984
ds_read_b128 v[100:103], v60 offset:20000
s_waitcnt lgkmcnt(6)
v_dot2_f32_bf16 v38, v8, v20, 0
v_dot2_f32_bf16 v38, v9, v21, v38
v_dot2_f32_bf16 v38, v10, v22, v38
v_dot2_f32_bf16 v38, v11, v23, v38
v_dot2_f32_bf16 v38, v12, v24, v38
v_dot2_f32_bf16 v38, v13, v25, v38
v_dot2_f32_bf16 v38, v14, v26, v38
v_dot2_f32_bf16 v38, v15, v27, v38
v_dot2_f32_bf16 v38, v16, v28, v38
ds_read_b128 v[20:23], v60 offset:19552
ds_read_b128 v[24:27], v60 offset:19568
ds_read_b128 v[28:31], v60 offset:19584
s_waitcnt lgkmcnt(6)
v_dot2_f32_bf16 v39, v8, v80, 0
v_dot2_f32_bf16 v39, v9, v81, v39
v_dot2_f32_bf16 v39, v10, v82, v39
v_dot2_f32_bf16 v39, v11, v83, v39
v_dot2_f32_bf16 v39, v12, v84, v39
v_dot2_f32_bf16 v39, v13, v85, v39
v_dot2_f32_bf16 v39, v14, v86, v39
v_dot2_f32_bf16 v39, v15, v87, v39
v_dot2_f32_bf16 v39, v16, v88, v39
ds_read_b128 v[80:83], v60 offset:19136
ds_read_b128 v[84:87], v60 offset:19152
ds_read_b128 v[88:91], v60 offset:19168
s_waitcnt vmcnt(1)
s_lshl_b32 s52, s63, 3
s_add_u32 s52, s52, s49
s_lshl_b32 s52, s52, 7
s_add_u32 s52, s52, 23592960
v_lshlrev_b32 v1, 3, v0
s_mov_b64 exec, 0xffff
buffer_store_dwordx2 v[74:75], v1, s[44:47], s52 offen sc0 sc1
s_mov_b64 exec, -1
v_cmp_gt_i32 vcc, 2, v61
s_nop 1
v_cndmask_b32 v33, v33, v64, vcc
v_cmp_gt_i32 vcc, 4, v61
s_nop 1
v_cndmask_b32 v34, v34, v64, vcc
v_cmp_gt_i32 vcc, 6, v61
s_nop 1
v_cndmask_b32 v35, v35, v64, vcc
v_cmp_gt_i32 vcc, 8, v61
s_nop 1
v_cndmask_b32 v36, v36, v64, vcc
v_cmp_gt_i32 vcc, 10, v61
s_nop 1
v_cndmask_b32 v37, v37, v64, vcc
v_cmp_gt_i32 vcc, 12, v61
s_nop 1
v_cndmask_b32 v38, v38, v64, vcc
v_cmp_gt_i32 vcc, 14, v61
s_nop 1
v_cndmask_b32 v39, v39, v64, vcc
v_max3_f32 v65, v32, v33, v34
v_max3_f32 v65, v65, v35, v36
v_max3_f32 v65, v65, v37, v38
v_max_f32 v65, v65, v39
s_mov_b32 s52, 0x3eae1a93
v_sub_f32 v32, v32, v65
v_sub_f32 v33, v33, v65
v_sub_f32 v34, v34, v65
v_sub_f32 v35, v35, v65
v_sub_f32 v36, v36, v65
v_sub_f32 v37, v37, v65
v_sub_f32 v38, v38, v65
v_sub_f32 v39, v39, v65
v_mul_f32 v32, s52, v32
v_mul_f32 v33, s52, v33
v_mul_f32 v34, s52, v34
v_mul_f32 v35, s52, v35
v_mul_f32 v36, s52, v36
v_mul_f32 v37, s52, v37
v_mul_f32 v38, s52, v38
v_mul_f32 v39, s52, v39
v_exp_f32 v32, v32
v_exp_f32 v33, v33
v_exp_f32 v34, v34
v_exp_f32 v35, v35
v_exp_f32 v36, v36
v_exp_f32 v37, v37
v_exp_f32 v38, v38
v_exp_f32 v39, v39
v_add_f32 v66, v32, v33
v_add_f32 v66, v66, v34
v_add_f32 v66, v66, v35
v_add_f32 v66, v66, v36
v_add_f32 v66, v66, v37
v_add_f32 v66, v66, v38
v_add_f32 v66, v66, v39
v_add_f32 v67, 1.0, v63
v_mul_f32 v66, v66, v67
v_rcp_f32 v66, v66
s_nop 0
v_mul_f32 v66, v66, v63
s_waitcnt lgkmcnt(6)
v_lshlrev_b32 v188, 16, v92
v_and_b32 v189, s62, v92
v_lshlrev_b32 v190, 16, v93
v_and_b32 v191, s62, v93
v_lshlrev_b32 v192, 16, v94
v_and_b32 v193, s62, v94
v_lshlrev_b32 v194, 16, v95
v_and_b32 v195, s62, v95
v_lshlrev_b32 v196, 16, v96
v_and_b32 v197, s62, v96
v_lshlrev_b32 v198, 16, v97
v_and_b32 v199, s62, v97
v_lshlrev_b32 v200, 16, v98
v_and_b32 v201, s62, v98
v_lshlrev_b32 v202, 16, v99
v_and_b32 v203, s62, v99
v_lshlrev_b32 v204, 16, v100
v_and_b32 v205, s62, v100
ds_read_b128 v[92:95], v60 offset:18720
ds_read_b128 v[96:99], v60 offset:18736
ds_read_b128 v[100:103], v60 offset:18752
v_pk_mul_f32 v[40:41], v[188:189], v[32:33] op_sel:[0,0] op_sel_hi:[1,0]
v_pk_mul_f32 v[42:43], v[190:191], v[32:33] op_sel:[0,0] op_sel_hi:[1,0]
v_pk_mul_f32 v[44:45], v[192:193], v[32:33] op_sel:[0,0] op_sel_hi:[1,0]
v_pk_mul_f32 v[46:47], v[194:195], v[32:33] op_sel:[0,0] op_sel_hi:[1,0]
v_pk_mul_f32 v[48:49], v[196:197], v[32:33] op_sel:[0,0] op_sel_hi:[1,0]
v_pk_mul_f32 v[50:51], v[198:199], v[32:33] op_sel:[0,0] op_sel_hi:[1,0]
v_pk_mul_f32 v[52:53], v[200:201], v[32:33] op_sel:[0,0] op_sel_hi:[1,0]
v_pk_mul_f32 v[54:55], v[202:203], v[32:33] op_sel:[0,0] op_sel_hi:[1,0]
v_pk_mul_f32 v[56:57], v[204:205], v[32:33] op_sel:[0,0] op_sel_hi:[1,0]
s_waitcnt lgkmcnt(6)
v_lshlrev_b32 v188, 16, v20
v_and_b32 v189, s62, v20
v_lshlrev_b32 v190, 16, v21
v_and_b32 v191, s62, v21
v_lshlrev_b32 v192, 16, v22
v_and_b32 v193, s62, v22
v_lshlrev_b32 v194, 16, v23
v_and_b32 v195, s62, v23
v_lshlrev_b32 v196, 16, v24
v_and_b32 v197, s62, v24
v_lshlrev_b32 v198, 16, v25
v_and_b32 v199, s62, v25
v_lshlrev_b32 v200, 16, v26
v_and_b32 v201, s62, v26
v_lshlrev_b32 v202, 16, v27
v_and_b32 v203, s62, v27
v_lshlrev_b32 v204, 16, v28
v_and_b32 v205, s62, v28
ds_read_b128 v[20:23], v60 offset:18304
ds_read_b128 v[24:27], v60 offset:18320
ds_read_b128 v[28:31], v60 offset:18336
v_pk_fma_f32 v[40:41], v[188:189], v[32:33], v[40:41] op_sel:[0,1,0] op_sel_hi:[1,1,1]
v_pk_fma_f32 v[42:43], v[190:191], v[32:33], v[42:43] op_sel:[0,1,0] op_sel_hi:[1,1,1]
v_pk_fma_f32 v[44:45], v[192:193], v[32:33], v[44:45] op_sel:[0,1,0] op_sel_hi:[1,1,1]
v_pk_fma_f32 v[46:47], v[194:195], v[32:33], v[46:47] op_sel:[0,1,0] op_sel_hi:[1,1,1]
v_pk_fma_f32 v[48:49], v[196:197], v[32:33], v[48:49] op_sel:[0,1,0] op_sel_hi:[1,1,1]
v_pk_fma_f32 v[50:51], v[198:199], v[32:33], v[50:51] op_sel:[0,1,0] op_sel_hi:[1,1,1]
v_pk_fma_f32 v[52:53], v[200:201], v[32:33], v[52:53] op_sel:[0,1,0] op_sel_hi:[1,1,1]
v_pk_fma_f32 v[54:55], v[202:203], v[32:33], v[54:55] op_sel:[0,1,0] op_sel_hi:[1,1,1]
v_pk_fma_f32 v[56:57], v[204:205], v[32:33], v[56:57] op_sel:[0,1,0] op_sel_hi:[1,1,1]
s_waitcnt lgkmcnt(6)
v_lshlrev_b32 v188, 16, v80
v_and_b32 v189, s62, v80
v_lshlrev_b32 v190, 16, v81
v_and_b32 v191, s62, v81
v_lshlrev_b32 v192, 16, v82
v_and_b32 v193, s62, v82
v_lshlrev_b32 v194, 16, v83
v_and_b32 v195, s62, v83
v_lshlrev_b32 v196, 16, v84
v_and_b32 v197, s62, v84
v_lshlrev_b32 v198, 16, v85
v_and_b32 v199, s62, v85
v_lshlrev_b32 v200, 16, v86
v_and_b32 v201, s62, v86
v_lshlrev_b32 v202, 16, v87
v_and_b32 v203, s62, v87
v_lshlrev_b32 v204, 16, v88
v_and_b32 v205, s62, v88
ds_read_b128 v[80:83], v60 offset:17888
ds_read_b128 v[84:87], v60 offset:17904
ds_read_b128 v[88:91], v60 offset:17920
v_pk_fma_f32 v[40:41], v[188:189], v[34:35], v[40:41] op_sel:[0,0,0] op_sel_hi:[1,0,1]
v_pk_fma_f32 v[42:43], v[190:191], v[34:35], v[42:43] op_sel:[0,0,0] op_sel_hi:[1,0,1]
v_pk_fma_f32 v[44:45], v[192:193], v[34:35], v[44:45] op_sel:[0,0,0] op_sel_hi:[1,0,1]
v_pk_fma_f32 v[46:47], v[194:195], v[34:35], v[46:47] op_sel:[0,0,0] op_sel_hi:[1,0,1]
v_pk_fma_f32 v[48:49], v[196:197], v[34:35], v[48:49] op_sel:[0,0,0] op_sel_hi:[1,0,1]
v_pk_fma_f32 v[50:51], v[198:199], v[34:35], v[50:51] op_sel:[0,0,0] op_sel_hi:[1,0,1]
v_pk_fma_f32 v[52:53], v[200:201], v[34:35], v[52:53] op_sel:[0,0,0] op_sel_hi:[1,0,1]
v_pk_fma_f32 v[54:55], v[202:203], v[34:35], v[54:55] op_sel:[0,0,0] op_sel_hi:[1,0,1]
v_pk_fma_f32 v[56:57], v[204:205], v[34:35], v[56:57] op_sel:[0,0,0] op_sel_hi:[1,0,1]
s_waitcnt vmcnt(1)
v_cmp_ne_u32 vcc, s51, v77
s_nop 3
s_cbranch_vccz L_fl_ok_15
s_mov_b32 s58, 100000
L_fl_poll_16:
buffer_load_dword v77, v76, s[44:47], 0 offen sc0 sc1
s_waitcnt vmcnt(0)
v_cmp_ne_u32 vcc, s51, v77
s_sub_u32 s58, s58, 1
s_cmp_eq_u32 s58, 0
s_cbranch_scc1 L_fl_ok_15
s_nop 1
s_cbranch_vccnz L_fl_poll_16
L_fl_ok_15:
s_waitcnt lgkmcnt(6)
v_lshlrev_b32 v188, 16, v92
v_and_b32 v189, s62, v92
v_lshlrev_b32 v190, 16, v93
v_and_b32 v191, s62, v93
v_lshlrev_b32 v192, 16, v94
v_and_b32 v193, s62, v94
v_lshlrev_b32 v194, 16, v95
v_and_b32 v195, s62, v95
v_lshlrev_b32 v196, 16, v96
v_and_b32 v197, s62, v96
v_lshlrev_b32 v198, 16, v97
v_and_b32 v199, s62, v97
v_lshlrev_b32 v200, 16, v98
v_and_b32 v201, s62, v98
v_lshlrev_b32 v202, 16, v99
v_and_b32 v203, s62, v99
v_lshlrev_b32 v204, 16, v100
v_and_b32 v205, s62, v100
ds_read_b128 v[92:95], v60 offset:17472
ds_read_b128 v[96:99], v60 offset:17488
ds_read_b128 v[100:103], v60 offset:17504
v_pk_fma_f32 v[40:41], v[188:189], v[34:35], v[40:41] op_sel:[0,1,0] op_sel_hi:[1,1,1]
v_pk_fma_f32 v[42:43], v[190:191], v[34:35], v[42:43] op_sel:[0,1,0] op_sel_hi:[1,1,1]
v_pk_fma_f32 v[44:45], v[192:193], v[34:35], v[44:45] op_sel:[0,1,0] op_sel_hi:[1,1,1]
v_pk_fma_f32 v[46:47], v[194:195], v[34:35], v[46:47] op_sel:[0,1,0] op_sel_hi:[1,1,1]
v_pk_fma_f32 v[48:49], v[196:197], v[34:35], v[48:49] op_sel:[0,1,0] op_sel_hi:[1,1,1]
v_pk_fma_f32 v[50:51], v[198:199], v[34:35], v[50:51] op_sel:[0,1,0] op_sel_hi:[1,1,1]
v_pk_fma_f32 v[52:53], v[200:201], v[34:35], v[52:53] op_sel:[0,1,0] op_sel_hi:[1,1,1]
v_pk_fma_f32 v[54:55], v[202:203], v[34:35], v[54:55] op_sel:[0,1,0] op_sel_hi:[1,1,1]
v_pk_fma_f32 v[56:57], v[204:205], v[34:35], v[56:57] op_sel:[0,1,0] op_sel_hi:[1,1,1]
s_waitcnt lgkmcnt(6)
v_lshlrev_b32 v188, 16, v20
v_and_b32 v189, s62, v20
v_lshlrev_b32 v190, 16, v21
v_and_b32 v191, s62, v21
v_lshlrev_b32 v192, 16, v22
v_and_b32 v193, s62, v22
v_lshlrev_b32 v194, 16, v23
v_and_b32 v195, s62, v23
v_lshlrev_b32 v196, 16, v24
v_and_b32 v197, s62, v24
v_lshlrev_b32 v198, 16, v25
v_and_b32 v199, s62, v25
v_lshlrev_b32 v200, 16, v26
v_and_b32 v201, s62, v26
v_lshlrev_b32 v202, 16, v27
v_and_b32 v203, s62, v27
v_lshlrev_b32 v204, 16, v28
v_and_b32 v205, s62, v28
ds_read_b128 v[20:23], v60 offset:17056
ds_read_b128 v[24:27], v60 offset:17072
ds_read_b128 v[28:31], v60 offset:17088
v_pk_fma_f32 v[40:41], v[188:189], v[36:37], v[40:41] op_sel:[0,0,0] op_sel_hi:[1,0,1]
v_pk_fma_f32 v[42:43], v[190:191], v[36:37], v[42:43] op_sel:[0,0,0] op_sel_hi:[1,0,1]
v_pk_fma_f32 v[44:45], v[192:193], v[36:37], v[44:45] op_sel:[0,0,0] op_sel_hi:[1,0,1]
v_pk_fma_f32 v[46:47], v[194:195], v[36:37], v[46:47] op_sel:[0,0,0] op_sel_hi:[1,0,1]
v_pk_fma_f32 v[48:49], v[196:197], v[36:37], v[48:49] op_sel:[0,0,0] op_sel_hi:[1,0,1]
v_pk_fma_f32 v[50:51], v[198:199], v[36:37], v[50:51] op_sel:[0,0,0] op_sel_hi:[1,0,1]
v_pk_fma_f32 v[52:53], v[200:201], v[36:37], v[52:53] op_sel:[0,0,0] op_sel_hi:[1,0,1]
v_pk_fma_f32 v[54:55], v[202:203], v[36:37], v[54:55] op_sel:[0,0,0] op_sel_hi:[1,0,1]
v_pk_fma_f32 v[56:57], v[204:205], v[36:37], v[56:57] op_sel:[0,0,0] op_sel_hi:[1,0,1]
s_barrier
s_waitcnt lgkmcnt(6)
v_lshlrev_b32 v188, 16, v80
v_and_b32 v189, s62, v80
v_lshlrev_b32 v190, 16, v81
v_and_b32 v191, s62, v81
v_lshlrev_b32 v192, 16, v82
v_and_b32 v193, s62, v82
v_lshlrev_b32 v194, 16, v83
v_and_b32 v195, s62, v83
v_lshlrev_b32 v196, 16, v84
v_and_b32 v197, s62, v84
v_lshlrev_b32 v198, 16, v85
v_and_b32 v199, s62, v85
v_lshlrev_b32 v200, 16, v86
v_and_b32 v201, s62, v86
v_lshlrev_b32 v202, 16, v87
v_and_b32 v203, s62, v87
v_lshlrev_b32 v204, 16, v88
v_and_b32 v205, s62, v88
v_pk_fma_f32 v[40:41], v[188:189], v[36:37], v[40:41] op_sel:[0,1,0] op_sel_hi:[1,1,1]
v_pk_fma_f32 v[42:43], v[190:191], v[36:37], v[42:43] op_sel:[0,1,0] op_sel_hi:[1,1,1]
v_pk_fma_f32 v[44:45], v[192:193], v[36:37], v[44:45] op_sel:[0,1,0] op_sel_hi:[1,1,1]
v_pk_fma_f32 v[46:47], v[194:195], v[36:37], v[46:47] op_sel:[0,1,0] op_sel_hi:[1,1,1]
v_pk_fma_f32 v[48:49], v[196:197], v[36:37], v[48:49] op_sel:[0,1,0] op_sel_hi:[1,1,1]
v_pk_fma_f32 v[50:51], v[198:199], v[36:37], v[50:51] op_sel:[0,1,0] op_sel_hi:[1,1,1]
v_pk_fma_f32 v[52:53], v[200:201], v[36:37], v[52:53] op_sel:[0,1,0] op_sel_hi:[1,1,1]
v_pk_fma_f32 v[54:55], v[202:203], v[36:37], v[54:55] op_sel:[0,1,0] op_sel_hi:[1,1,1]
v_pk_fma_f32 v[56:57], v[204:205], v[36:37], v[56:57] op_sel:[0,1,0] op_sel_hi:[1,1,1]
s_waitcnt lgkmcnt(3)
v_lshlrev_b32 v188, 16, v92
v_and_b32 v189, s62, v92
v_lshlrev_b32 v190, 16, v93
v_and_b32 v191, s62, v93
v_lshlrev_b32 v192, 16, v94
v_and_b32 v193, s62, v94
v_lshlrev_b32 v194, 16, v95
v_and_b32 v195, s62, v95
v_lshlrev_b32 v196, 16, v96
v_and_b32 v197, s62, v96
v_lshlrev_b32 v198, 16, v97
v_and_b32 v199, s62, v97
v_lshlrev_b32 v200, 16, v98
v_and_b32 v201, s62, v98
v_lshlrev_b32 v202, 16, v99
v_and_b32 v203, s62, v99
v_lshlrev_b32 v204, 16, v100
v_and_b32 v205, s62, v100
v_pk_fma_f32 v[40:41], v[188:189], v[38:39], v[40:41] op_sel:[0,0,0] op_sel_hi:[1,0,1]
v_pk_fma_f32 v[42:43], v[190:191], v[38:39], v[42:43] op_sel:[0,0,0] op_sel_hi:[1,0,1]
v_pk_fma_f32 v[44:45], v[192:193], v[38:39], v[44:45] op_sel:[0,0,0] op_sel_hi:[1,0,1]
v_pk_fma_f32 v[46:47], v[194:195], v[38:39], v[46:47] op_sel:[0,0,0] op_sel_hi:[1,0,1]
v_pk_fma_f32 v[48:49], v[196:197], v[38:39], v[48:49] op_sel:[0,0,0] op_sel_hi:[1,0,1]
v_pk_fma_f32 v[50:51], v[198:199], v[38:39], v[50:51] op_sel:[0,0,0] op_sel_hi:[1,0,1]
v_pk_fma_f32 v[52:53], v[200:201], v[38:39], v[52:53] op_sel:[0,0,0] op_sel_hi:[1,0,1]
v_pk_fma_f32 v[54:55], v[202:203], v[38:39], v[54:55] op_sel:[0,0,0] op_sel_hi:[1,0,1]
v_pk_fma_f32 v[56:57], v[204:205], v[38:39], v[56:57] op_sel:[0,0,0] op_sel_hi:[1,0,1]
s_lshl_b32 s52, s63, 10
s_add_u32 s52, s52, 23592960
v_lshrrev_b32 v1, 4, v0
v_and_b32 v2, 15, v0
v_lshlrev_b32 v1, 8, v1
v_lshl_add_u32 v1, v2, 3, v1
v_add_u32 v107, s52, v1
buffer_load_dwordx2 v[108:109], v107, s[44:47], 0 offen sc0 sc1
buffer_load_dwordx2 v[110:111], v107, s[44:47], 0 offen offset:128 sc0 sc1
s_waitcnt lgkmcnt(0)
v_lshlrev_b32 v188, 16, v20
v_and_b32 v189, s62, v20
v_lshlrev_b32 v190, 16, v21
v_and_b32 v191, s62, v21
v_lshlrev_b32 v192, 16, v22
v_and_b32 v193, s62, v22
v_lshlrev_b32 v194, 16, v23
v_and_b32 v195, s62, v23
v_lshlrev_b32 v196, 16, v24
v_and_b32 v197, s62, v24
v_lshlrev_b32 v198, 16, v25
v_and_b32 v199, s62, v25
v_lshlrev_b32 v200, 16, v26
v_and_b32 v201, s62, v26
v_lshlrev_b32 v202, 16, v27
v_and_b32 v203, s62, v27
v_lshlrev_b32 v204, 16, v28
v_and_b32 v205, s62, v28
v_pk_fma_f32 v[40:41], v[188:189], v[38:39], v[40:41] op_sel:[0,1,0] op_sel_hi:[1,1,1]
v_pk_fma_f32 v[42:43], v[190:191], v[38:39], v[42:43] op_sel:[0,1,0] op_sel_hi:[1,1,1]
v_pk_fma_f32 v[44:45], v[192:193], v[38:39], v[44:45] op_sel:[0,1,0] op_sel_hi:[1,1,1]
v_pk_fma_f32 v[46:47], v[194:195], v[38:39], v[46:47] op_sel:[0,1,0] op_sel_hi:[1,1,1]
v_pk_fma_f32 v[48:49], v[196:197], v[38:39], v[48:49] op_sel:[0,1,0] op_sel_hi:[1,1,1]
v_pk_fma_f32 v[50:51], v[198:199], v[38:39], v[50:51] op_sel:[0,1,0] op_sel_hi:[1,1,1]
v_pk_fma_f32 v[52:53], v[200:201], v[38:39], v[52:53] op_sel:[0,1,0] op_sel_hi:[1,1,1]
v_pk_fma_f32 v[54:55], v[202:203], v[38:39], v[54:55] op_sel:[0,1,0] op_sel_hi:[1,1,1]
v_pk_fma_f32 v[56:57], v[204:205], v[38:39], v[56:57] op_sel:[0,1,0] op_sel_hi:[1,1,1]
v_mul_f32 v40, v40, v66
v_mul_f32 v41, v41, v66
v_mul_f32 v42, v42, v66
v_mul_f32 v43, v43, v66
v_mul_f32 v44, v44, v66
v_mul_f32 v45, v45, v66
v_mul_f32 v46, v46, v66
v_mul_f32 v47, v47, v66
v_mul_f32 v48, v48, v66
v_mul_f32 v49, v49, v66
v_mul_f32 v50, v50, v66
v_mul_f32 v51, v51, v66
v_mul_f32 v52, v52, v66
v_mul_f32 v53, v53, v66
v_mul_f32 v54, v54, v66
v_mul_f32 v55, v55, v66
v_mul_f32 v56, v56, v66
v_mul_f32 v57, v57, v66
v_cvt_pk_bf16_f32 v188, v40, v41
v_cvt_pk_bf16_f32 v189, v42, v43
v_cvt_pk_bf16_f32 v190, v44, v45
v_cvt_pk_bf16_f32 v191, v46, v47
v_cvt_pk_bf16_f32 v192, v48, v49
v_cvt_pk_bf16_f32 v193, v50, v51
v_cvt_pk_bf16_f32 v194, v52, v53
v_cvt_pk_bf16_f32 v195, v54, v55
v_cvt_pk_bf16_f32 v196, v56, v57
v_lshrrev_b32 v68, 4, v0
v_mul_u32_u24 v68, 3072, v68
v_and_b32 v69, 15, v0
v_lshl_add_u32 v68, v69, 4, v68
v_add_u32 v68, 73728, v68
s_lshr_b32 s52, s50, 1
s_and_b32 s53, s50, 1
s_lshl_b32 s54, s52, 10
s_lshl_b32 s55, s53, 3
s_add_u32 s54, s54, s55
v_add_u32 v69, s54, v68
s_lshl_b32 s54, s52, 8
s_lshl_b32 s55, s53, 2
s_add_u32 s54, s54, s55
v_add_u32 v70, s54, v68
ds_write_b64 v69, v[188:189] offset:0
ds_write_b64 v69, v[190:191] offset:256
ds_write_b64 v69, v[192:193] offset:512
ds_write_b64 v69, v[194:195] offset:768
ds_write_b32 v70, v196 offset:2048
s_mul_i32 s52, s50, 18432
s_add_u32 s52, s52, 86016
v_add_u32 v37, s52, v59
v_and_b32 v38, 15, v0
v_lshlrev_b32 v38, 2, v38
v_add_u32 v38, 159744, v38
s_lshl_b32 s52, s50, 6
s_add_u32 s52, s52, 1408
v_add_u32 v39, s52, v38
s_waitcnt lgkmcnt(0)
s_barrier
s_waitcnt vmcnt(0)
v_max3_u32 v1, v108, v109, v110
v_max_u32 v1, v1, v111
v_cmp_eq_u32 vcc, -1, v1
s_nop 3
s_cbranch_vccz L_st_ok_17
s_mov_b32 s58, 100000
L_st_poll_18:
buffer_load_dwordx2 v[108:109], v107, s[44:47], 0 offen sc0 sc1
buffer_load_dwordx2 v[110:111], v107, s[44:47], 0 offen offset:128 sc0 sc1
s_waitcnt vmcnt(0)
v_max3_u32 v1, v108, v109, v110
v_max_u32 v1, v1, v111
v_cmp_eq_u32 vcc, -1, v1
s_sub_u32 s58, s58, 1
s_cmp_eq_u32 s58, 0
s_cbranch_scc1 L_st_ok_17
s_nop 1
s_cbranch_vccnz L_st_poll_18
L_st_ok_17:
s_mul_i32 s69, s63, 18432
s_add_u32 s69, s69, 2359296
buffer_load_dwordx4 v[112:115], v59, s[44:47], s69 offen offset:0 sc0 sc1
buffer_load_dwordx4 v[116:119], v59, s[44:47], s69 offen offset:1024 sc0 sc1
buffer_load_dwordx4 v[120:123], v59, s[44:47], s69 offen offset:2048 sc0 sc1
buffer_load_dwordx4 v[124:127], v59, s[44:47], s69 offen offset:3072 sc0 sc1
s_add_u32 s69, s69, 4096
buffer_load_dwordx4 v[128:131], v59, s[44:47], s69 offen offset:0 sc0 sc1
buffer_load_dwordx4 v[132:135], v59, s[44:47], s69 offen offset:1024 sc0 sc1
buffer_load_dwordx4 v[136:139], v59, s[44:47], s69 offen offset:2048 sc0 sc1
buffer_load_dwordx4 v[140:143], v59, s[44:47], s69 offen offset:3072 sc0 sc1
s_add_u32 s69, s69, 4096
buffer_load_dwordx4 v[144:147], v59, s[44:47], s69 offen offset:0 sc0 sc1
buffer_load_dwordx4 v[148:151], v59, s[44:47], s69 offen offset:1024 sc0 sc1
buffer_load_dwordx4 v[152:155], v59, s[44:47], s69 offen offset:2048 sc0 sc1
buffer_load_dwordx4 v[156:159], v59, s[44:47], s69 offen offset:3072 sc0 sc1
s_mov_b32 s52, s63
s_mul_i32 s71, s52, 3641
s_lshr_b32 s71, s71, 16
s_mul_i32 s53, s71, 18
s_sub_u32 s72, s52, s53
s_lshl_b32 s55, s71, 7
v_lshrrev_b32 v2, 3, v0
v_and_b32 v3, 7, v0
s_mul_i32 s80, s49, 18
s_add_u32 s80, s80, s72
s_mul_i32 s80, s80, 36864
s_add_u32 s80, s80, s55
v_mul_u32_u24 v1, 1152, v2
v_bfe_u32 v4, v0, 4, 2
v_lshlrev_b32 v4, 1, v4
v_xor_b32 v3, v3, v4
v_lshl_add_u32 v70, v3, 4, v1
s_mul_i32 s84, s50, 18432
s_add_u32 s84, s84, 8192
s_mov_b32 s52, s63
s_mul_i32 s71, s52, 3641
s_lshr_b32 s71, s71, 16
s_mul_i32 s53, s71, 18
s_sub_u32 s72, s52, s53
s_mul_i32 s52, s50, 18432
s_add_u32 s52, s52, 8192
v_lshrrev_b32 v2, 4, v0
v_bfe_u32 v3, v0, 2, 2
v_lshl_add_u32 v1, v2, 2, v3
v_lshlrev_b32 v1, 7, v1
v_lshrrev_b32 v3, 1, v3
v_and_b32 v2, 1, v2
v_lshl_or_b32 v2, v2, 1, v3
v_lshl_add_u32 v1, v2, 5, v1
v_and_b32 v3, 3, v0
v_lshl_add_u32 v1, v3, 3, v1
v_add_u32 v72, s52, v1
s_mul_i32 s86, s71, 21
s_add_u32 s86, s86, s72
s_add_u32 s86, s86, 3
s_lshl_b32 s86, s86, 10
s_add_u32 s86, s86, 230400
s_add_u32 s86, s86, s67
s_add_u32 s52, s63, 34
s_cmp_ge_u32 s63, 94
s_cselect_b32 s70, 0, 2
s_cmp_lt_u32 s63, 67
s_cselect_b32 s70, 3, s70
s_mul_i32 s71, s52, 3641
s_lshr_b32 s71, s71, 16
s_mul_i32 s53, s71, 18
s_sub_u32 s72, s52, s53
s_sub_u32 s52, s63, 67
s_and_b32 s52, s52, 31
s_mul_i32 s53, s52, 21846
s_lshr_b32 s53, s53, 16
s_mul_i32 s54, s53, 3
s_sub_u32 s54, s52, s54
s_cmp_ge_u32 s70, 2
s_cselect_b32 s71, s53, s71
s_cselect_b32 s72, s54, s72
s_lshl_b32 s55, s71, 7
v_lshrrev_b32 v2, 3, v0
v_and_b32 v3, 7, v0
s_cmp_ge_u32 s70, 2
s_cselect_b32 s76, s12, s28
s_cselect_b32 s77, s13, s29
s_mov_b32 s78, 5308416
s_cselect_b32 s78, 663552, s78
s_mov_b32 s79, 0x20000
s_mov_b32 s82, 8192
s_cselect_b32 s82, 10496, s82
s_lshl_b32 s52, s72, 5
s_mul_i32 s53, s49, 576
s_add_u32 s52, s52, s53
s_mul_i32 s53, s72, 36
s_cmp_eq_u32 s72, 2
s_cselect_b32 s53, 0, s53
s_mul_i32 s54, s49, 72
s_add_u32 s53, s53, s54
s_cmp_ge_u32 s70, 2
s_cselect_b32 s52, s53, s52
s_mul_i32 s81, s52, 1152
s_add_u32 s81, s81, s55
s_cmp_eq_u32 s70, 3
s_cselect_b32 s81, 1073741824, s81
s_lshl_b32 s53, s70, 5
s_add_u32 s53, s53, s72
s_cmp_eq_u32 s53, 66
s_cselect_b32 s83, 1073741824, 0
s_cselect_b64 vcc, -1, 0
v_lshrrev_b32 v4, 1, v2
v_mul_u32_u24 v4, 18, v4
v_and_b32 v5, 1, v2
v_add3_u32 v4, v4, v5, 16
v_cndmask_b32 v2, v2, v4, vcc
v_mul_u32_u24 v1, 1152, v2
v_bfe_u32 v4, v0, 4, 2
v_lshlrev_b32 v4, 1, v4
v_xor_b32 v3, v3, v4
v_lshl_add_u32 v71, v3, 4, v1
s_mul_i32 s85, s50, 18432
s_add_u32 s85, s85, 12288
s_add_u32 s52, s63, 34
s_cmp_ge_u32 s63, 94
s_cselect_b32 s70, 0, 2
s_cmp_lt_u32 s63, 67
s_cselect_b32 s70, 3, s70
s_mul_i32 s71, s52, 3641
s_lshr_b32 s71, s71, 16
s_mul_i32 s53, s71, 18
s_sub_u32 s72, s52, s53
s_sub_u32 s52, s63, 67
s_and_b32 s52, s52, 31
s_mul_i32 s53, s52, 21846
s_lshr_b32 s53, s53, 16
s_mul_i32 s54, s53, 3
s_sub_u32 s54, s52, s54
s_cmp_ge_u32 s70, 2
s_cselect_b32 s71, s53, s71
s_cselect_b32 s72, s54, s72
s_mul_i32 s52, s50, 18432
s_add_u32 s52, s52, 12288
v_lshrrev_b32 v2, 4, v0
v_bfe_u32 v3, v0, 2, 2
v_lshl_add_u32 v1, v2, 2, v3
v_lshlrev_b32 v1, 7, v1
v_lshrrev_b32 v3, 1, v3
v_and_b32 v2, 1, v2
v_lshl_or_b32 v2, v2, 1, v3
v_lshl_add_u32 v1, v2, 5, v1
v_and_b32 v3, 3, v0
v_lshl_add_u32 v1, v3, 3, v1
v_add_u32 v73, s52, v1
s_mul_i32 s87, s71, 21
s_add_u32 s87, s87, s72
s_cmp_eq_u32 s70, 0
s_cselect_b32 s53, 3, 0
s_add_u32 s87, s87, s53
s_lshl_b32 s87, s87, 10
s_add_u32 s87, s87, 230400
s_add_u32 s87, s87, s67
s_cmp_eq_u32 s70, 3
s_cselect_b32 s87, 1073741824, s87
v_pk_add_f32 v[108:109], v[108:109], v[110:111]
v_mov_b32 v110, v108
v_mov_b32 v111, v109
s_nop 0
v_permlane16_swap_b32 v108, v110
v_permlane16_swap_b32 v109, v111
v_add_f32 v108, v108, v110
v_add_f32 v109, v109, v111
v_mov_b32 v110, v108
v_mov_b32 v111, v109
s_nop 0
v_permlane32_swap_b32 v108, v110
v_permlane32_swap_b32 v109, v111
v_add_f32 v108, v108, v110
v_add_f32 v109, v109, v111
v_mul_f32 v108, 0xbae38e39, v108
v_mul_f32 v109, 0x3ae38e39, v109
v_fma_f32 v109, -v108, v108, v109
v_max_f32 v109, 0, v109
v_add_f32 v109, 0x3727c5ac, v109
v_rsq_f32 v36, v109
s_nop 0
ds_write_b32 v39, v36
ds_read_b32 v60, v38 offset:0
ds_read_b32 v61, v38 offset:64
ds_read_b32 v62, v38 offset:128
ds_read_b32 v63, v38 offset:192
s_add_u32 s69, s69, 4096
buffer_load_dwordx4 v[160:163], v59, s[44:47], s69 offen offset:0 sc0 sc1
s_waitcnt vmcnt(12)
v_dot2_f32_bf16 v8, v112, s88, v108
v_dot2_f32_bf16 v9, v112, s89, v108
v_dot2_f32_bf16 v10, v113, s88, v108
v_dot2_f32_bf16 v11, v113, s89, v108
v_dot2_f32_bf16 v12, v114, s88, v108
v_dot2_f32_bf16 v13, v114, s89, v108
v_dot2_f32_bf16 v14, v115, s88, v108
v_dot2_f32_bf16 v15, v115, s89, v108
v_cvt_pk_bf16_f32 v112, v8, v9
v_cvt_pk_bf16_f32 v113, v10, v11
v_cvt_pk_bf16_f32 v114, v12, v13
v_cvt_pk_bf16_f32 v115, v14, v15
ds_write_b128 v37, v[112:115] offset:0
buffer_load_dwordx4 v[164:167], v59, s[44:47], s69 offen offset:1024 sc0 sc1
s_waitcnt vmcnt(12)
v_dot2_f32_bf16 v16, v116, s88, v108
v_dot2_f32_bf16 v17, v116, s89, v108
v_dot2_f32_bf16 v18, v117, s88, v108
v_dot2_f32_bf16 v19, v117, s89, v108
v_dot2_f32_bf16 v20, v118, s88, v108
v_dot2_f32_bf16 v21, v118, s89, v108
v_dot2_f32_bf16 v22, v119, s88, v108
v_dot2_f32_bf16 v23, v119, s89, v108
v_cvt_pk_bf16_f32 v116, v16, v17
v_cvt_pk_bf16_f32 v117, v18, v19
v_cvt_pk_bf16_f32 v118, v20, v21
v_cvt_pk_bf16_f32 v119, v22, v23
ds_write_b128 v37, v[116:119] offset:1024
buffer_load_dwordx4 v[168:171], v59, s[44:47], s69 offen offset:2048 sc0 sc1
s_waitcnt vmcnt(12)
v_dot2_f32_bf16 v8, v120, s88, v108
v_dot2_f32_bf16 v9, v120, s89, v108
v_dot2_f32_bf16 v10, v121, s88, v108
v_dot2_f32_bf16 v11, v121, s89, v108
v_dot2_f32_bf16 v12, v122, s88, v108
v_dot2_f32_bf16 v13, v122, s89, v108
v_dot2_f32_bf16 v14, v123, s88, v108
v_dot2_f32_bf16 v15, v123, s89, v108
v_cvt_pk_bf16_f32 v120, v8, v9
v_cvt_pk_bf16_f32 v121, v10, v11
v_cvt_pk_bf16_f32 v122, v12, v13
v_cvt_pk_bf16_f32 v123, v14, v15
ds_write_b128 v37, v[120:123] offset:2048
buffer_load_dwordx4 v[172:175], v59, s[44:47], s69 offen offset:3072 sc0 sc1
s_waitcnt vmcnt(12)
v_dot2_f32_bf16 v16, v124, s88, v108
v_dot2_f32_bf16 v17, v124, s89, v108
v_dot2_f32_bf16 v18, v125, s88, v108
v_dot2_f32_bf16 v19, v125, s89, v108
v_dot2_f32_bf16 v20, v126, s88, v108
v_dot2_f32_bf16 v21, v126, s89, v108
v_dot2_f32_bf16 v22, v127, s88, v108
v_dot2_f32_bf16 v23, v127, s89, v108
v_cvt_pk_bf16_f32 v124, v16, v17
v_cvt_pk_bf16_f32 v125, v18, v19
v_cvt_pk_bf16_f32 v126, v20, v21
v_cvt_pk_bf16_f32 v127, v22, v23
ds_write_b128 v37, v[124:127] offset:3072
s_add_u32 s69, s69, 4096
buffer_load_dwordx4 v[176:179], v59, s[44:47], s69 offen offset:0 sc0 sc1
s_waitcnt vmcnt(12)
v_dot2_f32_bf16 v8, v128, s88, v108
v_dot2_f32_bf16 v9, v128, s89, v108
v_dot2_f32_bf16 v10, v129, s88, v108
v_dot2_f32_bf16 v11, v129, s89, v108
v_dot2_f32_bf16 v12, v130, s88, v108
v_dot2_f32_bf16 v13, v130, s89, v108
v_dot2_f32_bf16 v14, v131, s88, v108
v_dot2_f32_bf16 v15, v131, s89, v108
v_cvt_pk_bf16_f32 v128, v8, v9
v_cvt_pk_bf16_f32 v129, v10, v11
v_cvt_pk_bf16_f32 v130, v12, v13
v_cvt_pk_bf16_f32 v131, v14, v15
ds_write_b128 v37, v[128:131] offset:4096
buffer_load_dwordx4 v[180:183], v59, s[44:47], s69 offen offset:1024 sc0 sc1
s_waitcnt vmcnt(12)
v_dot2_f32_bf16 v16, v132, s88, v108
v_dot2_f32_bf16 v17, v132, s89, v108
v_dot2_f32_bf16 v18, v133, s88, v108
v_dot2_f32_bf16 v19, v133, s89, v108
v_dot2_f32_bf16 v20, v134, s88, v108
v_dot2_f32_bf16 v21, v134, s89, v108
v_dot2_f32_bf16 v22, v135, s88, v108
v_dot2_f32_bf16 v23, v135, s89, v108
v_cvt_pk_bf16_f32 v132, v16, v17
v_cvt_pk_bf16_f32 v133, v18, v19
v_cvt_pk_bf16_f32 v134, v20, v21
v_cvt_pk_bf16_f32 v135, v22, v23
ds_write_b128 v37, v[132:135] offset:5120
s_waitcnt vmcnt(11)
v_dot2_f32_bf16 v8, v136, s88, v108
v_dot2_f32_bf16 v9, v136, s89, v108
v_dot2_f32_bf16 v10, v137, s88, v108
v_dot2_f32_bf16 v11, v137, s89, v108
v_dot2_f32_bf16 v12, v138, s88, v108
v_dot2_f32_bf16 v13, v138, s89, v108
v_dot2_f32_bf16 v14, v139, s88, v108
v_dot2_f32_bf16 v15, v139, s89, v108
v_cvt_pk_bf16_f32 v136, v8, v9
v_cvt_pk_bf16_f32 v137, v10, v11
v_cvt_pk_bf16_f32 v138, v12, v13
v_cvt_pk_bf16_f32 v139, v14, v15
ds_write_b128 v37, v[136:139] offset:6144
buffer_load_dwordx4 v[188:191], v59, s[44:47], s68 offen offset:3072 sc1
s_add_u32 s68, s68, 4096
buffer_load_dwordx4 v[192:195], v59, s[44:47], s68 offen offset:0 sc1
s_waitcnt vmcnt(12)
v_dot2_f32_bf16 v16, v140, s88, v108
v_dot2_f32_bf16 v17, v140, s89, v108
v_dot2_f32_bf16 v18, v141, s88, v108
v_dot2_f32_bf16 v19, v141, s89, v108
v_dot2_f32_bf16 v20, v142, s88, v108
v_dot2_f32_bf16 v21, v142, s89, v108
v_dot2_f32_bf16 v22, v143, s88, v108
v_dot2_f32_bf16 v23, v143, s89, v108
v_cvt_pk_bf16_f32 v140, v16, v17
v_cvt_pk_bf16_f32 v141, v18, v19
v_cvt_pk_bf16_f32 v142, v20, v21
v_cvt_pk_bf16_f32 v143, v22, v23
ds_write_b128 v37, v[140:143] offset:7168
buffer_load_dwordx4 v[196:199], v59, s[44:47], s68 offen offset:1024 sc1
buffer_load_dwordx4 v[200:203], v59, s[44:47], s68 offen offset:2048 sc1
s_waitcnt vmcnt(13)
v_dot2_f32_bf16 v8, v144, s88, v108
v_dot2_f32_bf16 v9, v144, s89, v108
v_dot2_f32_bf16 v10, v145, s88, v108
v_dot2_f32_bf16 v11, v145, s89, v108
v_dot2_f32_bf16 v12, v146, s88, v108
v_dot2_f32_bf16 v13, v146, s89, v108
v_dot2_f32_bf16 v14, v147, s88, v108
v_dot2_f32_bf16 v15, v147, s89, v108
v_cvt_pk_bf16_f32 v144, v8, v9
v_cvt_pk_bf16_f32 v145, v10, v11
v_cvt_pk_bf16_f32 v146, v12, v13
v_cvt_pk_bf16_f32 v147, v14, v15
ds_write_b128 v37, v[144:147] offset:8192
buffer_load_dwordx4 v[204:207], v59, s[44:47], s68 offen offset:3072 sc1
s_add_u32 s68, s68, 4096
buffer_load_dwordx4 v[208:211], v59, s[44:47], s68 offen offset:0 sc1
s_waitcnt vmcnt(14)
v_dot2_f32_bf16 v16, v148, s88, v108
v_dot2_f32_bf16 v17, v148, s89, v108
v_dot2_f32_bf16 v18, v149, s88, v108
v_dot2_f32_bf16 v19, v149, s89, v108
v_dot2_f32_bf16 v20, v150, s88, v108
v_dot2_f32_bf16 v21, v150, s89, v108
v_dot2_f32_bf16 v22, v151, s88, v108
v_dot2_f32_bf16 v23, v151, s89, v108
v_cvt_pk_bf16_f32 v148, v16, v17
v_cvt_pk_bf16_f32 v149, v18, v19
v_cvt_pk_bf16_f32 v150, v20, v21
v_cvt_pk_bf16_f32 v151, v22, v23
ds_write_b128 v37, v[148:151] offset:9216
buffer_load_dwordx4 v[212:215], v59, s[44:47], s68 offen offset:1024 sc1
buffer_load_dwordx4 v[216:219], v59, s[44:47], s68 offen offset:2048 sc1
s_waitcnt vmcnt(15)
v_dot2_f32_bf16 v8, v152, s88, v108
v_dot2_f32_bf16 v9, v152, s89, v108
v_dot2_f32_bf16 v10, v153, s88, v108
v_dot2_f32_bf16 v11, v153, s89, v108
v_dot2_f32_bf16 v12, v154, s88, v108
v_dot2_f32_bf16 v13, v154, s89, v108
v_dot2_f32_bf16 v14, v155, s88, v108
v_dot2_f32_bf16 v15, v155, s89, v108
v_cvt_pk_bf16_f32 v152, v8, v9
v_cvt_pk_bf16_f32 v153, v10, v11
v_cvt_pk_bf16_f32 v154, v12, v13
v_cvt_pk_bf16_f32 v155, v14, v15
s_waitcnt lgkmcnt(13)
ds_write_b128 v37, v[152:155] offset:10240
buffer_load_dwordx4 v[220:223], v59, s[44:47], s68 offen offset:3072 sc1
s_add_u32 s68, s68, 4096
buffer_load_dwordx4 v[224:227], v59, s[44:47], s68 offen offset:0 sc1
s_waitcnt vmcnt(16)
v_dot2_f32_bf16 v16, v156, s88, v108
v_dot2_f32_bf16 v17, v156, s89, v108
v_dot2_f32_bf16 v18, v157, s88, v108
v_dot2_f32_bf16 v19, v157, s89, v108
v_dot2_f32_bf16 v20, v158, s88, v108
v_dot2_f32_bf16 v21, v158, s89, v108
v_dot2_f32_bf16 v22, v159, s88, v108
v_dot2_f32_bf16 v23, v159, s89, v108
v_cvt_pk_bf16_f32 v156, v16, v17
v_cvt_pk_bf16_f32 v157, v18, v19
v_cvt_pk_bf16_f32 v158, v20, v21
v_cvt_pk_bf16_f32 v159, v22, v23
ds_write_b128 v37, v[156:159] offset:11264
buffer_load_dwordx4 v[228:231], v59, s[44:47], s68 offen offset:1024 sc1
buffer_load_dwordx4 v[232:235], v59, s[44:47], s68 offen offset:2048 sc1
s_waitcnt vmcnt(17)
v_dot2_f32_bf16 v8, v160, s88, v108
v_dot2_f32_bf16 v9, v160, s89, v108
v_dot2_f32_bf16 v10, v161, s88, v108
v_dot2_f32_bf16 v11, v161, s89, v108
v_dot2_f32_bf16 v12, v162, s88, v108
v_dot2_f32_bf16 v13, v162, s89, v108
v_dot2_f32_bf16 v14, v163, s88, v108
v_dot2_f32_bf16 v15, v163, s89, v108
v_cvt_pk_bf16_f32 v160, v8, v9
v_cvt_pk_bf16_f32 v161, v10, v11
v_cvt_pk_bf16_f32 v162, v12, v13
v_cvt_pk_bf16_f32 v163, v14, v15
s_waitcnt lgkmcnt(13)
ds_write_b128 v37, v[160:163] offset:12288
buffer_load_dwordx4 v[236:239], v59, s[44:47], s68 offen offset:3072 sc1
s_add_u32 s68, s68, 4096
buffer_load_dwordx4 v[240:243], v59, s[44:47], s68 offen offset:0 sc1
s_waitcnt vmcnt(18)
v_dot2_f32_bf16 v16, v164, s88, v108
v_dot2_f32_bf16 v17, v164, s89, v108
v_dot2_f32_bf16 v18, v165, s88, v108
v_dot2_f32_bf16 v19, v165, s89, v108
v_dot2_f32_bf16 v20, v166, s88, v108
v_dot2_f32_bf16 v21, v166, s89, v108
v_dot2_f32_bf16 v22, v167, s88, v108
v_dot2_f32_bf16 v23, v167, s89, v108
v_cvt_pk_bf16_f32 v164, v16, v17
v_cvt_pk_bf16_f32 v165, v18, v19
v_cvt_pk_bf16_f32 v166, v20, v21
v_cvt_pk_bf16_f32 v167, v22, v23
ds_write_b128 v37, v[164:167] offset:13312
buffer_load_dwordx4 v[244:247], v59, s[44:47], s68 offen offset:1024 sc1
buffer_load_dwordx4 v[248:251], v59, s[44:47], s68 offen offset:2048 sc1
s_waitcnt vmcnt(19)
v_dot2_f32_bf16 v8, v168, s88, v108
v_dot2_f32_bf16 v9, v168, s89, v108
v_dot2_f32_bf16 v10, v169, s88, v108
v_dot2_f32_bf16 v11, v169, s89, v108
v_dot2_f32_bf16 v12, v170, s88, v108
v_dot2_f32_bf16 v13, v170, s89, v108
v_dot2_f32_bf16 v14, v171, s88, v108
v_dot2_f32_bf16 v15, v171, s89, v108
v_cvt_pk_bf16_f32 v168, v8, v9
v_cvt_pk_bf16_f32 v169, v10, v11
v_cvt_pk_bf16_f32 v170, v12, v13
v_cvt_pk_bf16_f32 v171, v14, v15
s_waitcnt lgkmcnt(13)
ds_write_b128 v37, v[168:171] offset:14336
buffer_load_dwordx4 v[40:43], v59, s[44:47], s68 offen offset:3072 sc1
s_waitcnt vmcnt(19)
v_dot2_f32_bf16 v16, v172, s88, v108
v_dot2_f32_bf16 v17, v172, s89, v108
v_dot2_f32_bf16 v18, v173, s88, v108
v_dot2_f32_bf16 v19, v173, s89, v108
v_dot2_f32_bf16 v20, v174, s88, v108
v_dot2_f32_bf16 v21, v174, s89, v108
v_dot2_f32_bf16 v22, v175, s88, v108
v_dot2_f32_bf16 v23, v175, s89, v108
v_cvt_pk_bf16_f32 v172, v16, v17
v_cvt_pk_bf16_f32 v173, v18, v19
v_cvt_pk_bf16_f32 v174, v20, v21
v_cvt_pk_bf16_f32 v175, v22, v23
ds_write_b128 v37, v[172:175] offset:15360
s_add_u32 s68, s68, 4096
buffer_load_dwordx4 v[44:47], v59, s[44:47], s68 offen offset:0 sc1
s_waitcnt vmcnt(19)
v_dot2_f32_bf16 v8, v176, s88, v108
v_dot2_f32_bf16 v9, v176, s89, v108
v_dot2_f32_bf16 v10, v177, s88, v108
v_dot2_f32_bf16 v11, v177, s89, v108
v_dot2_f32_bf16 v12, v178, s88, v108
v_dot2_f32_bf16 v13, v178, s89, v108
v_dot2_f32_bf16 v14, v179, s88, v108
v_dot2_f32_bf16 v15, v179, s89, v108
v_cvt_pk_bf16_f32 v176, v8, v9
v_cvt_pk_bf16_f32 v177, v10, v11
v_cvt_pk_bf16_f32 v178, v12, v13
v_cvt_pk_bf16_f32 v179, v14, v15
s_waitcnt lgkmcnt(13)
ds_write_b128 v37, v[176:179] offset:16384
buffer_load_dwordx4 v[48:51], v59, s[44:47], s68 offen offset:1024 sc1
s_waitcnt vmcnt(19)
v_dot2_f32_bf16 v16, v180, s88, v108
v_dot2_f32_bf16 v17, v180, s89, v108
v_dot2_f32_bf16 v18, v181, s88, v108
v_dot2_f32_bf16 v19, v181, s89, v108
v_dot2_f32_bf16 v20, v182, s88, v108
v_dot2_f32_bf16 v21, v182, s89, v108
v_dot2_f32_bf16 v22, v183, s88, v108
v_dot2_f32_bf16 v23, v183, s89, v108
v_cvt_pk_bf16_f32 v180, v16, v17
v_cvt_pk_bf16_f32 v181, v18, v19
v_cvt_pk_bf16_f32 v182, v20, v21
v_cvt_pk_bf16_f32 v183, v22, v23
ds_write_b128 v37, v[180:183] offset:17408
buffer_load_dwordx4 v[52:55], v59, s[44:47], s68 offen offset:2048 sc1
v_add_u32 v64, 86016, v59
v_add_u32 v67, 122880, v59
s_lshr_b32 s52, s50, 1
s_lshl_b32 s52, s52, 10
s_and_b32 s53, s50, 1
s_lshl_b32 s53, s53, 3
s_add_u32 s52, s52, s53
s_add_u32 s52, s52, 0
v_add_u32 v65, s52, v59
v_add_u32 v68, 36864, v65
v_add_u32 v69, 36864, v59
s_lshl_b32 s52, s48, 3
s_add_u32 s52, s52, s49
s_mul_i32 s52, s52, 73728
s_lshl_b32 s53, s50, 11
s_add_u32 s52, s52, s53
s_add_u32 s69, s52, 4718592
s_waitcnt lgkmcnt(0)
s_barrier
ds_read_b128 a[0:3], v64 offset:0
ds_read_b128 a[72:75], v64 offset:18432
ds_read_b128 a[144:147], v67 offset:0
ds_read_b128 a[216:219], v67 offset:18432
ds_read_b128 a[4:7], v64 offset:1024
ds_read_b128 a[76:79], v64 offset:19456
ds_read_b128 a[148:151], v67 offset:1024
ds_read_b128 a[220:223], v67 offset:19456
ds_read_b128 a[8:11], v64 offset:2048
ds_read_b128 a[80:83], v64 offset:20480
ds_read_b128 a[152:155], v67 offset:2048
ds_read_b128 a[224:227], v67 offset:20480
ds_read_b32 v4, v38 offset:1408
ds_read_b32 v5, v38 offset:1472
ds_read_b32 v6, v38 offset:1536
s_waitcnt lgkmcnt(13)
ds_read_b32 v7, v38 offset:1600
s_waitcnt vmcnt(19) lgkmcnt(12)
v_mfma_f32_16x16x32_bf16 v[80:83], v[188:191], a[0:3], 0
buffer_load_dwordx4 v[176:179], v59, s[44:47], s68 offen offset:3072 sc1
s_add_u32 s68, s68, 4096
buffer_load_dwordx4 v[180:183], v59, s[44:47], s68 offen offset:0 sc1
ds_read_b128 a[12:15], v64 offset:3072
ds_read_b128 a[84:87], v64 offset:21504
ds_read_b128 a[156:159], v67 offset:3072
s_waitcnt lgkmcnt(13)
ds_read_b128 a[228:231], v67 offset:21504
v_mfma_f32_16x16x32_bf16 v[84:87], v[188:191], a[72:75], 0
v_mfma_f32_16x16x32_bf16 v[88:91], v[188:191], a[144:147], 0
v_mfma_f32_16x16x32_bf16 v[92:95], v[188:191], a[216:219], 0
s_mov_b32 m0, s84
s_nop 0
buffer_load_dwordx4 v70, s[28:31], s80 offen offset:0 nt lds
s_waitcnt vmcnt(21) lgkmcnt(12)
v_mfma_f32_16x16x32_bf16 v[80:83], v[192:195], a[4:7], v[80:83]
buffer_load_dwordx4 v[184:187], v59, s[44:47], s68 offen offset:1024 sc1
buffer_load_dwordx4 v[252:255], v59, s[44:47], s68 offen offset:2048 sc1
ds_read_b128 a[16:19], v64 offset:4096
ds_read_b128 a[88:91], v64 offset:22528
ds_read_b128 a[160:163], v67 offset:4096
s_waitcnt lgkmcnt(13)
ds_read_b128 a[232:235], v67 offset:22528
v_mfma_f32_16x16x32_bf16 v[84:87], v[192:195], a[76:79], v[84:87]
v_mfma_f32_16x16x32_bf16 v[88:91], v[192:195], a[148:151], v[88:91]
v_mfma_f32_16x16x32_bf16 v[92:95], v[192:195], a[220:223], v[92:95]
s_waitcnt vmcnt(22) lgkmcnt(12)
v_mfma_f32_16x16x32_bf16 v[80:83], v[196:199], a[8:11], v[80:83]
buffer_load_dwordx4 v[188:191], v59, s[44:47], s68 offen offset:3072 sc1
s_add_u32 s68, s68, 4096
buffer_load_dwordx4 v[192:195], v59, s[44:47], s68 offen offset:0 sc1
ds_read_b128 a[20:23], v64 offset:5120
ds_read_b128 a[92:95], v64 offset:23552
ds_read_b128 a[164:167], v67 offset:5120
s_waitcnt lgkmcnt(13)
ds_read_b128 a[236:239], v67 offset:23552
v_mfma_f32_16x16x32_bf16 v[84:87], v[196:199], a[80:83], v[84:87]
v_mfma_f32_16x16x32_bf16 v[88:91], v[196:199], a[152:155], v[88:91]
v_mfma_f32_16x16x32_bf16 v[92:95], v[196:199], a[224:227], v[92:95]
s_mov_b32 m0, s84
s_add_u32 s80, s80, 8192
buffer_load_dwordx4 v70, s[28:31], s80 offen offset:1024 nt lds
s_waitcnt vmcnt(24) lgkmcnt(8)
v_mfma_f32_16x16x32_bf16 v[80:83], v[200:203], a[12:15], v[80:83]
buffer_load_dwordx4 v[196:199], v59, s[44:47], s68 offen offset:1024 sc1
ds_read_b128 a[24:27], v64 offset:6144
ds_read_b128 a[96:99], v64 offset:24576
ds_read_b128 a[168:171], v67 offset:6144
ds_read_b128 a[240:243], v67 offset:24576
v_mfma_f32_16x16x32_bf16 v[84:87], v[200:203], a[84:87], v[84:87]
v_mfma_f32_16x16x32_bf16 v[88:91], v[200:203], a[156:159], v[88:91]
v_mfma_f32_16x16x32_bf16 v[92:95], v[200:203], a[228:231], v[92:95]
v_rcp_f32 v3, v4
v_mul_f32 v66, v4, v4
v_mul_f32 v66, v66, v4
v_mul_f32 v66, s66, v66
v_mul_f32 v4, v4, v58
v_fma_f32 v60, v60, v3, v3
s_waitcnt vmcnt(24) lgkmcnt(8)
v_mfma_f32_16x16x32_bf16 v[80:83], v[204:207], a[16:19], v[80:83]
buffer_load_dwordx4 v[200:203], v59, s[44:47], s68 offen offset:2048 sc1
ds_read_b128 a[28:31], v64 offset:7168
ds_read_b128 a[100:103], v64 offset:25600
ds_read_b128 a[172:175], v67 offset:7168
ds_read_b128 a[244:247], v67 offset:25600
v_mfma_f32_16x16x32_bf16 v[84:87], v[204:207], a[88:91], v[84:87]
v_mfma_f32_16x16x32_bf16 v[88:91], v[204:207], a[160:163], v[88:91]
v_mfma_f32_16x16x32_bf16 v[92:95], v[204:207], a[232:235], v[92:95]
s_mov_b32 m0, s84
s_add_u32 s80, s80, 8192
buffer_load_dwordx4 v70, s[28:31], s80 offen offset:2048 nt lds
s_waitcnt vmcnt(25) lgkmcnt(8)
v_mfma_f32_16x16x32_bf16 v[80:83], v[208:211], a[20:23], v[80:83]
buffer_load_dwordx4 v[204:207], v59, s[44:47], s68 offen offset:3072 sc1
ds_read_b128 a[32:35], v64 offset:8192
ds_read_b128 a[104:107], v64 offset:26624
ds_read_b128 a[176:179], v67 offset:8192
ds_read_b128 a[248:251], v67 offset:26624
v_mfma_f32_16x16x32_bf16 v[84:87], v[208:211], a[92:95], v[84:87]
v_mfma_f32_16x16x32_bf16 v[88:91], v[208:211], a[164:167], v[88:91]
v_mfma_f32_16x16x32_bf16 v[92:95], v[208:211], a[236:239], v[92:95]
v_rcp_f32 v3, v5
v_mul_f32 v75, v5, v5
v_mul_f32 v75, v75, v5
v_mul_f32 v75, s66, v75
v_mul_f32 v5, v5, v58
v_fma_f32 v61, v61, v3, v3
s_waitcnt vmcnt(25) lgkmcnt(8)
v_mfma_f32_16x16x32_bf16 v[80:83], v[212:215], a[24:27], v[80:83]
s_add_u32 s68, s68, 4096
buffer_load_dwordx4 v[208:211], v59, s[44:47], s68 offen offset:0 sc1
ds_read_b128 a[36:39], v64 offset:9216
ds_read_b128 a[108:111], v64 offset:27648
ds_read_b128 a[180:183], v67 offset:9216
ds_read_b128 a[252:255], v67 offset:27648
v_mfma_f32_16x16x32_bf16 v[84:87], v[212:215], a[96:99], v[84:87]
v_mfma_f32_16x16x32_bf16 v[88:91], v[212:215], a[168:171], v[88:91]
v_mfma_f32_16x16x32_bf16 v[92:95], v[212:215], a[240:243], v[92:95]
s_mov_b32 m0, s84
s_add_u32 s80, s80, 8192
buffer_load_dwordx4 v70, s[28:31], s80 offen offset:3072 nt lds
s_waitcnt vmcnt(26) lgkmcnt(8)
v_mfma_f32_16x16x32_bf16 v[80:83], v[216:219], a[28:31], v[80:83]
buffer_load_dwordx4 v[212:215], v59, s[44:47], s68 offen offset:1024 sc1
ds_read_b128 a[40:43], v64 offset:10240
ds_read_b128 a[112:115], v64 offset:28672
ds_read_b128 a[184:187], v67 offset:10240
ds_read_b128 v[8:11], v67 offset:28672
v_mfma_f32_16x16x32_bf16 v[84:87], v[216:219], a[100:103], v[84:87]
v_mfma_f32_16x16x32_bf16 v[88:91], v[216:219], a[172:175], v[88:91]
v_mfma_f32_16x16x32_bf16 v[92:95], v[216:219], a[244:247], v[92:95]
v_rcp_f32 v3, v6
v_mul_f32 v56, v6, v6
v_mul_f32 v56, v56, v6
v_mul_f32 v56, s66, v56
v_mul_f32 v6, v6, v58
v_fma_f32 v62, v62, v3, v3
s_waitcnt vmcnt(26) lgkmcnt(8)
v_mfma_f32_16x16x32_bf16 v[80:83], v[220:223], a[32:35], v[80:83]
buffer_load_dwordx4 v[216:219], v59, s[44:47], s68 offen offset:2048 sc1
ds_read_b128 a[44:47], v64 offset:11264
ds_read_b128 a[116:119], v64 offset:29696
ds_read_b128 a[188:191], v67 offset:11264
ds_read_b128 v[12:15], v67 offset:29696
v_mfma_f32_16x16x32_bf16 v[84:87], v[220:223], a[104:107], v[84:87]
v_mfma_f32_16x16x32_bf16 v[88:91], v[220:223], a[176:179], v[88:91]
v_mfma_f32_16x16x32_bf16 v[92:95], v[220:223], a[248:251], v[92:95]
s_mov_b32 m0, s85
s_nop 0
buffer_load_dwordx4 v71, s[76:79], s81 offen offset:0 nt lds
s_waitcnt vmcnt(27) lgkmcnt(8)
v_mfma_f32_16x16x32_bf16 v[80:83], v[224:227], a[36:39], v[80:83]
buffer_load_dwordx4 v[220:223], v59, s[44:47], s68 offen offset:3072 sc1
ds_read_b128 a[48:51], v64 offset:12288
ds_read_b128 a[120:123], v64 offset:30720
ds_read_b128 a[192:195], v67 offset:12288
ds_read_b128 v[16:19], v67 offset:30720
v_mfma_f32_16x16x32_bf16 v[84:87], v[224:227], a[108:111], v[84:87]
v_mfma_f32_16x16x32_bf16 v[88:91], v[224:227], a[180:183], v[88:91]
v_mfma_f32_16x16x32_bf16 v[92:95], v[224:227], a[252:255], v[92:95]
v_rcp_f32 v3, v7
v_mul_f32 v57, v7, v7
v_mul_f32 v57, v57, v7
v_mul_f32 v57, s66, v57
v_mul_f32 v7, v7, v58
v_fma_f32 v63, v63, v3, v3
s_waitcnt vmcnt(27) lgkmcnt(8)
v_mfma_f32_16x16x32_bf16 v[80:83], v[228:231], a[40:43], v[80:83]
s_add_u32 s68, s68, 4096
buffer_load_dwordx4 v[224:227], v59, s[44:47], s68 offen offset:0 sc1
ds_read_b128 a[52:55], v64 offset:13312
ds_read_b128 a[124:127], v64 offset:31744
ds_read_b128 a[196:199], v67 offset:13312
ds_read_b128 v[20:23], v67 offset:31744
v_mfma_f32_16x16x32_bf16 v[84:87], v[228:231], a[112:115], v[84:87]
v_mfma_f32_16x16x32_bf16 v[88:91], v[228:231], a[184:187], v[88:91]
v_mfma_f32_16x16x32_bf16 v[92:95], v[228:231], v[8:11], v[92:95]
s_mov_b32 m0, s85
s_add_u32 s81, s81, 8192
s_or_b32 s81, s81, s83
buffer_load_dwordx4 v71, s[76:79], s81 offen offset:1024 nt lds
s_waitcnt vmcnt(28) lgkmcnt(8)
v_mfma_f32_16x16x32_bf16 v[80:83], v[232:235], a[44:47], v[80:83]
buffer_load_dwordx4 v[228:231], v59, s[44:47], s68 offen offset:1024 sc1
ds_read_b128 a[56:59], v64 offset:14336
ds_read_b128 a[128:131], v64 offset:32768
ds_read_b128 a[200:203], v67 offset:14336
ds_read_b128 v[24:27], v67 offset:32768
v_mfma_f32_16x16x32_bf16 v[84:87], v[232:235], a[116:119], v[84:87]
v_mfma_f32_16x16x32_bf16 v[88:91], v[232:235], a[188:191], v[88:91]
v_mfma_f32_16x16x32_bf16 v[92:95], v[232:235], v[12:15], v[92:95]
s_waitcnt vmcnt(28) lgkmcnt(8)
v_mfma_f32_16x16x32_bf16 v[80:83], v[236:239], a[48:51], v[80:83]
buffer_load_dwordx4 v[232:235], v59, s[44:47], s68 offen offset:2048 sc1
ds_read_b128 a[60:63], v64 offset:15360
ds_read_b128 a[132:135], v64 offset:33792
ds_read_b128 a[204:207], v67 offset:15360
ds_read_b128 v[28:31], v67 offset:33792
v_mfma_f32_16x16x32_bf16 v[84:87], v[236:239], a[120:123], v[84:87]
v_mfma_f32_16x16x32_bf16 v[88:91], v[236:239], a[192:195], v[88:91]
v_mfma_f32_16x16x32_bf16 v[92:95], v[236:239], v[16:19], v[92:95]
s_mov_b32 m0, s85
s_add_u32 s81, s81, s82
buffer_load_dwordx4 v71, s[76:79], s81 offen offset:2048 nt lds
s_waitcnt vmcnt(29) lgkmcnt(8)
v_mfma_f32_16x16x32_bf16 v[80:83], v[240:243], a[52:55], v[80:83]
buffer_load_dwordx4 v[236:239], v59, s[44:47], s68 offen offset:3072 sc1
ds_read_b128 a[64:67], v64 offset:16384
ds_read_b128 a[136:139], v64 offset:34816
ds_read_b128 a[208:211], v67 offset:16384
ds_read_b128 v[32:35], v67 offset:34816
v_mfma_f32_16x16x32_bf16 v[84:87], v[240:243], a[124:127], v[84:87]
v_mfma_f32_16x16x32_bf16 v[88:91], v[240:243], a[196:199], v[88:91]
v_mfma_f32_16x16x32_bf16 v[92:95], v[240:243], v[20:23], v[92:95]
s_waitcnt vmcnt(29) lgkmcnt(8)
v_mfma_f32_16x16x32_bf16 v[80:83], v[244:247], a[56:59], v[80:83]
s_add_u32 s68, s68, 4096
buffer_load_dwordx4 v[240:243], v59, s[44:47], s68 offen offset:0 sc1
ds_read_b128 a[68:71], v64 offset:17408
ds_read_b128 a[140:143], v64 offset:35840
ds_read_b128 a[212:215], v67 offset:17408
ds_read_b128 v[36:39], v67 offset:35840
v_mfma_f32_16x16x32_bf16 v[84:87], v[244:247], a[128:131], v[84:87]
v_mfma_f32_16x16x32_bf16 v[88:91], v[244:247], a[200:203], v[88:91]
v_mfma_f32_16x16x32_bf16 v[92:95], v[244:247], v[24:27], v[92:95]
s_mov_b32 m0, s85
s_add_u32 s81, s81, 8192
buffer_load_dwordx4 v71, s[76:79], s81 offen offset:3072 nt lds
s_waitcnt vmcnt(30) lgkmcnt(8)
v_mfma_f32_16x16x32_bf16 v[80:83], v[248:251], a[60:63], v[80:83]
buffer_load_dwordx4 v[244:247], v59, s[44:47], s68 offen offset:1024 sc1
v_mfma_f32_16x16x32_bf16 v[84:87], v[248:251], a[132:135], v[84:87]
v_mfma_f32_16x16x32_bf16 v[88:91], v[248:251], a[204:207], v[88:91]
v_mfma_f32_16x16x32_bf16 v[92:95], v[248:251], v[28:31], v[92:95]
s_waitcnt vmcnt(30) lgkmcnt(4)
v_mfma_f32_16x16x32_bf16 v[80:83], v[40:43], a[64:67], v[80:83]
buffer_load_dwordx4 v[248:251], v59, s[44:47], s68 offen offset:2048 sc1
v_mfma_f32_16x16x32_bf16 v[84:87], v[40:43], a[136:139], v[84:87]
v_mfma_f32_16x16x32_bf16 v[88:91], v[40:43], a[208:211], v[88:91]
v_mfma_f32_16x16x32_bf16 v[92:95], v[40:43], v[32:35], v[92:95]
s_waitcnt vmcnt(30) lgkmcnt(0)
v_mfma_f32_16x16x32_bf16 v[80:83], v[44:47], a[68:71], v[80:83]
buffer_load_dwordx4 v[40:43], v59, s[44:47], s68 offen offset:3072 sc1
v_mfma_f32_16x16x32_bf16 v[84:87], v[44:47], a[140:143], v[84:87]
v_mfma_f32_16x16x32_bf16 v[88:91], v[44:47], a[212:215], v[88:91]
v_mfma_f32_16x16x32_bf16 v[92:95], v[44:47], v[36:39], v[92:95]
s_waitcnt vmcnt(30)
v_mfma_f32_16x16x32_bf16 v[96:99], v[48:51], a[0:3], 0
s_add_u32 s68, s68, 4096
buffer_load_dwordx4 v[44:47], v59, s[44:47], s68 offen offset:0 sc1
v_mfma_f32_16x16x32_bf16 v[100:103], v[48:51], a[72:75], 0
v_mfma_f32_16x16x32_bf16 v[104:107], v[48:51], a[144:147], 0
v_mfma_f32_16x16x32_bf16 v[108:111], v[48:51], a[216:219], 0
s_waitcnt vmcnt(30)
v_mfma_f32_16x16x32_bf16 v[96:99], v[52:55], a[4:7], v[96:99]
buffer_load_dwordx4 v[48:51], v59, s[44:47], s68 offen offset:1024 sc1
v_mfma_f32_16x16x32_bf16 v[100:103], v[52:55], a[76:79], v[100:103]
v_mul_f32 v160, v80, v80
v_mul_f32 v161, v81, v81
v_mul_f32 v162, v82, v82
v_mfma_f32_16x16x32_bf16 v[104:107], v[52:55], a[148:151], v[104:107]
v_mul_f32 v163, v83, v83
v_mul_f32 v164, v84, v84
v_mul_f32 v165, v85, v85
v_mfma_f32_16x16x32_bf16 v[108:111], v[52:55], a[220:223], v[108:111]
v_mul_f32 v166, v86, v86
v_mul_f32 v167, v87, v87
v_fma_f32 v160, v160, v66, v4
s_waitcnt vmcnt(30)
v_mfma_f32_16x16x32_bf16 v[96:99], v[176:179], a[8:11], v[96:99]
buffer_load_dwordx4 v[52:55], v59, s[44:47], s68 offen offset:2048 sc1
v_mfma_f32_16x16x32_bf16 v[100:103], v[176:179], a[80:83], v[100:103]
v_fma_f32 v161, v161, v66, v4
v_fma_f32 v162, v162, v66, v4
v_fma_f32 v163, v163, v66, v4
v_fma_f32 v164, v164, v75, v5
v_mfma_f32_16x16x32_bf16 v[104:107], v[176:179], a[152:155], v[104:107]
v_fma_f32 v165, v165, v75, v5
v_fma_f32 v166, v166, v75, v5
v_fma_f32 v167, v167, v75, v5
v_mfma_f32_16x16x32_bf16 v[108:111], v[176:179], a[224:227], v[108:111]
v_mul_f32 v160, v160, v80
v_mul_f32 v161, v161, v81
v_mul_f32 v162, v162, v82
s_waitcnt vmcnt(30)
v_mfma_f32_16x16x32_bf16 v[96:99], v[180:183], a[12:15], v[96:99]
buffer_load_dwordx4 v[176:179], v59, s[44:47], s68 offen offset:3072 sc1
v_mfma_f32_16x16x32_bf16 v[100:103], v[180:183], a[84:87], v[100:103]
v_mul_f32 v163, v163, v83
v_mul_f32 v164, v164, v84
v_mul_f32 v165, v165, v85
v_mfma_f32_16x16x32_bf16 v[104:107], v[180:183], a[156:159], v[104:107]
v_mul_f32 v166, v166, v86
v_mul_f32 v167, v167, v87
v_exp_f32 v160, v160
v_mfma_f32_16x16x32_bf16 v[108:111], v[180:183], a[228:231], v[108:111]
v_exp_f32 v161, v161
s_waitcnt vmcnt(29)
v_mfma_f32_16x16x32_bf16 v[96:99], v[184:187], a[16:19], v[96:99]
s_add_u32 s68, s68, 4096
buffer_load_dwordx4 v[180:183], v59, s[44:47], s68 offen offset:0 sc1
v_mfma_f32_16x16x32_bf16 v[100:103], v[184:187], a[88:91], v[100:103]
v_exp_f32 v162, v162
v_exp_f32 v163, v163
v_mfma_f32_16x16x32_bf16 v[104:107], v[184:187], a[160:163], v[104:107]
v_exp_f32 v164, v164
v_mfma_f32_16x16x32_bf16 v[108:111], v[184:187], a[232:235], v[108:111]
v_exp_f32 v165, v165
v_exp_f32 v166, v166
s_waitcnt vmcnt(29)
v_mfma_f32_16x16x32_bf16 v[96:99], v[252:255], a[20:23], v[96:99]
buffer_load_dwordx4 v[184:187], v59, s[44:47], s68 offen offset:1024 sc1
v_mfma_f32_16x16x32_bf16 v[100:103], v[252:255], a[92:95], v[100:103]
v_exp_f32 v167, v167
v_fma_f32 v160, v160, v60, v60
v_fma_f32 v161, v161, v60, v60
v_mfma_f32_16x16x32_bf16 v[104:107], v[252:255], a[164:167], v[104:107]
v_fma_f32 v162, v162, v60, v60
v_fma_f32 v163, v163, v60, v60
v_fma_f32 v164, v164, v61, v61
v_mfma_f32_16x16x32_bf16 v[108:111], v[252:255], a[236:239], v[108:111]
v_fma_f32 v165, v165, v61, v61
v_fma_f32 v166, v166, v61, v61
v_fma_f32 v167, v167, v61, v61
s_waitcnt vmcnt(21)
ds_read_b64_tr_b16 v[112:113], v72
ds_read_b64_tr_b16 v[114:115], v72 offset:2048
v_mfma_f32_16x16x32_bf16 v[96:99], v[188:191], a[24:27], v[96:99]
buffer_load_dwordx4 v[252:255], v59, s[44:47], s68 offen offset:2048 sc1
v_mfma_f32_16x16x32_bf16 v[100:103], v[188:191], a[96:99], v[100:103]
v_rcp_f32 v160, v160
v_rcp_f32 v161, v161
v_mfma_f32_16x16x32_bf16 v[104:107], v[188:191], a[168:171], v[104:107]
v_rcp_f32 v162, v162
v_mfma_f32_16x16x32_bf16 v[108:111], v[188:191], a[240:243], v[108:111]
v_rcp_f32 v163, v163
v_rcp_f32 v164, v164
v_xor_b32 v74, 32, v72
ds_read_b64_tr_b16 v[116:117], v74
ds_read_b64_tr_b16 v[118:119], v74 offset:2048
v_mfma_f32_16x16x32_bf16 v[96:99], v[192:195], a[28:31], v[96:99]
buffer_load_dwordx4 v[188:191], v59, s[44:47], s68 offen offset:3072 sc1
v_mfma_f32_16x16x32_bf16 v[100:103], v[192:195], a[100:103], v[100:103]
v_rcp_f32 v165, v165
v_mfma_f32_16x16x32_bf16 v[104:107], v[192:195], a[172:175], v[104:107]
v_rcp_f32 v166, v166
v_rcp_f32 v167, v167
v_mul_f32 v160, v160, v80
v_mfma_f32_16x16x32_bf16 v[108:111], v[192:195], a[244:247], v[108:111]
v_mul_f32 v161, v161, v81
v_mul_f32 v162, v162, v82
v_mul_f32 v163, v163, v83
v_xor_b32 v74, 64, v72
ds_read_b64_tr_b16 v[120:121], v74
ds_read_b64_tr_b16 v[122:123], v74 offset:2048
s_waitcnt lgkmcnt(4)
buffer_store_dwordx4 v[112:115], v59, s[44:47], s86 offen sc0 sc1
v_mfma_f32_16x16x32_bf16 v[96:99], v[196:199], a[32:35], v[96:99]
s_add_u32 s68, s68, 4096
buffer_load_dwordx4 v[192:195], v59, s[44:47], s68 offen offset:0 sc1
v_mfma_f32_16x16x32_bf16 v[100:103], v[196:199], a[104:107], v[100:103]
v_mul_f32 v164, v164, v84
v_mul_f32 v165, v165, v85
v_mul_f32 v166, v166, v86
v_mfma_f32_16x16x32_bf16 v[104:107], v[196:199], a[176:179], v[104:107]
v_mul_f32 v167, v167, v87
v_cvt_pk_bf16_f32 v168, v160, v161
v_cvt_pk_bf16_f32 v169, v162, v163
v_mfma_f32_16x16x32_bf16 v[108:111], v[196:199], a[248:251], v[108:111]
v_cvt_pk_bf16_f32 v170, v164, v165
v_cvt_pk_bf16_f32 v171, v166, v167
ds_write_b64 v65, v[168:169] offset:0
ds_write_b64 v65, v[170:171] offset:18432
v_xor_b32 v74, 96, v72
ds_read_b64_tr_b16 v[124:125], v74
ds_read_b64_tr_b16 v[126:127], v74 offset:2048
v_mfma_f32_16x16x32_bf16 v[96:99], v[200:203], a[36:39], v[96:99]
buffer_load_dwordx4 v[196:199], v59, s[44:47], s68 offen offset:1024 sc1
v_mfma_f32_16x16x32_bf16 v[100:103], v[200:203], a[108:111], v[100:103]
v_mul_f32 v160, v88, v88
v_mul_f32 v161, v89, v89
v_mul_f32 v162, v90, v90
v_mfma_f32_16x16x32_bf16 v[104:107], v[200:203], a[180:183], v[104:107]
v_mul_f32 v163, v91, v91
v_mul_f32 v164, v92, v92
v_mul_f32 v165, v93, v93
v_mfma_f32_16x16x32_bf16 v[108:111], v[200:203], a[252:255], v[108:111]
v_mul_f32 v166, v94, v94
v_mul_f32 v167, v95, v95
v_fma_f32 v160, v160, v56, v6
s_waitcnt vmcnt(14)
ds_read_b64_tr_b16 v[128:129], v73
ds_read_b64_tr_b16 v[130:131], v73 offset:2048
v_mfma_f32_16x16x32_bf16 v[96:99], v[204:207], a[40:43], v[96:99]
buffer_load_dwordx4 v[200:203], v59, s[44:47], s68 offen offset:2048 sc1
v_mfma_f32_16x16x32_bf16 v[100:103], v[204:207], a[112:115], v[100:103]
v_fma_f32 v161, v161, v56, v6
v_fma_f32 v162, v162, v56, v6
v_fma_f32 v163, v163, v56, v6
v_fma_f32 v164, v164, v57, v7
v_mfma_f32_16x16x32_bf16 v[104:107], v[204:207], a[184:187], v[104:107]
v_fma_f32 v165, v165, v57, v7
v_fma_f32 v166, v166, v57, v7
v_fma_f32 v167, v167, v57, v7
v_mfma_f32_16x16x32_bf16 v[108:111], v[204:207], v[8:11], v[108:111]
v_mul_f32 v160, v160, v88
v_mul_f32 v161, v161, v89
v_mul_f32 v162, v162, v90
v_xor_b32 v74, 32, v73
ds_read_b64_tr_b16 v[132:133], v74
ds_read_b64_tr_b16 v[134:135], v74 offset:2048
v_mfma_f32_16x16x32_bf16 v[96:99], v[208:211], a[44:47], v[96:99]
buffer_load_dwordx4 v[204:207], v59, s[44:47], s68 offen offset:3072 sc1
v_mfma_f32_16x16x32_bf16 v[100:103], v[208:211], a[116:119], v[100:103]
v_mul_f32 v163, v163, v91
v_mul_f32 v164, v164, v92
v_mul_f32 v165, v165, v93
v_mfma_f32_16x16x32_bf16 v[104:107], v[208:211], a[188:191], v[104:107]
v_mul_f32 v166, v166, v94
v_mul_f32 v167, v167, v95
v_exp_f32 v160, v160
v_mfma_f32_16x16x32_bf16 v[108:111], v[208:211], v[12:15], v[108:111]
v_exp_f32 v161, v161
v_xor_b32 v74, 64, v73
ds_read_b64_tr_b16 v[136:137], v74
ds_read_b64_tr_b16 v[138:139], v74 offset:2048
v_mfma_f32_16x16x32_bf16 v[96:99], v[212:215], a[48:51], v[96:99]
s_add_u32 s68, s68, 4096
buffer_load_dwordx4 v[208:211], v59, s[44:47], s68 offen offset:0 sc1
v_mfma_f32_16x16x32_bf16 v[100:103], v[212:215], a[120:123], v[100:103]
v_exp_f32 v162, v162
v_exp_f32 v163, v163
v_mfma_f32_16x16x32_bf16 v[104:107], v[212:215], a[192:195], v[104:107]
v_exp_f32 v164, v164
v_mfma_f32_16x16x32_bf16 v[108:111], v[212:215], v[16:19], v[108:111]
v_exp_f32 v165, v165
v_exp_f32 v166, v166
v_xor_b32 v74, 96, v73
ds_read_b64_tr_b16 v[140:141], v74
s_waitcnt lgkmcnt(13)
ds_read_b64_tr_b16 v[142:143], v74 offset:2048
v_mfma_f32_16x16x32_bf16 v[96:99], v[216:219], a[52:55], v[96:99]
buffer_load_dwordx4 v[212:215], v59, s[44:47], s68 offen offset:1024 sc1
v_mfma_f32_16x16x32_bf16 v[100:103], v[216:219], a[124:127], v[100:103]
v_exp_f32 v167, v167
v_fma_f32 v160, v160, v62, v62
v_fma_f32 v161, v161, v62, v62
v_mfma_f32_16x16x32_bf16 v[104:107], v[216:219], a[196:199], v[104:107]
v_fma_f32 v162, v162, v62, v62
v_fma_f32 v163, v163, v62, v62
v_fma_f32 v164, v164, v63, v63
v_mfma_f32_16x16x32_bf16 v[108:111], v[216:219], v[20:23], v[108:111]
v_fma_f32 v165, v165, v63, v63
v_fma_f32 v166, v166, v63, v63
v_fma_f32 v167, v167, v63, v63
s_add_u32 s86, s86, 423936
buffer_store_dwordx4 v[116:119], v59, s[44:47], s86 offen sc0 sc1
v_mfma_f32_16x16x32_bf16 v[96:99], v[220:223], a[56:59], v[96:99]
buffer_load_dwordx4 v[216:219], v59, s[44:47], s68 offen offset:2048 sc1
v_mfma_f32_16x16x32_bf16 v[100:103], v[220:223], a[128:131], v[100:103]
v_rcp_f32 v160, v160
v_rcp_f32 v161, v161
v_mfma_f32_16x16x32_bf16 v[104:107], v[220:223], a[200:203], v[104:107]
v_rcp_f32 v162, v162
v_mfma_f32_16x16x32_bf16 v[108:111], v[220:223], v[24:27], v[108:111]
v_rcp_f32 v163, v163
v_rcp_f32 v164, v164
v_mfma_f32_16x16x32_bf16 v[96:99], v[224:227], a[60:63], v[96:99]
buffer_load_dwordx4 v[220:223], v59, s[44:47], s68 offen offset:3072 sc1
v_mfma_f32_16x16x32_bf16 v[100:103], v[224:227], a[132:135], v[100:103]
v_rcp_f32 v165, v165
v_mfma_f32_16x16x32_bf16 v[104:107], v[224:227], a[204:207], v[104:107]
v_rcp_f32 v166, v166
v_rcp_f32 v167, v167
v_mul_f32 v160, v160, v88
v_mfma_f32_16x16x32_bf16 v[108:111], v[224:227], v[28:31], v[108:111]
v_mul_f32 v161, v161, v89
v_mul_f32 v162, v162, v90
v_mul_f32 v163, v163, v91
v_mfma_f32_16x16x32_bf16 v[96:99], v[228:231], a[64:67], v[96:99]
s_add_u32 s68, s68, 4096
buffer_load_dwordx4 v[224:227], v59, s[44:47], s68 offen offset:0 sc1
v_mfma_f32_16x16x32_bf16 v[100:103], v[228:231], a[136:139], v[100:103]
v_mul_f32 v164, v164, v92
v_mul_f32 v165, v165, v93
v_mul_f32 v166, v166, v94
v_mfma_f32_16x16x32_bf16 v[104:107], v[228:231], a[208:211], v[104:107]
v_mul_f32 v167, v167, v95
v_cvt_pk_bf16_f32 v172, v160, v161
v_cvt_pk_bf16_f32 v173, v162, v163
v_mfma_f32_16x16x32_bf16 v[108:111], v[228:231], v[32:35], v[108:111]
v_cvt_pk_bf16_f32 v174, v164, v165
v_cvt_pk_bf16_f32 v175, v166, v167
ds_write_b64 v68, v[172:173] offset:0
s_waitcnt lgkmcnt(13)
ds_write_b64 v68, v[174:175] offset:18432
v_mfma_f32_16x16x32_bf16 v[96:99], v[232:235], a[68:71], v[96:99]
buffer_load_dwordx4 v[228:231], v59, s[44:47], s68 offen offset:1024 sc1
v_mfma_f32_16x16x32_bf16 v[100:103], v[232:235], a[140:143], v[100:103]
v_mfma_f32_16x16x32_bf16 v[104:107], v[232:235], a[212:215], v[104:107]
v_mfma_f32_16x16x32_bf16 v[108:111], v[232:235], v[36:39], v[108:111]
v_mfma_f32_16x16x32_bf16 v[80:83], v[236:239], a[0:3], 0
buffer_load_dwordx4 v[232:235], v59, s[44:47], s68 offen offset:2048 sc1
v_mfma_f32_16x16x32_bf16 v[84:87], v[236:239], a[72:75], 0
v_mfma_f32_16x16x32_bf16 v[88:91], v[236:239], a[144:147], 0
v_mfma_f32_16x16x32_bf16 v[92:95], v[236:239], a[216:219], 0
v_mfma_f32_16x16x32_bf16 v[80:83], v[240:243], a[4:7], v[80:83]
buffer_load_dwordx4 v[236:239], v59, s[44:47], s68 offen offset:3072 sc1
v_mfma_f32_16x16x32_bf16 v[84:87], v[240:243], a[76:79], v[84:87]
v_mul_f32 v160, v96, v96
v_mul_f32 v161, v97, v97
v_mul_f32 v162, v98, v98
v_mfma_f32_16x16x32_bf16 v[88:91], v[240:243], a[148:151], v[88:91]
v_mul_f32 v163, v99, v99
v_mul_f32 v164, v100, v100
v_mul_f32 v165, v101, v101
v_mfma_f32_16x16x32_bf16 v[92:95], v[240:243], a[220:223], v[92:95]
v_mul_f32 v166, v102, v102
v_mul_f32 v167, v103, v103
v_fma_f32 v160, v160, v66, v4
s_add_u32 s86, s86, 423936
buffer_store_dwordx4 v[120:123], v59, s[44:47], s86 offen sc0 sc1
s_waitcnt vmcnt(25)
v_mfma_f32_16x16x32_bf16 v[80:83], v[244:247], a[8:11], v[80:83]
s_add_u32 s68, s68, 4096
buffer_load_dwordx4 v[240:243], v59, s[44:47], s68 offen offset:0 sc1
v_mfma_f32_16x16x32_bf16 v[84:87], v[244:247], a[80:83], v[84:87]
v_fma_f32 v161, v161, v66, v4
v_fma_f32 v162, v162, v66, v4
v_fma_f32 v163, v163, v66, v4
v_fma_f32 v164, v164, v75, v5
v_mfma_f32_16x16x32_bf16 v[88:91], v[244:247], a[152:155], v[88:91]
v_fma_f32 v165, v165, v75, v5
v_fma_f32 v166, v166, v75, v5
v_fma_f32 v167, v167, v75, v5
v_mfma_f32_16x16x32_bf16 v[92:95], v[244:247], a[224:227], v[92:95]
v_mul_f32 v160, v160, v96
v_mul_f32 v161, v161, v97
v_mul_f32 v162, v162, v98
s_waitcnt vmcnt(25)
v_mfma_f32_16x16x32_bf16 v[80:83], v[248:251], a[12:15], v[80:83]
buffer_load_dwordx4 v[244:247], v59, s[44:47], s68 offen offset:1024 sc1
v_mfma_f32_16x16x32_bf16 v[84:87], v[248:251], a[84:87], v[84:87]
v_mul_f32 v163, v163, v99
v_mul_f32 v164, v164, v100
v_mul_f32 v165, v165, v101
v_mfma_f32_16x16x32_bf16 v[88:91], v[248:251], a[156:159], v[88:91]
v_mul_f32 v166, v166, v102
v_mul_f32 v167, v167, v103
v_exp_f32 v160, v160
v_mfma_f32_16x16x32_bf16 v[92:95], v[248:251], a[228:231], v[92:95]
v_exp_f32 v161, v161
s_waitcnt vmcnt(25)
v_mfma_f32_16x16x32_bf16 v[80:83], v[40:43], a[16:19], v[80:83]
buffer_load_dwordx4 v[248:251], v59, s[44:47], s68 offen offset:2048 sc1
v_mfma_f32_16x16x32_bf16 v[84:87], v[40:43], a[88:91], v[84:87]
v_exp_f32 v162, v162
v_exp_f32 v163, v163
v_mfma_f32_16x16x32_bf16 v[88:91], v[40:43], a[160:163], v[88:91]
v_exp_f32 v164, v164
v_mfma_f32_16x16x32_bf16 v[92:95], v[40:43], a[232:235], v[92:95]
v_exp_f32 v165, v165
v_exp_f32 v166, v166
s_waitcnt vmcnt(25)
v_mfma_f32_16x16x32_bf16 v[80:83], v[44:47], a[20:23], v[80:83]
buffer_load_dwordx4 v[40:43], v59, s[44:47], s68 offen offset:3072 sc1
v_mfma_f32_16x16x32_bf16 v[84:87], v[44:47], a[92:95], v[84:87]
v_exp_f32 v167, v167
v_fma_f32 v160, v160, v60, v60
v_fma_f32 v161, v161, v60, v60
v_mfma_f32_16x16x32_bf16 v[88:91], v[44:47], a[164:167], v[88:91]
v_fma_f32 v162, v162, v60, v60
v_fma_f32 v163, v163, v60, v60
v_fma_f32 v164, v164, v61, v61
v_mfma_f32_16x16x32_bf16 v[92:95], v[44:47], a[236:239], v[92:95]
v_fma_f32 v165, v165, v61, v61
v_fma_f32 v166, v166, v61, v61
v_fma_f32 v167, v167, v61, v61
s_waitcnt vmcnt(25)
v_mfma_f32_16x16x32_bf16 v[80:83], v[48:51], a[24:27], v[80:83]
s_add_u32 s68, s68, 4096
buffer_load_dwordx4 v[44:47], v59, s[44:47], s68 offen offset:0 sc1
v_mfma_f32_16x16x32_bf16 v[84:87], v[48:51], a[96:99], v[84:87]
v_rcp_f32 v160, v160
v_rcp_f32 v161, v161
v_mfma_f32_16x16x32_bf16 v[88:91], v[48:51], a[168:171], v[88:91]
v_rcp_f32 v162, v162
v_mfma_f32_16x16x32_bf16 v[92:95], v[48:51], a[240:243], v[92:95]
v_rcp_f32 v163, v163
v_rcp_f32 v164, v164
s_waitcnt vmcnt(25)
v_mfma_f32_16x16x32_bf16 v[80:83], v[52:55], a[28:31], v[80:83]
buffer_load_dwordx4 v[48:51], v59, s[44:47], s68 offen offset:1024 sc1
v_mfma_f32_16x16x32_bf16 v[84:87], v[52:55], a[100:103], v[84:87]
v_rcp_f32 v165, v165
v_mfma_f32_16x16x32_bf16 v[88:91], v[52:55], a[172:175], v[88:91]
v_rcp_f32 v166, v166
v_rcp_f32 v167, v167
v_mul_f32 v160, v160, v96
v_mfma_f32_16x16x32_bf16 v[92:95], v[52:55], a[244:247], v[92:95]
v_mul_f32 v161, v161, v97
v_mul_f32 v162, v162, v98
v_mul_f32 v163, v163, v99
s_waitcnt lgkmcnt(10)
s_add_u32 s86, s86, 423936
buffer_store_dwordx4 v[124:127], v59, s[44:47], s86 offen sc0 sc1
s_waitcnt vmcnt(26)
v_mfma_f32_16x16x32_bf16 v[80:83], v[176:179], a[32:35], v[80:83]
buffer_load_dwordx4 v[52:55], v59, s[44:47], s68 offen offset:2048 sc1
v_mfma_f32_16x16x32_bf16 v[84:87], v[176:179], a[104:107], v[84:87]
v_mul_f32 v164, v164, v100
v_mul_f32 v165, v165, v101
v_mul_f32 v166, v166, v102
v_mfma_f32_16x16x32_bf16 v[88:91], v[176:179], a[176:179], v[88:91]
v_mul_f32 v167, v167, v103
v_cvt_pk_bf16_f32 v168, v160, v161
v_cvt_pk_bf16_f32 v169, v162, v163
v_mfma_f32_16x16x32_bf16 v[92:95], v[176:179], a[248:251], v[92:95]
v_cvt_pk_bf16_f32 v170, v164, v165
v_cvt_pk_bf16_f32 v171, v166, v167
ds_write_b64 v65, v[168:169] offset:2048
ds_write_b64 v65, v[170:171] offset:20480
s_waitcnt vmcnt(26)
v_mfma_f32_16x16x32_bf16 v[80:83], v[180:183], a[36:39], v[80:83]
buffer_load_dwordx4 v[176:179], v59, s[44:47], s68 offen offset:3072 sc1
v_mfma_f32_16x16x32_bf16 v[84:87], v[180:183], a[108:111], v[84:87]
v_mul_f32 v160, v104, v104
v_mul_f32 v161, v105, v105
v_mul_f32 v162, v106, v106
v_mfma_f32_16x16x32_bf16 v[88:91], v[180:183], a[180:183], v[88:91]
v_mul_f32 v163, v107, v107
v_mul_f32 v164, v108, v108
v_mul_f32 v165, v109, v109
v_mfma_f32_16x16x32_bf16 v[92:95], v[180:183], a[252:255], v[92:95]
v_mul_f32 v166, v110, v110
v_mul_f32 v167, v111, v111
v_fma_f32 v160, v160, v56, v6
s_waitcnt vmcnt(26)
v_mfma_f32_16x16x32_bf16 v[80:83], v[184:187], a[40:43], v[80:83]
s_add_u32 s68, s68, 4096
buffer_load_dwordx4 v[180:183], v59, s[44:47], s68 offen offset:0 sc1
v_mfma_f32_16x16x32_bf16 v[84:87], v[184:187], a[112:115], v[84:87]
v_fma_f32 v161, v161, v56, v6
v_fma_f32 v162, v162, v56, v6
v_fma_f32 v163, v163, v56, v6
v_fma_f32 v164, v164, v57, v7
v_mfma_f32_16x16x32_bf16 v[88:91], v[184:187], a[184:187], v[88:91]
v_fma_f32 v165, v165, v57, v7
v_fma_f32 v166, v166, v57, v7
v_fma_f32 v167, v167, v57, v7
v_mfma_f32_16x16x32_bf16 v[92:95], v[184:187], v[8:11], v[92:95]
v_mul_f32 v160, v160, v104
v_mul_f32 v161, v161, v105
v_mul_f32 v162, v162, v106
s_waitcnt vmcnt(26)
v_mfma_f32_16x16x32_bf16 v[80:83], v[252:255], a[44:47], v[80:83]
buffer_load_dwordx4 v[184:187], v59, s[44:47], s68 offen offset:1024 sc1
v_mfma_f32_16x16x32_bf16 v[84:87], v[252:255], a[116:119], v[84:87]
v_mul_f32 v163, v163, v107
v_mul_f32 v164, v164, v108
v_mul_f32 v165, v165, v109
v_mfma_f32_16x16x32_bf16 v[88:91], v[252:255], a[188:191], v[88:91]
v_mul_f32 v166, v166, v110
v_mul_f32 v167, v167, v111
v_exp_f32 v160, v160
v_mfma_f32_16x16x32_bf16 v[92:95], v[252:255], v[12:15], v[92:95]
v_exp_f32 v161, v161
s_waitcnt vmcnt(26)
v_mfma_f32_16x16x32_bf16 v[80:83], v[188:191], a[48:51], v[80:83]
buffer_load_dwordx4 v[252:255], v59, s[44:47], s68 offen offset:2048 sc1
v_mfma_f32_16x16x32_bf16 v[84:87], v[188:191], a[120:123], v[84:87]
v_exp_f32 v162, v162
v_exp_f32 v163, v163
v_mfma_f32_16x16x32_bf16 v[88:91], v[188:191], a[192:195], v[88:91]
v_exp_f32 v164, v164
v_mfma_f32_16x16x32_bf16 v[92:95], v[188:191], v[16:19], v[92:95]
v_exp_f32 v165, v165
v_exp_f32 v166, v166
s_waitcnt vmcnt(25)
v_mfma_f32_16x16x32_bf16 v[80:83], v[192:195], a[52:55], v[80:83]
buffer_load_dwordx4 v[188:191], v59, s[44:47], s68 offen offset:3072 sc1
v_mfma_f32_16x16x32_bf16 v[84:87], v[192:195], a[124:127], v[84:87]
v_exp_f32 v167, v167
v_fma_f32 v160, v160, v62, v62
v_fma_f32 v161, v161, v62, v62
v_mfma_f32_16x16x32_bf16 v[88:91], v[192:195], a[196:199], v[88:91]
v_fma_f32 v162, v162, v62, v62
v_fma_f32 v163, v163, v62, v62
v_fma_f32 v164, v164, v63, v63
v_mfma_f32_16x16x32_bf16 v[92:95], v[192:195], v[20:23], v[92:95]
v_fma_f32 v165, v165, v63, v63
v_fma_f32 v166, v166, v63, v63
v_fma_f32 v167, v167, v63, v63
s_waitcnt lgkmcnt(10)
buffer_store_dwordx4 v[128:131], v59, s[44:47], s87 offen sc0 sc1
s_waitcnt vmcnt(26)
v_mfma_f32_16x16x32_bf16 v[80:83], v[196:199], a[56:59], v[80:83]
s_add_u32 s68, s68, 4096
buffer_load_dwordx4 v[192:195], v59, s[44:47], s68 offen offset:0 sc1
v_mfma_f32_16x16x32_bf16 v[84:87], v[196:199], a[128:131], v[84:87]
v_rcp_f32 v160, v160
v_rcp_f32 v161, v161
v_mfma_f32_16x16x32_bf16 v[88:91], v[196:199], a[200:203], v[88:91]
v_rcp_f32 v162, v162
v_mfma_f32_16x16x32_bf16 v[92:95], v[196:199], v[24:27], v[92:95]
v_rcp_f32 v163, v163
v_rcp_f32 v164, v164
s_waitcnt vmcnt(26)
v_mfma_f32_16x16x32_bf16 v[80:83], v[200:203], a[60:63], v[80:83]
buffer_load_dwordx4 v[196:199], v59, s[44:47], s68 offen offset:1024 sc1
v_mfma_f32_16x16x32_bf16 v[84:87], v[200:203], a[132:135], v[84:87]
v_rcp_f32 v165, v165
v_mfma_f32_16x16x32_bf16 v[88:91], v[200:203], a[204:207], v[88:91]
v_rcp_f32 v166, v166
v_rcp_f32 v167, v167
v_mul_f32 v160, v160, v104
v_mfma_f32_16x16x32_bf16 v[92:95], v[200:203], v[28:31], v[92:95]
v_mul_f32 v161, v161, v105
v_mul_f32 v162, v162, v106
v_mul_f32 v163, v163, v107
s_waitcnt vmcnt(26)
v_mfma_f32_16x16x32_bf16 v[80:83], v[204:207], a[64:67], v[80:83]
buffer_load_dwordx4 v[200:203], v59, s[44:47], s68 offen offset:2048 sc1
v_mfma_f32_16x16x32_bf16 v[84:87], v[204:207], a[136:139], v[84:87]
v_mul_f32 v164, v164, v108
v_mul_f32 v165, v165, v109
v_mul_f32 v166, v166, v110
v_mfma_f32_16x16x32_bf16 v[88:91], v[204:207], a[208:211], v[88:91]
v_mul_f32 v167, v167, v111
v_cvt_pk_bf16_f32 v172, v160, v161
v_cvt_pk_bf16_f32 v173, v162, v163
v_mfma_f32_16x16x32_bf16 v[92:95], v[204:207], v[32:35], v[92:95]
v_cvt_pk_bf16_f32 v174, v164, v165
v_cvt_pk_bf16_f32 v175, v166, v167
ds_write_b64 v68, v[172:173] offset:2048
ds_write_b64 v68, v[174:175] offset:20480
s_waitcnt vmcnt(26)
v_mfma_f32_16x16x32_bf16 v[80:83], v[208:211], a[68:71], v[80:83]
buffer_load_dwordx4 v[204:207], v59, s[44:47], s68 offen offset:3072 sc1
v_mfma_f32_16x16x32_bf16 v[84:87], v[208:211], a[140:143], v[84:87]
v_mfma_f32_16x16x32_bf16 v[88:91], v[208:211], a[212:215], v[88:91]
v_mfma_f32_16x16x32_bf16 v[92:95], v[208:211], v[36:39], v[92:95]
s_waitcnt vmcnt(26)
v_mfma_f32_16x16x32_bf16 v[96:99], v[212:215], a[0:3], 0
s_add_u32 s68, s68, 4096
buffer_load_dwordx4 v[208:211], v59, s[44:47], s68 offen offset:0 sc1
v_mfma_f32_16x16x32_bf16 v[100:103], v[212:215], a[72:75], 0
v_mfma_f32_16x16x32_bf16 v[104:107], v[212:215], a[144:147], 0
v_mfma_f32_16x16x32_bf16 v[108:111], v[212:215], a[216:219], 0
s_waitcnt vmcnt(25)
v_mfma_f32_16x16x32_bf16 v[96:99], v[216:219], a[4:7], v[96:99]
buffer_load_dwordx4 v[212:215], v59, s[44:47], s68 offen offset:1024 sc1
v_mfma_f32_16x16x32_bf16 v[100:103], v[216:219], a[76:79], v[100:103]
v_mul_f32 v160, v80, v80
v_mul_f32 v161, v81, v81
v_mul_f32 v162, v82, v82
v_mfma_f32_16x16x32_bf16 v[104:107], v[216:219], a[148:151], v[104:107]
v_mul_f32 v163, v83, v83
v_mul_f32 v164, v84, v84
v_mul_f32 v165, v85, v85
v_mfma_f32_16x16x32_bf16 v[108:111], v[216:219], a[220:223], v[108:111]
v_mul_f32 v166, v86, v86
v_mul_f32 v167, v87, v87
v_fma_f32 v160, v160, v66, v4
s_waitcnt lgkmcnt(10)
s_add_u32 s87, s87, 423936
buffer_store_dwordx4 v[132:135], v59, s[44:47], s87 offen sc0 sc1
s_waitcnt vmcnt(26)
v_mfma_f32_16x16x32_bf16 v[96:99], v[220:223], a[8:11], v[96:99]
buffer_load_dwordx4 v[216:219], v59, s[44:47], s68 offen offset:2048 sc1
v_mfma_f32_16x16x32_bf16 v[100:103], v[220:223], a[80:83], v[100:103]
v_fma_f32 v161, v161, v66, v4
v_fma_f32 v162, v162, v66, v4
v_fma_f32 v163, v163, v66, v4
v_fma_f32 v164, v164, v75, v5
v_mfma_f32_16x16x32_bf16 v[104:107], v[220:223], a[152:155], v[104:107]
v_fma_f32 v165, v165, v75, v5
v_fma_f32 v166, v166, v75, v5
v_fma_f32 v167, v167, v75, v5
v_mfma_f32_16x16x32_bf16 v[108:111], v[220:223], a[224:227], v[108:111]
v_mul_f32 v160, v160, v80
v_mul_f32 v161, v161, v81
v_mul_f32 v162, v162, v82
s_waitcnt vmcnt(26)
v_mfma_f32_16x16x32_bf16 v[96:99], v[224:227], a[12:15], v[96:99]
buffer_load_dwordx4 v[220:223], v59, s[44:47], s68 offen offset:3072 sc1
v_mfma_f32_16x16x32_bf16 v[100:103], v[224:227], a[84:87], v[100:103]
v_mul_f32 v163, v163, v83
v_mul_f32 v164, v164, v84
v_mul_f32 v165, v165, v85
v_mfma_f32_16x16x32_bf16 v[104:107], v[224:227], a[156:159], v[104:107]
v_mul_f32 v166, v166, v86
v_mul_f32 v167, v167, v87
v_exp_f32 v160, v160
v_mfma_f32_16x16x32_bf16 v[108:111], v[224:227], a[228:231], v[108:111]
v_exp_f32 v161, v161
s_waitcnt vmcnt(26)
v_mfma_f32_16x16x32_bf16 v[96:99], v[228:231], a[16:19], v[96:99]
s_add_u32 s68, s68, 4096
buffer_load_dwordx4 v[224:227], v59, s[44:47], s68 offen offset:0 sc1
v_mfma_f32_16x16x32_bf16 v[100:103], v[228:231], a[88:91], v[100:103]
v_exp_f32 v162, v162
v_exp_f32 v163, v163
v_mfma_f32_16x16x32_bf16 v[104:107], v[228:231], a[160:163], v[104:107]
v_exp_f32 v164, v164
v_mfma_f32_16x16x32_bf16 v[108:111], v[228:231], a[232:235], v[108:111]
v_exp_f32 v165, v165
v_exp_f32 v166, v166
s_waitcnt vmcnt(26)
v_mfma_f32_16x16x32_bf16 v[96:99], v[232:235], a[20:23], v[96:99]
buffer_load_dwordx4 v[228:231], v59, s[44:47], s68 offen offset:1024 sc1
v_mfma_f32_16x16x32_bf16 v[100:103], v[232:235], a[92:95], v[100:103]
v_exp_f32 v167, v167
v_fma_f32 v160, v160, v60, v60
v_fma_f32 v161, v161, v60, v60
v_mfma_f32_16x16x32_bf16 v[104:107], v[232:235], a[164:167], v[104:107]
v_fma_f32 v162, v162, v60, v60
v_fma_f32 v163, v163, v60, v60
v_fma_f32 v164, v164, v61, v61
v_mfma_f32_16x16x32_bf16 v[108:111], v[232:235], a[236:239], v[108:111]
v_fma_f32 v165, v165, v61, v61
v_fma_f32 v166, v166, v61, v61
v_fma_f32 v167, v167, v61, v61
s_waitcnt vmcnt(26)
v_mfma_f32_16x16x32_bf16 v[96:99], v[236:239], a[24:27], v[96:99]
buffer_load_dwordx4 v[232:235], v59, s[44:47], s68 offen offset:2048 sc1
v_mfma_f32_16x16x32_bf16 v[100:103], v[236:239], a[96:99], v[100:103]
v_rcp_f32 v160, v160
v_rcp_f32 v161, v161
v_mfma_f32_16x16x32_bf16 v[104:107], v[236:239], a[168:171], v[104:107]
v_rcp_f32 v162, v162
v_mfma_f32_16x16x32_bf16 v[108:111], v[236:239], a[240:243], v[108:111]
v_rcp_f32 v163, v163
v_rcp_f32 v164, v164
s_waitcnt vmcnt(25)
v_mfma_f32_16x16x32_bf16 v[96:99], v[240:243], a[28:31], v[96:99]
buffer_load_dwordx4 v[236:239], v59, s[44:47], s68 offen offset:3072 sc1
v_mfma_f32_16x16x32_bf16 v[100:103], v[240:243], a[100:103], v[100:103]
v_rcp_f32 v165, v165
v_mfma_f32_16x16x32_bf16 v[104:107], v[240:243], a[172:175], v[104:107]
v_rcp_f32 v166, v166
v_rcp_f32 v167, v167
v_mul_f32 v160, v160, v80
v_mfma_f32_16x16x32_bf16 v[108:111], v[240:243], a[244:247], v[108:111]
v_mul_f32 v161, v161, v81
v_mul_f32 v162, v162, v82
v_mul_f32 v163, v163, v83
s_waitcnt lgkmcnt(8)
s_add_u32 s87, s87, 423936
buffer_store_dwordx4 v[136:139], v59, s[44:47], s87 offen sc0 sc1
s_waitcnt vmcnt(26)
v_mfma_f32_16x16x32_bf16 v[96:99], v[244:247], a[32:35], v[96:99]
s_add_u32 s68, s68, 4096
buffer_load_dwordx4 v[240:243], v59, s[44:47], s68 offen offset:0 sc1
v_mfma_f32_16x16x32_bf16 v[100:103], v[244:247], a[104:107], v[100:103]
v_mul_f32 v164, v164, v84
v_mul_f32 v165, v165, v85
v_mul_f32 v166, v166, v86
v_mfma_f32_16x16x32_bf16 v[104:107], v[244:247], a[176:179], v[104:107]
v_mul_f32 v167, v167, v87
v_cvt_pk_bf16_f32 v168, v160, v161
v_cvt_pk_bf16_f32 v169, v162, v163
v_mfma_f32_16x16x32_bf16 v[108:111], v[244:247], a[248:251], v[108:111]
v_cvt_pk_bf16_f32 v170, v164, v165
v_cvt_pk_bf16_f32 v171, v166, v167
ds_write_b64 v65, v[168:169] offset:4096
ds_write_b64 v65, v[170:171] offset:22528
s_waitcnt vmcnt(26)
v_mfma_f32_16x16x32_bf16 v[96:99], v[248:251], a[36:39], v[96:99]
buffer_load_dwordx4 v[244:247], v59, s[44:47], s68 offen offset:1024 sc1
v_mfma_f32_16x16x32_bf16 v[100:103], v[248:251], a[108:111], v[100:103]
v_mul_f32 v160, v88, v88
v_mul_f32 v161, v89, v89
v_mul_f32 v162, v90, v90
v_mfma_f32_16x16x32_bf16 v[104:107], v[248:251], a[180:183], v[104:107]
v_mul_f32 v163, v91, v91
v_mul_f32 v164, v92, v92
v_mul_f32 v165, v93, v93
v_mfma_f32_16x16x32_bf16 v[108:111], v[248:251], a[252:255], v[108:111]
v_mul_f32 v166, v94, v94
v_mul_f32 v167, v95, v95
v_fma_f32 v160, v160, v56, v6
s_waitcnt vmcnt(26)
v_mfma_f32_16x16x32_bf16 v[96:99], v[40:43], a[40:43], v[96:99]
buffer_load_dwordx4 v[248:251], v59, s[44:47], s68 offen offset:2048 sc1
v_mfma_f32_16x16x32_bf16 v[100:103], v[40:43], a[112:115], v[100:103]
v_fma_f32 v161, v161, v56, v6
v_fma_f32 v162, v162, v56, v6
v_fma_f32 v163, v163, v56, v6
v_fma_f32 v164, v164, v57, v7
v_mfma_f32_16x16x32_bf16 v[104:107], v[40:43], a[184:187], v[104:107]
v_fma_f32 v165, v165, v57, v7
v_fma_f32 v166, v166, v57, v7
v_fma_f32 v167, v167, v57, v7
v_mfma_f32_16x16x32_bf16 v[108:111], v[40:43], v[8:11], v[108:111]
v_mul_f32 v160, v160, v88
v_mul_f32 v161, v161, v89
v_mul_f32 v162, v162, v90
s_waitcnt vmcnt(26)
v_mfma_f32_16x16x32_bf16 v[96:99], v[44:47], a[44:47], v[96:99]
buffer_load_dwordx4 v[40:43], v59, s[44:47], s68 offen offset:3072 sc1
v_mfma_f32_16x16x32_bf16 v[100:103], v[44:47], a[116:119], v[100:103]
v_mul_f32 v163, v163, v91
v_mul_f32 v164, v164, v92
v_mul_f32 v165, v165, v93
v_mfma_f32_16x16x32_bf16 v[104:107], v[44:47], a[188:191], v[104:107]
v_mul_f32 v166, v166, v94
v_mul_f32 v167, v167, v95
v_exp_f32 v160, v160
v_mfma_f32_16x16x32_bf16 v[108:111], v[44:47], v[12:15], v[108:111]
v_exp_f32 v161, v161
s_waitcnt vmcnt(26)
v_mfma_f32_16x16x32_bf16 v[96:99], v[48:51], a[48:51], v[96:99]
s_add_u32 s68, s68, 4096
buffer_load_dwordx4 v[44:47], v59, s[44:47], s68 offen offset:0 sc1
v_mfma_f32_16x16x32_bf16 v[100:103], v[48:51], a[120:123], v[100:103]
v_exp_f32 v162, v162
v_exp_f32 v163, v163
v_mfma_f32_16x16x32_bf16 v[104:107], v[48:51], a[192:195], v[104:107]
v_exp_f32 v164, v164
v_mfma_f32_16x16x32_bf16 v[108:111], v[48:51], v[16:19], v[108:111]
v_exp_f32 v165, v165
v_exp_f32 v166, v166
s_waitcnt vmcnt(25)
v_mfma_f32_16x16x32_bf16 v[96:99], v[52:55], a[52:55], v[96:99]
buffer_load_dwordx4 v[48:51], v59, s[44:47], s68 offen offset:1024 sc1
v_mfma_f32_16x16x32_bf16 v[100:103], v[52:55], a[124:127], v[100:103]
v_exp_f32 v167, v167
v_fma_f32 v160, v160, v62, v62
v_fma_f32 v161, v161, v62, v62
v_mfma_f32_16x16x32_bf16 v[104:107], v[52:55], a[196:199], v[104:107]
v_fma_f32 v162, v162, v62, v62
v_fma_f32 v163, v163, v62, v62
v_fma_f32 v164, v164, v63, v63
v_mfma_f32_16x16x32_bf16 v[108:111], v[52:55], v[20:23], v[108:111]
v_fma_f32 v165, v165, v63, v63
v_fma_f32 v166, v166, v63, v63
v_fma_f32 v167, v167, v63, v63
s_waitcnt lgkmcnt(8)
s_add_u32 s87, s87, 423936
buffer_store_dwordx4 v[140:143], v59, s[44:47], s87 offen sc0 sc1
s_waitcnt vmcnt(26)
v_mfma_f32_16x16x32_bf16 v[96:99], v[176:179], a[56:59], v[96:99]
buffer_load_dwordx4 v[52:55], v59, s[44:47], s68 offen offset:2048 sc1
v_mfma_f32_16x16x32_bf16 v[100:103], v[176:179], a[128:131], v[100:103]
v_rcp_f32 v160, v160
v_rcp_f32 v161, v161
v_mfma_f32_16x16x32_bf16 v[104:107], v[176:179], a[200:203], v[104:107]
v_rcp_f32 v162, v162
v_mfma_f32_16x16x32_bf16 v[108:111], v[176:179], v[24:27], v[108:111]
v_rcp_f32 v163, v163
v_rcp_f32 v164, v164
s_waitcnt vmcnt(26)
v_mfma_f32_16x16x32_bf16 v[96:99], v[180:183], a[60:63], v[96:99]
buffer_load_dwordx4 v[176:179], v59, s[44:47], s68 offen offset:3072 sc1
v_mfma_f32_16x16x32_bf16 v[100:103], v[180:183], a[132:135], v[100:103]
v_rcp_f32 v165, v165
v_mfma_f32_16x16x32_bf16 v[104:107], v[180:183], a[204:207], v[104:107]
v_rcp_f32 v166, v166
v_rcp_f32 v167, v167
v_mul_f32 v160, v160, v88
v_mfma_f32_16x16x32_bf16 v[108:111], v[180:183], v[28:31], v[108:111]
v_mul_f32 v161, v161, v89
v_mul_f32 v162, v162, v90
v_mul_f32 v163, v163, v91
s_waitcnt vmcnt(26)
v_mfma_f32_16x16x32_bf16 v[96:99], v[184:187], a[64:67], v[96:99]
s_add_u32 s68, s68, 4096
buffer_load_dwordx4 v[180:183], v59, s[44:47], s68 offen offset:0 sc1
v_mfma_f32_16x16x32_bf16 v[100:103], v[184:187], a[136:139], v[100:103]
v_mul_f32 v164, v164, v92
v_mul_f32 v165, v165, v93
v_mul_f32 v166, v166, v94
v_mfma_f32_16x16x32_bf16 v[104:107], v[184:187], a[208:211], v[104:107]
v_mul_f32 v167, v167, v95
v_cvt_pk_bf16_f32 v172, v160, v161
v_cvt_pk_bf16_f32 v173, v162, v163
v_mfma_f32_16x16x32_bf16 v[108:111], v[184:187], v[32:35], v[108:111]
v_cvt_pk_bf16_f32 v174, v164, v165
v_cvt_pk_bf16_f32 v175, v166, v167
ds_write_b64 v68, v[172:173] offset:4096
ds_write_b64 v68, v[174:175] offset:22528
s_waitcnt vmcnt(26)
v_mfma_f32_16x16x32_bf16 v[96:99], v[252:255], a[68:71], v[96:99]
buffer_load_dwordx4 v[184:187], v59, s[44:47], s68 offen offset:1024 sc1
v_mfma_f32_16x16x32_bf16 v[100:103], v[252:255], a[140:143], v[100:103]
v_mfma_f32_16x16x32_bf16 v[104:107], v[252:255], a[212:215], v[104:107]
v_mfma_f32_16x16x32_bf16 v[108:111], v[252:255], v[36:39], v[108:111]
s_waitcnt vmcnt(26)
v_mfma_f32_16x16x32_bf16 v[80:83], v[188:191], a[0:3], 0
buffer_load_dwordx4 v[252:255], v59, s[44:47], s68 offen offset:2048 sc1
v_mfma_f32_16x16x32_bf16 v[84:87], v[188:191], a[72:75], 0
v_mfma_f32_16x16x32_bf16 v[88:91], v[188:191], a[144:147], 0
v_mfma_f32_16x16x32_bf16 v[92:95], v[188:191], a[216:219], 0
s_waitcnt vmcnt(25)
v_mfma_f32_16x16x32_bf16 v[80:83], v[192:195], a[4:7], v[80:83]
buffer_load_dwordx4 v[188:191], v59, s[44:47], s68 offen offset:3072 sc1
v_mfma_f32_16x16x32_bf16 v[84:87], v[192:195], a[76:79], v[84:87]
v_mul_f32 v160, v96, v96
v_mul_f32 v161, v97, v97
v_mul_f32 v162, v98, v98
v_mfma_f32_16x16x32_bf16 v[88:91], v[192:195], a[148:151], v[88:91]
v_mul_f32 v163, v99, v99
v_mul_f32 v164, v100, v100
v_mul_f32 v165, v101, v101
v_mfma_f32_16x16x32_bf16 v[92:95], v[192:195], a[220:223], v[92:95]
v_mul_f32 v166, v102, v102
v_mul_f32 v167, v103, v103
v_fma_f32 v160, v160, v66, v4
s_waitcnt vmcnt(25)
v_mfma_f32_16x16x32_bf16 v[80:83], v[196:199], a[8:11], v[80:83]
s_add_u32 s68, s68, 4096
buffer_load_dwordx4 v[192:195], v59, s[44:47], s68 offen offset:0 sc1
v_mfma_f32_16x16x32_bf16 v[84:87], v[196:199], a[80:83], v[84:87]
v_fma_f32 v161, v161, v66, v4
v_fma_f32 v162, v162, v66, v4
v_fma_f32 v163, v163, v66, v4
v_fma_f32 v164, v164, v75, v5
v_mfma_f32_16x16x32_bf16 v[88:91], v[196:199], a[152:155], v[88:91]
v_fma_f32 v165, v165, v75, v5
v_fma_f32 v166, v166, v75, v5
v_fma_f32 v167, v167, v75, v5
v_mfma_f32_16x16x32_bf16 v[92:95], v[196:199], a[224:227], v[92:95]
v_mul_f32 v160, v160, v96
v_mul_f32 v161, v161, v97
v_mul_f32 v162, v162, v98
s_waitcnt vmcnt(25)
v_mfma_f32_16x16x32_bf16 v[80:83], v[200:203], a[12:15], v[80:83]
buffer_load_dwordx4 v[196:199], v59, s[44:47], s68 offen offset:1024 sc1
v_mfma_f32_16x16x32_bf16 v[84:87], v[200:203], a[84:87], v[84:87]
v_mul_f32 v163, v163, v99
v_mul_f32 v164, v164, v100
v_mul_f32 v165, v165, v101
v_mfma_f32_16x16x32_bf16 v[88:91], v[200:203], a[156:159], v[88:91]
v_mul_f32 v166, v166, v102
v_mul_f32 v167, v167, v103
v_exp_f32 v160, v160
v_mfma_f32_16x16x32_bf16 v[92:95], v[200:203], a[228:231], v[92:95]
v_exp_f32 v161, v161
s_waitcnt vmcnt(25)
v_mfma_f32_16x16x32_bf16 v[80:83], v[204:207], a[16:19], v[80:83]
buffer_load_dwordx4 v[200:203], v59, s[44:47], s68 offen offset:2048 sc1
v_mfma_f32_16x16x32_bf16 v[84:87], v[204:207], a[88:91], v[84:87]
v_exp_f32 v162, v162
v_exp_f32 v163, v163
v_mfma_f32_16x16x32_bf16 v[88:91], v[204:207], a[160:163], v[88:91]
v_exp_f32 v164, v164
v_mfma_f32_16x16x32_bf16 v[92:95], v[204:207], a[232:235], v[92:95]
v_exp_f32 v165, v165
v_exp_f32 v166, v166
s_waitcnt vmcnt(25)
v_mfma_f32_16x16x32_bf16 v[80:83], v[208:211], a[20:23], v[80:83]
buffer_load_dwordx4 v[204:207], v59, s[44:47], s68 offen offset:3072 sc1
v_mfma_f32_16x16x32_bf16 v[84:87], v[208:211], a[92:95], v[84:87]
v_exp_f32 v167, v167
v_fma_f32 v160, v160, v60, v60
v_fma_f32 v161, v161, v60, v60
v_mfma_f32_16x16x32_bf16 v[88:91], v[208:211], a[164:167], v[88:91]
v_fma_f32 v162, v162, v60, v60
v_fma_f32 v163, v163, v60, v60
v_fma_f32 v164, v164, v61, v61
v_mfma_f32_16x16x32_bf16 v[92:95], v[208:211], a[236:239], v[92:95]
v_fma_f32 v165, v165, v61, v61
v_fma_f32 v166, v166, v61, v61
v_fma_f32 v167, v167, v61, v61
s_waitcnt vmcnt(25)
v_mfma_f32_16x16x32_bf16 v[80:83], v[212:215], a[24:27], v[80:83]
s_add_u32 s68, s68, 4096
buffer_load_dwordx4 v[208:211], v59, s[44:47], s68 offen offset:0 sc1
v_mfma_f32_16x16x32_bf16 v[84:87], v[212:215], a[96:99], v[84:87]
v_rcp_f32 v160, v160
v_rcp_f32 v161, v161
v_mfma_f32_16x16x32_bf16 v[88:91], v[212:215], a[168:171], v[88:91]
v_rcp_f32 v162, v162
v_mfma_f32_16x16x32_bf16 v[92:95], v[212:215], a[240:243], v[92:95]
v_rcp_f32 v163, v163
v_rcp_f32 v164, v164
s_waitcnt vmcnt(24)
v_mfma_f32_16x16x32_bf16 v[80:83], v[216:219], a[28:31], v[80:83]
buffer_load_dwordx4 v[212:215], v59, s[44:47], s68 offen offset:1024 sc1
v_mfma_f32_16x16x32_bf16 v[84:87], v[216:219], a[100:103], v[84:87]
v_rcp_f32 v165, v165
v_mfma_f32_16x16x32_bf16 v[88:91], v[216:219], a[172:175], v[88:91]
v_rcp_f32 v166, v166
v_rcp_f32 v167, v167
v_mul_f32 v160, v160, v96
v_mfma_f32_16x16x32_bf16 v[92:95], v[216:219], a[244:247], v[92:95]
v_mul_f32 v161, v161, v97
v_mul_f32 v162, v162, v98
v_mul_f32 v163, v163, v99
s_waitcnt vmcnt(24)
v_mfma_f32_16x16x32_bf16 v[80:83], v[220:223], a[32:35], v[80:83]
buffer_load_dwordx4 v[216:219], v59, s[44:47], s68 offen offset:2048 sc1
v_mfma_f32_16x16x32_bf16 v[84:87], v[220:223], a[104:107], v[84:87]
v_mul_f32 v164, v164, v100
v_mul_f32 v165, v165, v101
v_mul_f32 v166, v166, v102
v_mfma_f32_16x16x32_bf16 v[88:91], v[220:223], a[176:179], v[88:91]
v_mul_f32 v167, v167, v103
v_cvt_pk_bf16_f32 v168, v160, v161
v_cvt_pk_bf16_f32 v169, v162, v163
v_mfma_f32_16x16x32_bf16 v[92:95], v[220:223], a[248:251], v[92:95]
v_cvt_pk_bf16_f32 v170, v164, v165
v_cvt_pk_bf16_f32 v171, v166, v167
ds_write_b64 v65, v[168:169] offset:6144
ds_write_b64 v65, v[170:171] offset:24576
s_waitcnt vmcnt(24)
v_mfma_f32_16x16x32_bf16 v[80:83], v[224:227], a[36:39], v[80:83]
buffer_load_dwordx4 v[220:223], v59, s[44:47], s68 offen offset:3072 sc1
v_mfma_f32_16x16x32_bf16 v[84:87], v[224:227], a[108:111], v[84:87]
v_mul_f32 v160, v104, v104
v_mul_f32 v161, v105, v105
v_mul_f32 v162, v106, v106
v_mfma_f32_16x16x32_bf16 v[88:91], v[224:227], a[180:183], v[88:91]
v_mul_f32 v163, v107, v107
v_mul_f32 v164, v108, v108
v_mul_f32 v165, v109, v109
v_mfma_f32_16x16x32_bf16 v[92:95], v[224:227], a[252:255], v[92:95]
v_mul_f32 v166, v110, v110
v_mul_f32 v167, v111, v111
v_fma_f32 v160, v160, v56, v6
s_waitcnt vmcnt(24)
v_mfma_f32_16x16x32_bf16 v[80:83], v[228:231], a[40:43], v[80:83]
s_add_u32 s68, s68, 4096
buffer_load_dwordx4 v[224:227], v59, s[44:47], s68 offen offset:0 sc1
v_mfma_f32_16x16x32_bf16 v[84:87], v[228:231], a[112:115], v[84:87]
v_fma_f32 v161, v161, v56, v6
v_fma_f32 v162, v162, v56, v6
v_fma_f32 v163, v163, v56, v6
v_fma_f32 v164, v164, v57, v7
v_mfma_f32_16x16x32_bf16 v[88:91], v[228:231], a[184:187], v[88:91]
v_fma_f32 v165, v165, v57, v7
v_fma_f32 v166, v166, v57, v7
v_fma_f32 v167, v167, v57, v7
v_mfma_f32_16x16x32_bf16 v[92:95], v[228:231], v[8:11], v[92:95]
v_mul_f32 v160, v160, v104
v_mul_f32 v161, v161, v105
v_mul_f32 v162, v162, v106
s_waitcnt vmcnt(24)
v_mfma_f32_16x16x32_bf16 v[80:83], v[232:235], a[44:47], v[80:83]
buffer_load_dwordx4 v[228:231], v59, s[44:47], s68 offen offset:1024 sc1
v_mfma_f32_16x16x32_bf16 v[84:87], v[232:235], a[116:119], v[84:87]
v_mul_f32 v163, v163, v107
v_mul_f32 v164, v164, v108
v_mul_f32 v165, v165, v109
v_mfma_f32_16x16x32_bf16 v[88:91], v[232:235], a[188:191], v[88:91]
v_mul_f32 v166, v166, v110
v_mul_f32 v167, v167, v111
v_exp_f32 v160, v160
v_mfma_f32_16x16x32_bf16 v[92:95], v[232:235], v[12:15], v[92:95]
v_exp_f32 v161, v161
s_waitcnt vmcnt(16)
s_barrier
s_cmp_lg_u32 s50, 0
s_cbranch_scc1 L_nofl_19
v_mov_b32 v2, s51
s_mov_b64 exec, 1
s_lshl_b32 s52, s49, 5
s_add_u32 s52, s52, s48
s_lshl_b32 s52, s52, 2
s_add_u32 s52, s52, 37957632
v_mov_b32 v1, s52
buffer_store_dword v2, v1, s[44:47], 0 offen sc0 sc1
s_mov_b64 exec, -1
L_nofl_19:
v_mfma_f32_16x16x32_bf16 v[80:83], v[236:239], a[48:51], v[80:83]
buffer_load_dwordx4 v[232:235], v59, s[44:47], s68 offen offset:2048 sc1
v_mfma_f32_16x16x32_bf16 v[84:87], v[236:239], a[120:123], v[84:87]
v_exp_f32 v162, v162
v_exp_f32 v163, v163
v_mfma_f32_16x16x32_bf16 v[88:91], v[236:239], a[192:195], v[88:91]
v_exp_f32 v164, v164
v_mfma_f32_16x16x32_bf16 v[92:95], v[236:239], v[16:19], v[92:95]
v_exp_f32 v165, v165
v_exp_f32 v166, v166
v_mfma_f32_16x16x32_bf16 v[80:83], v[240:243], a[52:55], v[80:83]
buffer_load_dwordx4 v[236:239], v59, s[44:47], s68 offen offset:3072 sc1
v_mfma_f32_16x16x32_bf16 v[84:87], v[240:243], a[124:127], v[84:87]
v_exp_f32 v167, v167
v_fma_f32 v160, v160, v62, v62
v_fma_f32 v161, v161, v62, v62
v_mfma_f32_16x16x32_bf16 v[88:91], v[240:243], a[196:199], v[88:91]
v_fma_f32 v162, v162, v62, v62
v_fma_f32 v163, v163, v62, v62
v_fma_f32 v164, v164, v63, v63
v_mfma_f32_16x16x32_bf16 v[92:95], v[240:243], v[20:23], v[92:95]
v_fma_f32 v165, v165, v63, v63
v_fma_f32 v166, v166, v63, v63
v_fma_f32 v167, v167, v63, v63
v_mfma_f32_16x16x32_bf16 v[80:83], v[244:247], a[56:59], v[80:83]
s_add_u32 s68, s68, 4096
buffer_load_dwordx4 v[240:243], v59, s[44:47], s68 offen offset:0 sc1
v_mfma_f32_16x16x32_bf16 v[84:87], v[244:247], a[128:131], v[84:87]
v_rcp_f32 v160, v160
v_rcp_f32 v161, v161
v_mfma_f32_16x16x32_bf16 v[88:91], v[244:247], a[200:203], v[88:91]
v_rcp_f32 v162, v162
v_mfma_f32_16x16x32_bf16 v[92:95], v[244:247], v[24:27], v[92:95]
v_rcp_f32 v163, v163
v_rcp_f32 v164, v164
v_mfma_f32_16x16x32_bf16 v[80:83], v[248:251], a[60:63], v[80:83]
buffer_load_dwordx4 v[244:247], v59, s[44:47], s68 offen offset:1024 sc1
v_mfma_f32_16x16x32_bf16 v[84:87], v[248:251], a[132:135], v[84:87]
v_rcp_f32 v165, v165
v_mfma_f32_16x16x32_bf16 v[88:91], v[248:251], a[204:207], v[88:91]
v_rcp_f32 v166, v166
v_rcp_f32 v167, v167
v_mul_f32 v160, v160, v104
v_mfma_f32_16x16x32_bf16 v[92:95], v[248:251], v[28:31], v[92:95]
v_mul_f32 v161, v161, v105
v_mul_f32 v162, v162, v106
v_mul_f32 v163, v163, v107
v_mfma_f32_16x16x32_bf16 v[80:83], v[40:43], a[64:67], v[80:83]
buffer_load_dwordx4 v[248:251], v59, s[44:47], s68 offen offset:2048 sc1
v_mfma_f32_16x16x32_bf16 v[84:87], v[40:43], a[136:139], v[84:87]
v_mul_f32 v164, v164, v108
v_mul_f32 v165, v165, v109
v_mul_f32 v166, v166, v110
v_mfma_f32_16x16x32_bf16 v[88:91], v[40:43], a[208:211], v[88:91]
v_mul_f32 v167, v167, v111
v_cvt_pk_bf16_f32 v172, v160, v161
v_cvt_pk_bf16_f32 v173, v162, v163
v_mfma_f32_16x16x32_bf16 v[92:95], v[40:43], v[32:35], v[92:95]
v_cvt_pk_bf16_f32 v174, v164, v165
v_cvt_pk_bf16_f32 v175, v166, v167
ds_write_b64 v68, v[172:173] offset:6144
ds_write_b64 v68, v[174:175] offset:24576
v_mfma_f32_16x16x32_bf16 v[80:83], v[44:47], a[68:71], v[80:83]
buffer_load_dwordx4 v[40:43], v59, s[44:47], s68 offen offset:3072 sc1
v_mfma_f32_16x16x32_bf16 v[84:87], v[44:47], a[140:143], v[84:87]
v_mfma_f32_16x16x32_bf16 v[88:91], v[44:47], a[212:215], v[88:91]
v_mfma_f32_16x16x32_bf16 v[92:95], v[44:47], v[36:39], v[92:95]
v_mfma_f32_16x16x32_bf16 v[96:99], v[48:51], a[0:3], 0
s_add_u32 s68, s68, 4096
buffer_load_dwordx4 v[44:47], v59, s[44:47], s68 offen offset:0 sc1
v_mfma_f32_16x16x32_bf16 v[100:103], v[48:51], a[72:75], 0
v_mfma_f32_16x16x32_bf16 v[104:107], v[48:51], a[144:147], 0
v_mfma_f32_16x16x32_bf16 v[108:111], v[48:51], a[216:219], 0
s_waitcnt vmcnt(22)
v_mfma_f32_16x16x32_bf16 v[96:99], v[52:55], a[4:7], v[96:99]
buffer_load_dwordx4 v[48:51], v59, s[44:47], s68 offen offset:1024 sc1
v_mfma_f32_16x16x32_bf16 v[100:103], v[52:55], a[76:79], v[100:103]
v_mul_f32 v160, v80, v80
v_mul_f32 v161, v81, v81
v_mul_f32 v162, v82, v82
v_mfma_f32_16x16x32_bf16 v[104:107], v[52:55], a[148:151], v[104:107]
v_mul_f32 v163, v83, v83
v_mul_f32 v164, v84, v84
v_mul_f32 v165, v85, v85
v_mfma_f32_16x16x32_bf16 v[108:111], v[52:55], a[220:223], v[108:111]
v_mul_f32 v166, v86, v86
v_mul_f32 v167, v87, v87
v_fma_f32 v160, v160, v66, v4
s_waitcnt vmcnt(22)
v_mfma_f32_16x16x32_bf16 v[96:99], v[176:179], a[8:11], v[96:99]
buffer_load_dwordx4 v[52:55], v59, s[44:47], s68 offen offset:2048 sc1
v_mfma_f32_16x16x32_bf16 v[100:103], v[176:179], a[80:83], v[100:103]
v_fma_f32 v161, v161, v66, v4
v_fma_f32 v162, v162, v66, v4
v_fma_f32 v163, v163, v66, v4
v_fma_f32 v164, v164, v75, v5
v_mfma_f32_16x16x32_bf16 v[104:107], v[176:179], a[152:155], v[104:107]
v_fma_f32 v165, v165, v75, v5
v_fma_f32 v166, v166, v75, v5
v_fma_f32 v167, v167, v75, v5
v_mfma_f32_16x16x32_bf16 v[108:111], v[176:179], a[224:227], v[108:111]
v_mul_f32 v160, v160, v80
v_mul_f32 v161, v161, v81
v_mul_f32 v162, v162, v82
s_waitcnt vmcnt(22)
v_mfma_f32_16x16x32_bf16 v[96:99], v[180:183], a[12:15], v[96:99]
buffer_load_dwordx4 v[176:179], v59, s[44:47], s68 offen offset:3072 sc1
v_mfma_f32_16x16x32_bf16 v[100:103], v[180:183], a[84:87], v[100:103]
v_mul_f32 v163, v163, v83
v_mul_f32 v164, v164, v84
v_mul_f32 v165, v165, v85
v_mfma_f32_16x16x32_bf16 v[104:107], v[180:183], a[156:159], v[104:107]
v_mul_f32 v166, v166, v86
v_mul_f32 v167, v167, v87
v_exp_f32 v160, v160
v_mfma_f32_16x16x32_bf16 v[108:111], v[180:183], a[228:231], v[108:111]
v_exp_f32 v161, v161
s_waitcnt vmcnt(22)
v_mfma_f32_16x16x32_bf16 v[96:99], v[184:187], a[16:19], v[96:99]
s_add_u32 s68, s68, 4096
buffer_load_dwordx4 v[180:183], v59, s[44:47], s68 offen offset:0 sc1
v_mfma_f32_16x16x32_bf16 v[100:103], v[184:187], a[88:91], v[100:103]
v_exp_f32 v162, v162
v_exp_f32 v163, v163
v_mfma_f32_16x16x32_bf16 v[104:107], v[184:187], a[160:163], v[104:107]
v_exp_f32 v164, v164
v_mfma_f32_16x16x32_bf16 v[108:111], v[184:187], a[232:235], v[108:111]
v_exp_f32 v165, v165
v_exp_f32 v166, v166
s_waitcnt vmcnt(22)
v_mfma_f32_16x16x32_bf16 v[96:99], v[252:255], a[20:23], v[96:99]
buffer_load_dwordx4 v[184:187], v59, s[44:47], s68 offen offset:1024 sc1
v_mfma_f32_16x16x32_bf16 v[100:103], v[252:255], a[92:95], v[100:103]
v_exp_f32 v167, v167
v_fma_f32 v160, v160, v60, v60
v_fma_f32 v161, v161, v60, v60
v_mfma_f32_16x16x32_bf16 v[104:107], v[252:255], a[164:167], v[104:107]
v_fma_f32 v162, v162, v60, v60
v_fma_f32 v163, v163, v60, v60
v_fma_f32 v164, v164, v61, v61
v_mfma_f32_16x16x32_bf16 v[108:111], v[252:255], a[236:239], v[108:111]
v_fma_f32 v165, v165, v61, v61
v_fma_f32 v166, v166, v61, v61
v_fma_f32 v167, v167, v61, v61
s_waitcnt vmcnt(22)
v_mfma_f32_16x16x32_bf16 v[96:99], v[188:191], a[24:27], v[96:99]
buffer_load_dwordx4 v[252:255], v59, s[44:47], s68 offen offset:2048 sc1
v_mfma_f32_16x16x32_bf16 v[100:103], v[188:191], a[96:99], v[100:103]
v_rcp_f32 v160, v160
v_rcp_f32 v161, v161
v_mfma_f32_16x16x32_bf16 v[104:107], v[188:191], a[168:171], v[104:107]
v_rcp_f32 v162, v162
v_mfma_f32_16x16x32_bf16 v[108:111], v[188:191], a[240:243], v[108:111]
v_rcp_f32 v163, v163
v_rcp_f32 v164, v164
s_waitcnt vmcnt(22)
v_mfma_f32_16x16x32_bf16 v[96:99], v[192:195], a[28:31], v[96:99]
buffer_load_dwordx4 v[188:191], v59, s[44:47], s68 offen offset:3072 sc1
v_mfma_f32_16x16x32_bf16 v[100:103], v[192:195], a[100:103], v[100:103]
v_rcp_f32 v165, v165
v_mfma_f32_16x16x32_bf16 v[104:107], v[192:195], a[172:175], v[104:107]
v_rcp_f32 v166, v166
v_rcp_f32 v167, v167
v_mul_f32 v160, v160, v80
v_mfma_f32_16x16x32_bf16 v[108:111], v[192:195], a[244:247], v[108:111]
v_mul_f32 v161, v161, v81
v_mul_f32 v162, v162, v82
v_mul_f32 v163, v163, v83
s_waitcnt vmcnt(22)
v_mfma_f32_16x16x32_bf16 v[96:99], v[196:199], a[32:35], v[96:99]
s_add_u32 s68, s68, 4096
buffer_load_dwordx4 v[192:195], v59, s[44:47], s68 offen offset:0 sc1
v_mfma_f32_16x16x32_bf16 v[100:103], v[196:199], a[104:107], v[100:103]
v_mul_f32 v164, v164, v84
v_mul_f32 v165, v165, v85
v_mul_f32 v166, v166, v86
v_mfma_f32_16x16x32_bf16 v[104:107], v[196:199], a[176:179], v[104:107]
v_mul_f32 v167, v167, v87
v_cvt_pk_bf16_f32 v168, v160, v161
v_cvt_pk_bf16_f32 v169, v162, v163
v_mfma_f32_16x16x32_bf16 v[108:111], v[196:199], a[248:251], v[108:111]
v_cvt_pk_bf16_f32 v170, v164, v165
v_cvt_pk_bf16_f32 v171, v166, v167
ds_write_b64 v65, v[168:169] offset:8192
s_waitcnt lgkmcnt(13)
ds_write_b64 v65, v[170:171] offset:26624
s_waitcnt vmcnt(22)
v_mfma_f32_16x16x32_bf16 v[96:99], v[200:203], a[36:39], v[96:99]
buffer_load_dwordx4 v[196:199], v59, s[44:47], s68 offen offset:1024 sc1
v_mfma_f32_16x16x32_bf16 v[100:103], v[200:203], a[108:111], v[100:103]
v_mul_f32 v160, v88, v88
v_mul_f32 v161, v89, v89
v_mul_f32 v162, v90, v90
v_mfma_f32_16x16x32_bf16 v[104:107], v[200:203], a[180:183], v[104:107]
v_mul_f32 v163, v91, v91
v_mul_f32 v164, v92, v92
v_mul_f32 v165, v93, v93
v_mfma_f32_16x16x32_bf16 v[108:111], v[200:203], a[252:255], v[108:111]
v_mul_f32 v166, v94, v94
v_mul_f32 v167, v95, v95
v_fma_f32 v160, v160, v56, v6
s_waitcnt vmcnt(22)
v_mfma_f32_16x16x32_bf16 v[96:99], v[204:207], a[40:43], v[96:99]
buffer_load_dwordx4 v[200:203], v59, s[44:47], s68 offen offset:2048 sc1
v_mfma_f32_16x16x32_bf16 v[100:103], v[204:207], a[112:115], v[100:103]
v_fma_f32 v161, v161, v56, v6
v_fma_f32 v162, v162, v56, v6
v_fma_f32 v163, v163, v56, v6
v_fma_f32 v164, v164, v57, v7
v_mfma_f32_16x16x32_bf16 v[104:107], v[204:207], a[184:187], v[104:107]
v_fma_f32 v165, v165, v57, v7
v_fma_f32 v166, v166, v57, v7
v_fma_f32 v167, v167, v57, v7
v_mfma_f32_16x16x32_bf16 v[108:111], v[204:207], v[8:11], v[108:111]
v_mul_f32 v160, v160, v88
v_mul_f32 v161, v161, v89
v_mul_f32 v162, v162, v90
s_waitcnt vmcnt(22)
v_mfma_f32_16x16x32_bf16 v[96:99], v[208:211], a[44:47], v[96:99]
buffer_load_dwordx4 v[204:207], v59, s[44:47], s68 offen offset:3072 sc1
v_mfma_f32_16x16x32_bf16 v[100:103], v[208:211], a[116:119], v[100:103]
v_mul_f32 v163, v163, v91
v_mul_f32 v164, v164, v92
v_mul_f32 v165, v165, v93
v_mfma_f32_16x16x32_bf16 v[104:107], v[208:211], a[188:191], v[104:107]
v_mul_f32 v166, v166, v94
v_mul_f32 v167, v167, v95
v_exp_f32 v160, v160
v_mfma_f32_16x16x32_bf16 v[108:111], v[208:211], v[12:15], v[108:111]
v_exp_f32 v161, v161
s_waitcnt vmcnt(22)
v_mfma_f32_16x16x32_bf16 v[96:99], v[212:215], a[48:51], v[96:99]
s_add_u32 s68, s68, 4096
buffer_load_dwordx4 v[208:211], v59, s[44:47], s68 offen offset:0 sc1
v_mfma_f32_16x16x32_bf16 v[100:103], v[212:215], a[120:123], v[100:103]
v_exp_f32 v162, v162
v_exp_f32 v163, v163
v_mfma_f32_16x16x32_bf16 v[104:107], v[212:215], a[192:195], v[104:107]
v_exp_f32 v164, v164
v_mfma_f32_16x16x32_bf16 v[108:111], v[212:215], v[16:19], v[108:111]
v_exp_f32 v165, v165
v_exp_f32 v166, v166
s_waitcnt vmcnt(22)
v_mfma_f32_16x16x32_bf16 v[96:99], v[216:219], a[52:55], v[96:99]
buffer_load_dwordx4 v[212:215], v59, s[44:47], s68 offen offset:1024 sc1
v_mfma_f32_16x16x32_bf16 v[100:103], v[216:219], a[124:127], v[100:103]
v_exp_f32 v167, v167
v_fma_f32 v160, v160, v62, v62
v_fma_f32 v161, v161, v62, v62
v_mfma_f32_16x16x32_bf16 v[104:107], v[216:219], a[196:199], v[104:107]
v_fma_f32 v162, v162, v62, v62
v_fma_f32 v163, v163, v62, v62
v_fma_f32 v164, v164, v63, v63
v_mfma_f32_16x16x32_bf16 v[108:111], v[216:219], v[20:23], v[108:111]
v_fma_f32 v165, v165, v63, v63
v_fma_f32 v166, v166, v63, v63
v_fma_f32 v167, v167, v63, v63
s_waitcnt vmcnt(22)
v_mfma_f32_16x16x32_bf16 v[96:99], v[220:223], a[56:59], v[96:99]
buffer_load_dwordx4 v[216:219], v59, s[44:47], s68 offen offset:2048 sc1
v_mfma_f32_16x16x32_bf16 v[100:103], v[220:223], a[128:131], v[100:103]
v_rcp_f32 v160, v160
v_rcp_f32 v161, v161
v_mfma_f32_16x16x32_bf16 v[104:107], v[220:223], a[200:203], v[104:107]
v_rcp_f32 v162, v162
v_mfma_f32_16x16x32_bf16 v[108:111], v[220:223], v[24:27], v[108:111]
v_rcp_f32 v163, v163
v_rcp_f32 v164, v164
s_waitcnt vmcnt(22)
v_mfma_f32_16x16x32_bf16 v[96:99], v[224:227], a[60:63], v[96:99]
buffer_load_dwordx4 v[220:223], v59, s[44:47], s68 offen offset:3072 sc1
v_mfma_f32_16x16x32_bf16 v[100:103], v[224:227], a[132:135], v[100:103]
v_rcp_f32 v165, v165
v_mfma_f32_16x16x32_bf16 v[104:107], v[224:227], a[204:207], v[104:107]
v_rcp_f32 v166, v166
v_rcp_f32 v167, v167
v_mul_f32 v160, v160, v88
v_mfma_f32_16x16x32_bf16 v[108:111], v[224:227], v[28:31], v[108:111]
v_mul_f32 v161, v161, v89
v_mul_f32 v162, v162, v90
v_mul_f32 v163, v163, v91
s_waitcnt vmcnt(22)
v_mfma_f32_16x16x32_bf16 v[96:99], v[228:231], a[64:67], v[96:99]
s_add_u32 s68, s68, 4096
buffer_load_dwordx4 v[224:227], v59, s[44:47], s68 offen offset:0 sc1
v_mfma_f32_16x16x32_bf16 v[100:103], v[228:231], a[136:139], v[100:103]
v_mul_f32 v164, v164, v92
v_mul_f32 v165, v165, v93
v_mul_f32 v166, v166, v94
v_mfma_f32_16x16x32_bf16 v[104:107], v[228:231], a[208:211], v[104:107]
v_mul_f32 v167, v167, v95
v_cvt_pk_bf16_f32 v172, v160, v161
v_cvt_pk_bf16_f32 v173, v162, v163
v_mfma_f32_16x16x32_bf16 v[108:111], v[228:231], v[32:35], v[108:111]
v_cvt_pk_bf16_f32 v174, v164, v165
v_cvt_pk_bf16_f32 v175, v166, v167
ds_write_b64 v68, v[172:173] offset:8192
s_waitcnt lgkmcnt(13)
ds_write_b64 v68, v[174:175] offset:26624
s_waitcnt vmcnt(22)
v_mfma_f32_16x16x32_bf16 v[96:99], v[232:235], a[68:71], v[96:99]
buffer_load_dwordx4 v[228:231], v59, s[44:47], s68 offen offset:1024 sc1
v_mfma_f32_16x16x32_bf16 v[100:103], v[232:235], a[140:143], v[100:103]
v_mfma_f32_16x16x32_bf16 v[104:107], v[232:235], a[212:215], v[104:107]
v_mfma_f32_16x16x32_bf16 v[108:111], v[232:235], v[36:39], v[108:111]
s_waitcnt vmcnt(22)
v_mfma_f32_16x16x32_bf16 v[80:83], v[236:239], a[0:3], 0
buffer_load_dwordx4 v[232:235], v59, s[44:47], s68 offen offset:2048 sc1
v_mfma_f32_16x16x32_bf16 v[84:87], v[236:239], a[72:75], 0
v_mfma_f32_16x16x32_bf16 v[88:91], v[236:239], a[144:147], 0
v_mfma_f32_16x16x32_bf16 v[92:95], v[236:239], a[216:219], 0
s_waitcnt vmcnt(22)
v_mfma_f32_16x16x32_bf16 v[80:83], v[240:243], a[4:7], v[80:83]
buffer_load_dwordx4 v[236:239], v59, s[44:47], s68 offen offset:3072 sc1
v_mfma_f32_16x16x32_bf16 v[84:87], v[240:243], a[76:79], v[84:87]
v_mul_f32 v160, v96, v96
v_mul_f32 v161, v97, v97
v_mul_f32 v162, v98, v98
v_mfma_f32_16x16x32_bf16 v[88:91], v[240:243], a[148:151], v[88:91]
v_mul_f32 v163, v99, v99
v_mul_f32 v164, v100, v100
v_mul_f32 v165, v101, v101
v_mfma_f32_16x16x32_bf16 v[92:95], v[240:243], a[220:223], v[92:95]
v_mul_f32 v166, v102, v102
v_mul_f32 v167, v103, v103
v_fma_f32 v160, v160, v66, v4
s_waitcnt vmcnt(22)
v_mfma_f32_16x16x32_bf16 v[80:83], v[244:247], a[8:11], v[80:83]
s_add_u32 s68, s68, 4096
buffer_load_dwordx4 v[240:243], v59, s[44:47], s68 offen offset:0 sc1
v_mfma_f32_16x16x32_bf16 v[84:87], v[244:247], a[80:83], v[84:87]
v_fma_f32 v161, v161, v66, v4
v_fma_f32 v162, v162, v66, v4
v_fma_f32 v163, v163, v66, v4
v_fma_f32 v164, v164, v75, v5
v_mfma_f32_16x16x32_bf16 v[88:91], v[244:247], a[152:155], v[88:91]
v_fma_f32 v165, v165, v75, v5
v_fma_f32 v166, v166, v75, v5
v_fma_f32 v167, v167, v75, v5
v_mfma_f32_16x16x32_bf16 v[92:95], v[244:247], a[224:227], v[92:95]
v_mul_f32 v160, v160, v96
v_mul_f32 v161, v161, v97
v_mul_f32 v162, v162, v98
s_waitcnt vmcnt(22)
v_mfma_f32_16x16x32_bf16 v[80:83], v[248:251], a[12:15], v[80:83]
buffer_load_dwordx4 v[244:247], v59, s[44:47], s68 offen offset:1024 sc1
v_mfma_f32_16x16x32_bf16 v[84:87], v[248:251], a[84:87], v[84:87]
v_mul_f32 v163, v163, v99
v_mul_f32 v164, v164, v100
v_mul_f32 v165, v165, v101
v_mfma_f32_16x16x32_bf16 v[88:91], v[248:251], a[156:159], v[88:91]
v_mul_f32 v166, v166, v102
v_mul_f32 v167, v167, v103
v_exp_f32 v160, v160
v_mfma_f32_16x16x32_bf16 v[92:95], v[248:251], a[228:231], v[92:95]
v_exp_f32 v161, v161
s_waitcnt vmcnt(22)
v_mfma_f32_16x16x32_bf16 v[80:83], v[40:43], a[16:19], v[80:83]
buffer_load_dwordx4 v[248:251], v59, s[44:47], s68 offen offset:2048 sc1
v_mfma_f32_16x16x32_bf16 v[84:87], v[40:43], a[88:91], v[84:87]
v_exp_f32 v162, v162
v_exp_f32 v163, v163
v_mfma_f32_16x16x32_bf16 v[88:91], v[40:43], a[160:163], v[88:91]
v_exp_f32 v164, v164
v_mfma_f32_16x16x32_bf16 v[92:95], v[40:43], a[232:235], v[92:95]
v_exp_f32 v165, v165
v_exp_f32 v166, v166
s_waitcnt vmcnt(22)
v_mfma_f32_16x16x32_bf16 v[80:83], v[44:47], a[20:23], v[80:83]
buffer_load_dwordx4 v[40:43], v59, s[44:47], s68 offen offset:3072 sc1
v_mfma_f32_16x16x32_bf16 v[84:87], v[44:47], a[92:95], v[84:87]
v_exp_f32 v167, v167
v_fma_f32 v160, v160, v60, v60
v_fma_f32 v161, v161, v60, v60
v_mfma_f32_16x16x32_bf16 v[88:91], v[44:47], a[164:167], v[88:91]
v_fma_f32 v162, v162, v60, v60
v_fma_f32 v163, v163, v60, v60
v_fma_f32 v164, v164, v61, v61
v_mfma_f32_16x16x32_bf16 v[92:95], v[44:47], a[236:239], v[92:95]
v_fma_f32 v165, v165, v61, v61
v_fma_f32 v166, v166, v61, v61
v_fma_f32 v167, v167, v61, v61
s_waitcnt vmcnt(22)
v_mfma_f32_16x16x32_bf16 v[80:83], v[48:51], a[24:27], v[80:83]
s_add_u32 s68, s68, 4096
buffer_load_dwordx4 v[44:47], v59, s[44:47], s68 offen offset:0 sc1
v_mfma_f32_16x16x32_bf16 v[84:87], v[48:51], a[96:99], v[84:87]
v_rcp_f32 v160, v160
v_rcp_f32 v161, v161
v_mfma_f32_16x16x32_bf16 v[88:91], v[48:51], a[168:171], v[88:91]
v_rcp_f32 v162, v162
v_mfma_f32_16x16x32_bf16 v[92:95], v[48:51], a[240:243], v[92:95]
v_rcp_f32 v163, v163
v_rcp_f32 v164, v164
s_waitcnt vmcnt(22)
v_mfma_f32_16x16x32_bf16 v[80:83], v[52:55], a[28:31], v[80:83]
buffer_load_dwordx4 v[48:51], v59, s[44:47], s68 offen offset:1024 sc1
v_mfma_f32_16x16x32_bf16 v[84:87], v[52:55], a[100:103], v[84:87]
v_rcp_f32 v165, v165
v_mfma_f32_16x16x32_bf16 v[88:91], v[52:55], a[172:175], v[88:91]
v_rcp_f32 v166, v166
v_rcp_f32 v167, v167
v_mul_f32 v160, v160, v96
v_mfma_f32_16x16x32_bf16 v[92:95], v[52:55], a[244:247], v[92:95]
v_mul_f32 v161, v161, v97
v_mul_f32 v162, v162, v98
v_mul_f32 v163, v163, v99
s_waitcnt vmcnt(22)
v_mfma_f32_16x16x32_bf16 v[80:83], v[176:179], a[32:35], v[80:83]
buffer_load_dwordx4 v[52:55], v59, s[44:47], s68 offen offset:2048 sc1
v_mfma_f32_16x16x32_bf16 v[84:87], v[176:179], a[104:107], v[84:87]
v_mul_f32 v164, v164, v100
v_mul_f32 v165, v165, v101
v_mul_f32 v166, v166, v102
v_mfma_f32_16x16x32_bf16 v[88:91], v[176:179], a[176:179], v[88:91]
v_mul_f32 v167, v167, v103
v_cvt_pk_bf16_f32 v168, v160, v161
v_cvt_pk_bf16_f32 v169, v162, v163
v_mfma_f32_16x16x32_bf16 v[92:95], v[176:179], a[248:251], v[92:95]
v_cvt_pk_bf16_f32 v170, v164, v165
v_cvt_pk_bf16_f32 v171, v166, v167
ds_write_b64 v65, v[168:169] offset:10240
s_waitcnt lgkmcnt(13)
ds_write_b64 v65, v[170:171] offset:28672
s_waitcnt vmcnt(22)
v_mfma_f32_16x16x32_bf16 v[80:83], v[180:183], a[36:39], v[80:83]
buffer_load_dwordx4 v[176:179], v59, s[44:47], s68 offen offset:3072 sc1
v_mfma_f32_16x16x32_bf16 v[84:87], v[180:183], a[108:111], v[84:87]
v_mul_f32 v160, v104, v104
v_mul_f32 v161, v105, v105
v_mul_f32 v162, v106, v106
v_mfma_f32_16x16x32_bf16 v[88:91], v[180:183], a[180:183], v[88:91]
v_mul_f32 v163, v107, v107
v_mul_f32 v164, v108, v108
v_mul_f32 v165, v109, v109
v_mfma_f32_16x16x32_bf16 v[92:95], v[180:183], a[252:255], v[92:95]
v_mul_f32 v166, v110, v110
v_mul_f32 v167, v111, v111
v_fma_f32 v160, v160, v56, v6
s_waitcnt vmcnt(22)
v_mfma_f32_16x16x32_bf16 v[80:83], v[184:187], a[40:43], v[80:83]
s_add_u32 s68, s68, 4096
buffer_load_dwordx4 v[180:183], v59, s[44:47], s68 offen offset:0 sc1
v_mfma_f32_16x16x32_bf16 v[84:87], v[184:187], a[112:115], v[84:87]
v_fma_f32 v161, v161, v56, v6
v_fma_f32 v162, v162, v56, v6
v_fma_f32 v163, v163, v56, v6
v_fma_f32 v164, v164, v57, v7
v_mfma_f32_16x16x32_bf16 v[88:91], v[184:187], a[184:187], v[88:91]
v_fma_f32 v165, v165, v57, v7
v_fma_f32 v166, v166, v57, v7
v_fma_f32 v167, v167, v57, v7
v_mfma_f32_16x16x32_bf16 v[92:95], v[184:187], v[8:11], v[92:95]
v_mul_f32 v160, v160, v104
v_mul_f32 v161, v161, v105
v_mul_f32 v162, v162, v106
s_waitcnt vmcnt(22)
v_mfma_f32_16x16x32_bf16 v[80:83], v[252:255], a[44:47], v[80:83]
buffer_load_dwordx4 v[184:187], v59, s[44:47], s68 offen offset:1024 sc1
v_mfma_f32_16x16x32_bf16 v[84:87], v[252:255], a[116:119], v[84:87]
v_mul_f32 v163, v163, v107
v_mul_f32 v164, v164, v108
v_mul_f32 v165, v165, v109
v_mfma_f32_16x16x32_bf16 v[88:91], v[252:255], a[188:191], v[88:91]
v_mul_f32 v166, v166, v110
v_mul_f32 v167, v167, v111
v_exp_f32 v160, v160
v_mfma_f32_16x16x32_bf16 v[92:95], v[252:255], v[12:15], v[92:95]
v_exp_f32 v161, v161
s_waitcnt vmcnt(22)
v_mfma_f32_16x16x32_bf16 v[80:83], v[188:191], a[48:51], v[80:83]
buffer_load_dwordx4 v[252:255], v59, s[44:47], s68 offen offset:2048 sc1
v_mfma_f32_16x16x32_bf16 v[84:87], v[188:191], a[120:123], v[84:87]
v_exp_f32 v162, v162
v_exp_f32 v163, v163
v_mfma_f32_16x16x32_bf16 v[88:91], v[188:191], a[192:195], v[88:91]
v_exp_f32 v164, v164
v_mfma_f32_16x16x32_bf16 v[92:95], v[188:191], v[16:19], v[92:95]
v_exp_f32 v165, v165
v_exp_f32 v166, v166
s_waitcnt vmcnt(22)
v_mfma_f32_16x16x32_bf16 v[80:83], v[192:195], a[52:55], v[80:83]
buffer_load_dwordx4 v[188:191], v59, s[44:47], s68 offen offset:3072 sc1
v_mfma_f32_16x16x32_bf16 v[84:87], v[192:195], a[124:127], v[84:87]
v_exp_f32 v167, v167
v_fma_f32 v160, v160, v62, v62
v_fma_f32 v161, v161, v62, v62
v_mfma_f32_16x16x32_bf16 v[88:91], v[192:195], a[196:199], v[88:91]
v_fma_f32 v162, v162, v62, v62
v_fma_f32 v163, v163, v62, v62
v_fma_f32 v164, v164, v63, v63
v_mfma_f32_16x16x32_bf16 v[92:95], v[192:195], v[20:23], v[92:95]
v_fma_f32 v165, v165, v63, v63
v_fma_f32 v166, v166, v63, v63
v_fma_f32 v167, v167, v63, v63
s_waitcnt vmcnt(22)
v_mfma_f32_16x16x32_bf16 v[80:83], v[196:199], a[56:59], v[80:83]
s_add_u32 s68, s68, 4096
buffer_load_dwordx4 v[192:195], v59, s[44:47], s68 offen offset:0 sc1
v_mfma_f32_16x16x32_bf16 v[84:87], v[196:199], a[128:131], v[84:87]
v_rcp_f32 v160, v160
v_rcp_f32 v161, v161
v_mfma_f32_16x16x32_bf16 v[88:91], v[196:199], a[200:203], v[88:91]
v_rcp_f32 v162, v162
v_mfma_f32_16x16x32_bf16 v[92:95], v[196:199], v[24:27], v[92:95]
v_rcp_f32 v163, v163
v_rcp_f32 v164, v164
s_waitcnt vmcnt(22)
v_mfma_f32_16x16x32_bf16 v[80:83], v[200:203], a[60:63], v[80:83]
buffer_load_dwordx4 v[196:199], v59, s[44:47], s68 offen offset:1024 sc1
v_mfma_f32_16x16x32_bf16 v[84:87], v[200:203], a[132:135], v[84:87]
v_rcp_f32 v165, v165
v_mfma_f32_16x16x32_bf16 v[88:91], v[200:203], a[204:207], v[88:91]
v_rcp_f32 v166, v166
v_rcp_f32 v167, v167
v_mul_f32 v160, v160, v104
v_mfma_f32_16x16x32_bf16 v[92:95], v[200:203], v[28:31], v[92:95]
v_mul_f32 v161, v161, v105
v_mul_f32 v162, v162, v106
v_mul_f32 v163, v163, v107
s_waitcnt vmcnt(22)
v_mfma_f32_16x16x32_bf16 v[80:83], v[204:207], a[64:67], v[80:83]
buffer_load_dwordx4 v[200:203], v59, s[44:47], s68 offen offset:2048 sc1
v_mfma_f32_16x16x32_bf16 v[84:87], v[204:207], a[136:139], v[84:87]
v_mul_f32 v164, v164, v108
v_mul_f32 v165, v165, v109
v_mul_f32 v166, v166, v110
v_mfma_f32_16x16x32_bf16 v[88:91], v[204:207], a[208:211], v[88:91]
v_mul_f32 v167, v167, v111
v_cvt_pk_bf16_f32 v172, v160, v161
v_cvt_pk_bf16_f32 v173, v162, v163
v_mfma_f32_16x16x32_bf16 v[92:95], v[204:207], v[32:35], v[92:95]
v_cvt_pk_bf16_f32 v174, v164, v165
v_cvt_pk_bf16_f32 v175, v166, v167
ds_write_b64 v68, v[172:173] offset:10240
s_waitcnt lgkmcnt(13)
ds_write_b64 v68, v[174:175] offset:28672
s_lshl_b32 s52, s49, 7
s_add_u32 s52, s52, 37957632
v_and_b32 v1, 31, v0
v_lshl_add_u32 v76, v1, 2, s52
buffer_load_dword v77, v76, s[44:47], 0 offen sc0 sc1
s_waitcnt vmcnt(23)
v_mfma_f32_16x16x32_bf16 v[80:83], v[208:211], a[68:71], v[80:83]
buffer_load_dwordx4 v[204:207], v59, s[44:47], s68 offen offset:3072 sc1
v_mfma_f32_16x16x32_bf16 v[84:87], v[208:211], a[140:143], v[84:87]
v_mfma_f32_16x16x32_bf16 v[88:91], v[208:211], a[212:215], v[88:91]
v_mfma_f32_16x16x32_bf16 v[92:95], v[208:211], v[36:39], v[92:95]
s_waitcnt vmcnt(23)
v_mfma_f32_16x16x32_bf16 v[96:99], v[212:215], a[0:3], 0
s_add_u32 s68, s68, 4096
buffer_load_dwordx4 v[208:211], v59, s[44:47], s68 offen offset:0 sc1
v_mfma_f32_16x16x32_bf16 v[100:103], v[212:215], a[72:75], 0
v_mfma_f32_16x16x32_bf16 v[104:107], v[212:215], a[144:147], 0
v_mfma_f32_16x16x32_bf16 v[108:111], v[212:215], a[216:219], 0
s_waitcnt vmcnt(23)
v_mfma_f32_16x16x32_bf16 v[96:99], v[216:219], a[4:7], v[96:99]
buffer_load_dwordx4 v[212:215], v59, s[44:47], s68 offen offset:1024 sc1
v_mfma_f32_16x16x32_bf16 v[100:103], v[216:219], a[76:79], v[100:103]
v_mul_f32 v160, v80, v80
v_mul_f32 v161, v81, v81
v_mul_f32 v162, v82, v82
v_mfma_f32_16x16x32_bf16 v[104:107], v[216:219], a[148:151], v[104:107]
v_mul_f32 v163, v83, v83
v_mul_f32 v164, v84, v84
v_mul_f32 v165, v85, v85
v_mfma_f32_16x16x32_bf16 v[108:111], v[216:219], a[220:223], v[108:111]
v_mul_f32 v166, v86, v86
v_mul_f32 v167, v87, v87
v_fma_f32 v160, v160, v66, v4
s_waitcnt vmcnt(23)
v_mfma_f32_16x16x32_bf16 v[96:99], v[220:223], a[8:11], v[96:99]
buffer_load_dwordx4 v[216:219], v59, s[44:47], s68 offen offset:2048 sc1
v_mfma_f32_16x16x32_bf16 v[100:103], v[220:223], a[80:83], v[100:103]
v_fma_f32 v161, v161, v66, v4
v_fma_f32 v162, v162, v66, v4
v_fma_f32 v163, v163, v66, v4
v_fma_f32 v164, v164, v75, v5
v_mfma_f32_16x16x32_bf16 v[104:107], v[220:223], a[152:155], v[104:107]
v_fma_f32 v165, v165, v75, v5
v_fma_f32 v166, v166, v75, v5
v_fma_f32 v167, v167, v75, v5
v_mfma_f32_16x16x32_bf16 v[108:111], v[220:223], a[224:227], v[108:111]
v_mul_f32 v160, v160, v80
v_mul_f32 v161, v161, v81
v_mul_f32 v162, v162, v82
s_waitcnt vmcnt(23)
v_mfma_f32_16x16x32_bf16 v[96:99], v[224:227], a[12:15], v[96:99]
buffer_load_dwordx4 v[220:223], v59, s[44:47], s68 offen offset:3072 sc1
v_mfma_f32_16x16x32_bf16 v[100:103], v[224:227], a[84:87], v[100:103]
v_mul_f32 v163, v163, v83
v_mul_f32 v164, v164, v84
v_mul_f32 v165, v165, v85
v_mfma_f32_16x16x32_bf16 v[104:107], v[224:227], a[156:159], v[104:107]
v_mul_f32 v166, v166, v86
v_mul_f32 v167, v167, v87
v_exp_f32 v160, v160
v_mfma_f32_16x16x32_bf16 v[108:111], v[224:227], a[228:231], v[108:111]
v_exp_f32 v161, v161
s_waitcnt vmcnt(23)
v_mfma_f32_16x16x32_bf16 v[96:99], v[228:231], a[16:19], v[96:99]
s_add_u32 s68, s68, 4096
buffer_load_dwordx4 v[224:227], v59, s[44:47], s68 offen offset:0 sc1
v_mfma_f32_16x16x32_bf16 v[100:103], v[228:231], a[88:91], v[100:103]
v_exp_f32 v162, v162
v_exp_f32 v163, v163
v_mfma_f32_16x16x32_bf16 v[104:107], v[228:231], a[160:163], v[104:107]
v_exp_f32 v164, v164
v_mfma_f32_16x16x32_bf16 v[108:111], v[228:231], a[232:235], v[108:111]
v_exp_f32 v165, v165
v_exp_f32 v166, v166
s_waitcnt vmcnt(23)
v_mfma_f32_16x16x32_bf16 v[96:99], v[232:235], a[20:23], v[96:99]
buffer_load_dwordx4 v[228:231], v59, s[44:47], s68 offen offset:1024 sc1
v_mfma_f32_16x16x32_bf16 v[100:103], v[232:235], a[92:95], v[100:103]
v_exp_f32 v167, v167
v_fma_f32 v160, v160, v60, v60
v_fma_f32 v161, v161, v60, v60
v_mfma_f32_16x16x32_bf16 v[104:107], v[232:235], a[164:167], v[104:107]
v_fma_f32 v162, v162, v60, v60
v_fma_f32 v163, v163, v60, v60
v_fma_f32 v164, v164, v61, v61
v_mfma_f32_16x16x32_bf16 v[108:111], v[232:235], a[236:239], v[108:111]
v_fma_f32 v165, v165, v61, v61
v_fma_f32 v166, v166, v61, v61
v_fma_f32 v167, v167, v61, v61
s_waitcnt vmcnt(23)
v_mfma_f32_16x16x32_bf16 v[96:99], v[236:239], a[24:27], v[96:99]
buffer_load_dwordx4 v[232:235], v59, s[44:47], s68 offen offset:2048 sc1
v_mfma_f32_16x16x32_bf16 v[100:103], v[236:239], a[96:99], v[100:103]
v_rcp_f32 v160, v160
v_rcp_f32 v161, v161
v_mfma_f32_16x16x32_bf16 v[104:107], v[236:239], a[168:171], v[104:107]
v_rcp_f32 v162, v162
v_mfma_f32_16x16x32_bf16 v[108:111], v[236:239], a[240:243], v[108:111]
v_rcp_f32 v163, v163
v_rcp_f32 v164, v164
s_waitcnt vmcnt(23)
v_mfma_f32_16x16x32_bf16 v[96:99], v[240:243], a[28:31], v[96:99]
buffer_load_dwordx4 v[236:239], v59, s[44:47], s68 offen offset:3072 sc1
v_mfma_f32_16x16x32_bf16 v[100:103], v[240:243], a[100:103], v[100:103]
v_rcp_f32 v165, v165
v_mfma_f32_16x16x32_bf16 v[104:107], v[240:243], a[172:175], v[104:107]
v_rcp_f32 v166, v166
v_rcp_f32 v167, v167
v_mul_f32 v160, v160, v80
v_mfma_f32_16x16x32_bf16 v[108:111], v[240:243], a[244:247], v[108:111]
v_mul_f32 v161, v161, v81
v_mul_f32 v162, v162, v82
v_mul_f32 v163, v163, v83
s_waitcnt vmcnt(23)
v_mfma_f32_16x16x32_bf16 v[96:99], v[244:247], a[32:35], v[96:99]
s_add_u32 s68, s68, 4096
buffer_load_dwordx4 v[240:243], v59, s[44:47], s68 offen offset:0 sc1
v_mfma_f32_16x16x32_bf16 v[100:103], v[244:247], a[104:107], v[100:103]
v_mul_f32 v164, v164, v84
v_mul_f32 v165, v165, v85
v_mul_f32 v166, v166, v86
v_mfma_f32_16x16x32_bf16 v[104:107], v[244:247], a[176:179], v[104:107]
v_mul_f32 v167, v167, v87
v_cvt_pk_bf16_f32 v168, v160, v161
v_cvt_pk_bf16_f32 v169, v162, v163
v_mfma_f32_16x16x32_bf16 v[108:111], v[244:247], a[248:251], v[108:111]
v_cvt_pk_bf16_f32 v170, v164, v165
v_cvt_pk_bf16_f32 v171, v166, v167
ds_write_b64 v65, v[168:169] offset:12288
s_waitcnt lgkmcnt(13)
ds_write_b64 v65, v[170:171] offset:30720
s_waitcnt vmcnt(23)
v_mfma_f32_16x16x32_bf16 v[96:99], v[248:251], a[36:39], v[96:99]
buffer_load_dwordx4 v[244:247], v59, s[44:47], s68 offen offset:1024 sc1
v_mfma_f32_16x16x32_bf16 v[100:103], v[248:251], a[108:111], v[100:103]
v_mul_f32 v160, v88, v88
v_mul_f32 v161, v89, v89
v_mul_f32 v162, v90, v90
v_mfma_f32_16x16x32_bf16 v[104:107], v[248:251], a[180:183], v[104:107]
v_mul_f32 v163, v91, v91
v_mul_f32 v164, v92, v92
v_mul_f32 v165, v93, v93
v_mfma_f32_16x16x32_bf16 v[108:111], v[248:251], a[252:255], v[108:111]
v_mul_f32 v166, v94, v94
v_mul_f32 v167, v95, v95
v_fma_f32 v160, v160, v56, v6
s_waitcnt vmcnt(23)
v_mfma_f32_16x16x32_bf16 v[96:99], v[40:43], a[40:43], v[96:99]
buffer_load_dwordx4 v[248:251], v59, s[44:47], s68 offen offset:2048 sc1
v_mfma_f32_16x16x32_bf16 v[100:103], v[40:43], a[112:115], v[100:103]
v_fma_f32 v161, v161, v56, v6
v_fma_f32 v162, v162, v56, v6
v_fma_f32 v163, v163, v56, v6
v_fma_f32 v164, v164, v57, v7
v_mfma_f32_16x16x32_bf16 v[104:107], v[40:43], a[184:187], v[104:107]
v_fma_f32 v165, v165, v57, v7
v_fma_f32 v166, v166, v57, v7
v_fma_f32 v167, v167, v57, v7
v_mfma_f32_16x16x32_bf16 v[108:111], v[40:43], v[8:11], v[108:111]
v_mul_f32 v160, v160, v88
v_mul_f32 v161, v161, v89
v_mul_f32 v162, v162, v90
s_waitcnt vmcnt(12)
v_cmp_ne_u32 vcc, s51, v77
s_nop 3
s_cbranch_vccz L_fl_ok_20
s_mov_b32 s58, 100000
L_fl_poll_21:
buffer_load_dword v77, v76, s[44:47], 0 offen sc0 sc1
s_waitcnt vmcnt(0)
v_cmp_ne_u32 vcc, s51, v77
s_sub_u32 s58, s58, 1
s_cmp_eq_u32 s58, 0
s_cbranch_scc1 L_fl_ok_20
s_nop 1
s_cbranch_vccnz L_fl_poll_21
L_fl_ok_20:
v_mfma_f32_16x16x32_bf16 v[96:99], v[44:47], a[44:47], v[96:99]
buffer_load_dwordx4 v[40:43], v59, s[44:47], s68 offen offset:3072 sc1
v_mfma_f32_16x16x32_bf16 v[100:103], v[44:47], a[116:119], v[100:103]
v_mul_f32 v163, v163, v91
v_mul_f32 v164, v164, v92
v_mul_f32 v165, v165, v93
v_mfma_f32_16x16x32_bf16 v[104:107], v[44:47], a[188:191], v[104:107]
v_mul_f32 v166, v166, v94
v_mul_f32 v167, v167, v95
v_exp_f32 v160, v160
v_mfma_f32_16x16x32_bf16 v[108:111], v[44:47], v[12:15], v[108:111]
v_exp_f32 v161, v161
s_and_b32 s84, s48, 15
s_mul_i32 s84, s84, 2432
s_mul_i32 s53, s50, 423936
s_add_u32 s84, s84, s53
s_add_u32 s84, s84, s67
s_add_u32 s84, s84, 273408
v_lshlrev_b32 v74, 7, v0
s_mov_b64 exec, 524287
buffer_load_dword v78, v74, s[44:47], s84 offen sc1
s_mov_b64 exec, -1
v_mfma_f32_16x16x32_bf16 v[96:99], v[48:51], a[48:51], v[96:99]
s_add_u32 s68, s68, 4096
buffer_load_dwordx4 v[44:47], v59, s[44:47], s68 offen offset:0 sc1
v_mfma_f32_16x16x32_bf16 v[100:103], v[48:51], a[120:123], v[100:103]
v_exp_f32 v162, v162
v_exp_f32 v163, v163
v_mfma_f32_16x16x32_bf16 v[104:107], v[48:51], a[192:195], v[104:107]
v_exp_f32 v164, v164
v_mfma_f32_16x16x32_bf16 v[108:111], v[48:51], v[16:19], v[108:111]
v_exp_f32 v165, v165
v_exp_f32 v166, v166
v_mfma_f32_16x16x32_bf16 v[96:99], v[52:55], a[52:55], v[96:99]
v_mfma_f32_16x16x32_bf16 v[100:103], v[52:55], a[124:127], v[100:103]
v_exp_f32 v167, v167
v_fma_f32 v160, v160, v62, v62
v_fma_f32 v161, v161, v62, v62
v_mfma_f32_16x16x32_bf16 v[104:107], v[52:55], a[196:199], v[104:107]
v_fma_f32 v162, v162, v62, v62
v_fma_f32 v163, v163, v62, v62
v_fma_f32 v164, v164, v63, v63
v_mfma_f32_16x16x32_bf16 v[108:111], v[52:55], v[20:23], v[108:111]
v_fma_f32 v165, v165, v63, v63
v_fma_f32 v166, v166, v63, v63
v_fma_f32 v167, v167, v63, v63
v_mfma_f32_16x16x32_bf16 v[96:99], v[176:179], a[56:59], v[96:99]
v_mfma_f32_16x16x32_bf16 v[100:103], v[176:179], a[128:131], v[100:103]
v_rcp_f32 v160, v160
v_rcp_f32 v161, v161
v_mfma_f32_16x16x32_bf16 v[104:107], v[176:179], a[200:203], v[104:107]
v_rcp_f32 v162, v162
v_mfma_f32_16x16x32_bf16 v[108:111], v[176:179], v[24:27], v[108:111]
v_rcp_f32 v163, v163
v_rcp_f32 v164, v164
v_mfma_f32_16x16x32_bf16 v[96:99], v[180:183], a[60:63], v[96:99]
v_mfma_f32_16x16x32_bf16 v[100:103], v[180:183], a[132:135], v[100:103]
v_rcp_f32 v165, v165
v_mfma_f32_16x16x32_bf16 v[104:107], v[180:183], a[204:207], v[104:107]
v_rcp_f32 v166, v166
v_rcp_f32 v167, v167
v_mul_f32 v160, v160, v88
v_mfma_f32_16x16x32_bf16 v[108:111], v[180:183], v[28:31], v[108:111]
v_mul_f32 v161, v161, v89
v_mul_f32 v162, v162, v90
v_mul_f32 v163, v163, v91
v_mfma_f32_16x16x32_bf16 v[96:99], v[184:187], a[64:67], v[96:99]
v_mfma_f32_16x16x32_bf16 v[100:103], v[184:187], a[136:139], v[100:103]
v_mul_f32 v164, v164, v92
v_mul_f32 v165, v165, v93
v_mul_f32 v166, v166, v94
v_mfma_f32_16x16x32_bf16 v[104:107], v[184:187], a[208:211], v[104:107]
v_mul_f32 v167, v167, v95
v_cvt_pk_bf16_f32 v172, v160, v161
v_cvt_pk_bf16_f32 v173, v162, v163
v_mfma_f32_16x16x32_bf16 v[108:111], v[184:187], v[32:35], v[108:111]
v_cvt_pk_bf16_f32 v174, v164, v165
v_cvt_pk_bf16_f32 v175, v166, v167
ds_write_b64 v68, v[172:173] offset:12288
s_waitcnt lgkmcnt(13)
ds_write_b64 v68, v[174:175] offset:30720
v_mfma_f32_16x16x32_bf16 v[96:99], v[252:255], a[68:71], v[96:99]
v_mfma_f32_16x16x32_bf16 v[100:103], v[252:255], a[140:143], v[100:103]
v_mfma_f32_16x16x32_bf16 v[104:107], v[252:255], a[212:215], v[104:107]
v_mfma_f32_16x16x32_bf16 v[108:111], v[252:255], v[36:39], v[108:111]
v_add_u32 v1, 73728, v59
v_mov_b32 v120, 0
s_add_u32 s84, s84, 38912
s_mov_b64 exec, 524287
buffer_load_dword v78, v74, s[44:47], s84 offen sc1
s_mov_b64 exec, -1
v_mfma_f32_16x16x32_bf16 v[80:83], v[188:191], a[0:3], 0
v_mfma_f32_16x16x32_bf16 v[84:87], v[188:191], a[72:75], 0
v_mfma_f32_16x16x32_bf16 v[88:91], v[188:191], a[144:147], 0
v_mfma_f32_16x16x32_bf16 v[92:95], v[188:191], a[216:219], 0
v_mov_b32 v121, 0
v_mov_b32 v122, 0
v_mfma_f32_16x16x32_bf16 v[80:83], v[192:195], a[4:7], v[80:83]
buffer_load_dwordx4 v[188:191], v59, s[44:47], s68 offen offset:1024 sc1
v_mfma_f32_16x16x32_bf16 v[84:87], v[192:195], a[76:79], v[84:87]
v_mul_f32 v160, v96, v96
v_mul_f32 v161, v97, v97
v_mul_f32 v162, v98, v98
v_mfma_f32_16x16x32_bf16 v[88:91], v[192:195], a[148:151], v[88:91]
v_mul_f32 v163, v99, v99
v_mul_f32 v164, v100, v100
v_mul_f32 v165, v101, v101
v_mfma_f32_16x16x32_bf16 v[92:95], v[192:195], a[220:223], v[92:95]
v_mul_f32 v166, v102, v102
v_mul_f32 v167, v103, v103
v_fma_f32 v160, v160, v66, v4
v_mov_b32 v123, 0
v_mov_b32 v132, 0
v_mfma_f32_16x16x32_bf16 v[80:83], v[196:199], a[8:11], v[80:83]
buffer_load_dwordx4 v[192:195], v59, s[44:47], s68 offen offset:2048 sc1
v_mfma_f32_16x16x32_bf16 v[84:87], v[196:199], a[80:83], v[84:87]
v_fma_f32 v161, v161, v66, v4
v_fma_f32 v162, v162, v66, v4
v_fma_f32 v163, v163, v66, v4
v_fma_f32 v164, v164, v75, v5
v_mfma_f32_16x16x32_bf16 v[88:91], v[196:199], a[152:155], v[88:91]
v_fma_f32 v165, v165, v75, v5
v_fma_f32 v166, v166, v75, v5
v_fma_f32 v167, v167, v75, v5
v_mfma_f32_16x16x32_bf16 v[92:95], v[196:199], a[224:227], v[92:95]
v_mul_f32 v160, v160, v96
v_mul_f32 v161, v161, v97
v_mul_f32 v162, v162, v98
v_mov_b32 v133, 0
v_mov_b32 v134, 0
v_mfma_f32_16x16x32_bf16 v[80:83], v[200:203], a[12:15], v[80:83]
buffer_load_dwordx4 v[196:199], v59, s[44:47], s68 offen offset:3072 sc1
v_mfma_f32_16x16x32_bf16 v[84:87], v[200:203], a[84:87], v[84:87]
v_mul_f32 v163, v163, v99
v_mul_f32 v164, v164, v100
v_mul_f32 v165, v165, v101
v_mfma_f32_16x16x32_bf16 v[88:91], v[200:203], a[156:159], v[88:91]
v_mul_f32 v166, v166, v102
v_mul_f32 v167, v167, v103
v_exp_f32 v160, v160
v_mfma_f32_16x16x32_bf16 v[92:95], v[200:203], a[228:231], v[92:95]
v_exp_f32 v161, v161
v_mov_b32 v135, 0
v_mov_b32 v144, 0
s_waitcnt vmcnt(18)
v_mfma_f32_16x16x32_bf16 v[80:83], v[204:207], a[16:19], v[80:83]
s_add_u32 s68, s68, 4096
buffer_load_dwordx4 v[200:203], v59, s[44:47], s68 offen offset:0 sc1
v_mfma_f32_16x16x32_bf16 v[84:87], v[204:207], a[88:91], v[84:87]
v_exp_f32 v162, v162
v_exp_f32 v163, v163
v_mfma_f32_16x16x32_bf16 v[88:91], v[204:207], a[160:163], v[88:91]
v_exp_f32 v164, v164
v_mfma_f32_16x16x32_bf16 v[92:95], v[204:207], a[232:235], v[92:95]
v_exp_f32 v165, v165
v_exp_f32 v166, v166
v_mov_b32 v145, 0
v_mov_b32 v146, 0
s_waitcnt vmcnt(18)
v_mfma_f32_16x16x32_bf16 v[80:83], v[208:211], a[20:23], v[80:83]
buffer_load_dwordx4 v[204:207], v59, s[44:47], s68 offen offset:1024 sc1
v_mfma_f32_16x16x32_bf16 v[84:87], v[208:211], a[92:95], v[84:87]
v_exp_f32 v167, v167
v_fma_f32 v160, v160, v60, v60
v_fma_f32 v161, v161, v60, v60
v_mfma_f32_16x16x32_bf16 v[88:91], v[208:211], a[164:167], v[88:91]
v_fma_f32 v162, v162, v60, v60
v_fma_f32 v163, v163, v60, v60
v_fma_f32 v164, v164, v61, v61
v_mfma_f32_16x16x32_bf16 v[92:95], v[208:211], a[236:239], v[92:95]
v_fma_f32 v165, v165, v61, v61
v_fma_f32 v166, v166, v61, v61
v_fma_f32 v167, v167, v61, v61
v_mov_b32 v147, 0
v_mov_b32 v156, 0
s_add_u32 s84, s84, 38912
s_mov_b64 exec, 524287
buffer_load_dword v78, v74, s[44:47], s84 offen sc1
s_mov_b64 exec, -1
s_waitcnt vmcnt(19)
v_mfma_f32_16x16x32_bf16 v[80:83], v[212:215], a[24:27], v[80:83]
buffer_load_dwordx4 v[208:211], v59, s[44:47], s68 offen offset:2048 sc1
v_mfma_f32_16x16x32_bf16 v[84:87], v[212:215], a[96:99], v[84:87]
v_rcp_f32 v160, v160
v_rcp_f32 v161, v161
v_mfma_f32_16x16x32_bf16 v[88:91], v[212:215], a[168:171], v[88:91]
v_rcp_f32 v162, v162
v_mfma_f32_16x16x32_bf16 v[92:95], v[212:215], a[240:243], v[92:95]
v_rcp_f32 v163, v163
v_rcp_f32 v164, v164
v_mov_b32 v157, 0
v_mov_b32 v158, 0
s_waitcnt vmcnt(19)
v_mfma_f32_16x16x32_bf16 v[80:83], v[216:219], a[28:31], v[80:83]
buffer_load_dwordx4 v[212:215], v59, s[44:47], s68 offen offset:3072 sc1
v_mfma_f32_16x16x32_bf16 v[84:87], v[216:219], a[100:103], v[84:87]
v_rcp_f32 v165, v165
v_mfma_f32_16x16x32_bf16 v[88:91], v[216:219], a[172:175], v[88:91]
v_rcp_f32 v166, v166
v_rcp_f32 v167, v167
v_mul_f32 v160, v160, v96
v_mfma_f32_16x16x32_bf16 v[92:95], v[216:219], a[244:247], v[92:95]
v_mul_f32 v161, v161, v97
v_mul_f32 v162, v162, v98
v_mul_f32 v163, v163, v99
v_mov_b32 v159, 0
ds_read_b128 v[112:115], v1 offset:0
s_waitcnt vmcnt(19)
v_mfma_f32_16x16x32_bf16 v[80:83], v[220:223], a[32:35], v[80:83]
s_add_u32 s68, s68, 4096
buffer_load_dwordx4 v[216:219], v59, s[44:47], s68 offen offset:0 sc1
v_mfma_f32_16x16x32_bf16 v[84:87], v[220:223], a[104:107], v[84:87]
v_mul_f32 v164, v164, v100
v_mul_f32 v165, v165, v101
v_mul_f32 v166, v166, v102
v_mfma_f32_16x16x32_bf16 v[88:91], v[220:223], a[176:179], v[88:91]
v_mul_f32 v167, v167, v103
v_cvt_pk_bf16_f32 v168, v160, v161
v_cvt_pk_bf16_f32 v169, v162, v163
v_mfma_f32_16x16x32_bf16 v[92:95], v[220:223], a[248:251], v[92:95]
v_cvt_pk_bf16_f32 v170, v164, v165
v_cvt_pk_bf16_f32 v171, v166, v167
s_waitcnt lgkmcnt(13)
ds_write_b64 v65, v[168:169] offset:14336
ds_write_b64 v65, v[170:171] offset:32768
s_waitcnt lgkmcnt(13)
ds_read_b128 v[116:119], v1 offset:1024
ds_read_b128 v[124:127], v1 offset:3072
s_waitcnt vmcnt(19)
v_mfma_f32_16x16x32_bf16 v[80:83], v[224:227], a[36:39], v[80:83]
buffer_load_dwordx4 v[220:223], v59, s[44:47], s68 offen offset:1024 sc1
v_mfma_f32_16x16x32_bf16 v[84:87], v[224:227], a[108:111], v[84:87]
v_mul_f32 v160, v104, v104
v_mul_f32 v161, v105, v105
v_mul_f32 v162, v106, v106
v_mfma_f32_16x16x32_bf16 v[88:91], v[224:227], a[180:183], v[88:91]
v_mul_f32 v163, v107, v107
v_mul_f32 v164, v108, v108
v_mul_f32 v165, v109, v109
v_mfma_f32_16x16x32_bf16 v[92:95], v[224:227], a[252:255], v[92:95]
v_mul_f32 v166, v110, v110
v_mul_f32 v167, v111, v111
v_fma_f32 v160, v160, v56, v6
s_waitcnt lgkmcnt(13)
ds_read_b128 v[128:131], v1 offset:4096
ds_read_b128 v[136:139], v1 offset:6144
s_waitcnt vmcnt(19)
v_mfma_f32_16x16x32_bf16 v[80:83], v[228:231], a[40:43], v[80:83]
buffer_load_dwordx4 v[224:227], v59, s[44:47], s68 offen offset:2048 sc1
v_mfma_f32_16x16x32_bf16 v[84:87], v[228:231], a[112:115], v[84:87]
v_fma_f32 v161, v161, v56, v6
v_fma_f32 v162, v162, v56, v6
v_fma_f32 v163, v163, v56, v6
v_fma_f32 v164, v164, v57, v7
v_mfma_f32_16x16x32_bf16 v[88:91], v[228:231], a[184:187], v[88:91]
v_fma_f32 v165, v165, v57, v7
v_fma_f32 v166, v166, v57, v7
v_fma_f32 v167, v167, v57, v7
v_mfma_f32_16x16x32_bf16 v[92:95], v[228:231], v[8:11], v[92:95]
v_mul_f32 v160, v160, v104
v_mul_f32 v161, v161, v105
v_mul_f32 v162, v162, v106
s_waitcnt lgkmcnt(13)
ds_read_b128 v[140:143], v1 offset:7168
ds_read_b128 v[148:151], v1 offset:9216
s_waitcnt vmcnt(19)
v_mfma_f32_16x16x32_bf16 v[80:83], v[232:235], a[44:47], v[80:83]
buffer_load_dwordx4 v[228:231], v59, s[44:47], s68 offen offset:3072 sc1
v_mfma_f32_16x16x32_bf16 v[84:87], v[232:235], a[116:119], v[84:87]
v_mul_f32 v163, v163, v107
v_mul_f32 v164, v164, v108
v_mul_f32 v165, v165, v109
v_mfma_f32_16x16x32_bf16 v[88:91], v[232:235], a[188:191], v[88:91]
v_mul_f32 v166, v166, v110
v_mul_f32 v167, v167, v111
v_exp_f32 v160, v160
v_mfma_f32_16x16x32_bf16 v[92:95], v[232:235], v[12:15], v[92:95]
v_exp_f32 v161, v161
s_waitcnt lgkmcnt(13)
ds_read_b128 v[152:155], v1 offset:10240
s_mov_b32 exec_lo, 0xffffffff
s_mov_b32 exec_hi, 0x0
ds_read_b64 v[120:121], v1 offset:2048
s_waitcnt lgkmcnt(13)
ds_read_b64 v[132:133], v1 offset:5120
ds_read_b64 v[144:145], v1 offset:8192
s_waitcnt lgkmcnt(13)
ds_read_b64 v[156:157], v1 offset:11264
s_mov_b64 exec, -1
s_add_u32 s84, s84, 38912
s_mov_b64 exec, 524287
buffer_load_dword v78, v74, s[44:47], s84 offen sc1
s_mov_b64 exec, -1
s_waitcnt vmcnt(20)
v_mfma_f32_16x16x32_bf16 v[80:83], v[236:239], a[48:51], v[80:83]
s_add_u32 s68, s68, 4096
buffer_load_dwordx4 v[232:235], v59, s[44:47], s68 offen offset:0 sc1
v_mfma_f32_16x16x32_bf16 v[84:87], v[236:239], a[120:123], v[84:87]
v_exp_f32 v162, v162
v_exp_f32 v163, v163
v_mfma_f32_16x16x32_bf16 v[88:91], v[236:239], a[192:195], v[88:91]
v_exp_f32 v164, v164
v_mfma_f32_16x16x32_bf16 v[92:95], v[236:239], v[16:19], v[92:95]
v_exp_f32 v165, v165
v_exp_f32 v166, v166
s_waitcnt vmcnt(20)
v_mfma_f32_16x16x32_bf16 v[80:83], v[240:243], a[52:55], v[80:83]
buffer_load_dwordx4 v[236:239], v59, s[44:47], s68 offen offset:1024 sc1
v_mfma_f32_16x16x32_bf16 v[84:87], v[240:243], a[124:127], v[84:87]
v_exp_f32 v167, v167
v_fma_f32 v160, v160, v62, v62
v_fma_f32 v161, v161, v62, v62
v_mfma_f32_16x16x32_bf16 v[88:91], v[240:243], a[196:199], v[88:91]
v_fma_f32 v162, v162, v62, v62
v_fma_f32 v163, v163, v62, v62
v_fma_f32 v164, v164, v63, v63
v_mfma_f32_16x16x32_bf16 v[92:95], v[240:243], v[20:23], v[92:95]
v_fma_f32 v165, v165, v63, v63
v_fma_f32 v166, v166, v63, v63
v_fma_f32 v167, v167, v63, v63
v_bfe_u32 v1, v0, 3, 2
s_and_b32 s52, s49, 3
v_cmp_eq_u32 vcc, s52, v1
s_lshr_b32 s53, s49, 2
s_mul_i32 s54, s50, 2304
s_add_u32 s54, s54, 86016
v_lshrrev_b32 v1, 5, v0
v_lshlrev_b32 v1, 7, v1
v_and_b32 v2, 7, v0
v_lshl_add_u32 v1, v2, 4, v1
v_add_u32 v1, s54, v1
v_add_u32 v2, 102400, v59
v_cndmask_b32 v1, v2, v1, vcc
v_mov_b32 v3, 1073741824
v_cndmask_b32 v3, v59, v3, vcc
s_cmp_eq_u32 s53, 0
s_cselect_b64 vcc, -1, 0
v_cndmask_b32 v70, v59, v3, vcc
v_cndmask_b32 v71, v3, v59, vcc
v_cndmask_b32 v72, v2, v1, vcc
v_cndmask_b32 v73, v1, v2, vcc
s_waitcnt vmcnt(20)
v_mfma_f32_16x16x32_bf16 v[80:83], v[244:247], a[56:59], v[80:83]
buffer_load_dwordx4 v[240:243], v59, s[44:47], s68 offen offset:2048 sc1
v_mfma_f32_16x16x32_bf16 v[84:87], v[244:247], a[128:131], v[84:87]
v_rcp_f32 v160, v160
v_rcp_f32 v161, v161
v_mfma_f32_16x16x32_bf16 v[88:91], v[244:247], a[200:203], v[88:91]
v_rcp_f32 v162, v162
v_mfma_f32_16x16x32_bf16 v[92:95], v[244:247], v[24:27], v[92:95]
v_rcp_f32 v163, v163
v_rcp_f32 v164, v164
s_waitcnt vmcnt(20)
v_mfma_f32_16x16x32_bf16 v[80:83], v[248:251], a[60:63], v[80:83]
buffer_load_dwordx4 v[244:247], v59, s[44:47], s68 offen offset:3072 sc1
v_mfma_f32_16x16x32_bf16 v[84:87], v[248:251], a[132:135], v[84:87]
v_rcp_f32 v165, v165
v_mfma_f32_16x16x32_bf16 v[88:91], v[248:251], a[204:207], v[88:91]
v_rcp_f32 v166, v166
v_rcp_f32 v167, v167
v_mul_f32 v160, v160, v104
v_mfma_f32_16x16x32_bf16 v[92:95], v[248:251], v[28:31], v[92:95]
v_mul_f32 v161, v161, v105
v_mul_f32 v162, v162, v106
v_mul_f32 v163, v163, v107
s_waitcnt vmcnt(20)
v_mfma_f32_16x16x32_bf16 v[80:83], v[40:43], a[64:67], v[80:83]
s_add_u32 s68, s68, 4096
buffer_load_dwordx4 v[248:251], v59, s[44:47], s68 offen offset:0 sc1
v_mfma_f32_16x16x32_bf16 v[84:87], v[40:43], a[136:139], v[84:87]
v_mul_f32 v164, v164, v108
v_mul_f32 v165, v165, v109
v_mul_f32 v166, v166, v110
v_mfma_f32_16x16x32_bf16 v[88:91], v[40:43], a[208:211], v[88:91]
v_mul_f32 v167, v167, v111
v_cvt_pk_bf16_f32 v172, v160, v161
v_cvt_pk_bf16_f32 v173, v162, v163
v_mfma_f32_16x16x32_bf16 v[92:95], v[40:43], v[32:35], v[92:95]
v_cvt_pk_bf16_f32 v174, v164, v165
v_cvt_pk_bf16_f32 v175, v166, v167
ds_write_b64 v68, v[172:173] offset:14336
s_waitcnt lgkmcnt(13)
ds_write_b64 v68, v[174:175] offset:32768
s_waitcnt vmcnt(19)
v_mfma_f32_16x16x32_bf16 v[80:83], v[44:47], a[68:71], v[80:83]
v_mfma_f32_16x16x32_bf16 v[84:87], v[44:47], a[140:143], v[84:87]
v_mfma_f32_16x16x32_bf16 v[88:91], v[44:47], a[212:215], v[88:91]
v_mfma_f32_16x16x32_bf16 v[92:95], v[44:47], v[36:39], v[92:95]
s_waitcnt lgkmcnt(2)
s_waitcnt vmcnt(17)
v_mfma_f32_16x16x32_bf16 v[96:99], v[188:191], v[112:115], 0
s_waitcnt lgkmcnt(0)
s_barrier
ds_read_b128 a[0:3], v59 offset:0
ds_read_b128 a[72:75], v59 offset:18432
ds_read_b128 a[144:147], v69 offset:0
ds_read_b128 a[216:219], v69 offset:18432
v_mfma_f32_16x16x32_bf16 v[100:103], v[188:191], v[124:127], 0
v_mfma_f32_16x16x32_bf16 v[104:107], v[188:191], v[136:139], 0
v_mfma_f32_16x16x32_bf16 v[108:111], v[188:191], v[148:151], 0
s_waitcnt vmcnt(16)
v_mfma_f32_16x16x32_bf16 v[96:99], v[192:195], v[116:119], v[96:99]
buffer_load_dwordx4 v[188:191], v59, s[44:47], s68 offen offset:1024 sc1
ds_read_b128 a[4:7], v59 offset:1024
ds_read_b128 a[76:79], v59 offset:19456
ds_read_b128 a[148:151], v69 offset:1024
ds_read_b128 a[220:223], v69 offset:19456
v_mfma_f32_16x16x32_bf16 v[100:103], v[192:195], v[128:131], v[100:103]
v_mul_f32 v160, v80, v80
v_mul_f32 v161, v81, v81
v_mul_f32 v162, v82, v82
v_mul_f32 v163, v83, v83
v_mfma_f32_16x16x32_bf16 v[104:107], v[192:195], v[140:143], v[104:107]
v_mul_f32 v164, v84, v84
v_mul_f32 v165, v85, v85
v_mul_f32 v166, v86, v86
v_mul_f32 v167, v87, v87
v_mfma_f32_16x16x32_bf16 v[108:111], v[192:195], v[152:155], v[108:111]
v_fma_f32 v160, v160, v66, v4
v_fma_f32 v161, v161, v66, v4
v_fma_f32 v162, v162, v66, v4
v_fma_f32 v163, v163, v66, v4
v_fma_f32 v164, v164, v75, v5
s_waitcnt vmcnt(16)
v_mfma_f32_16x16x32_bf16 v[96:99], v[196:199], v[120:123], v[96:99]
buffer_load_dwordx4 v[192:195], v59, s[44:47], s68 offen offset:2048 sc1
ds_read_b128 a[8:11], v59 offset:2048
ds_read_b128 a[80:83], v59 offset:20480
ds_read_b128 a[152:155], v69 offset:2048
ds_read_b128 a[224:227], v69 offset:20480
v_mfma_f32_16x16x32_bf16 v[100:103], v[196:199], v[132:135], v[100:103]
v_fma_f32 v165, v165, v75, v5
v_fma_f32 v166, v166, v75, v5
v_fma_f32 v167, v167, v75, v5
v_mul_f32 v160, v160, v80
v_mfma_f32_16x16x32_bf16 v[104:107], v[196:199], v[144:147], v[104:107]
v_mul_f32 v161, v161, v81
v_mul_f32 v162, v162, v82
v_mul_f32 v163, v163, v83
v_mul_f32 v164, v164, v84
v_mfma_f32_16x16x32_bf16 v[108:111], v[196:199], v[156:159], v[108:111]
v_mul_f32 v165, v165, v85
v_mul_f32 v166, v166, v86
v_mul_f32 v167, v167, v87
v_exp_f32 v160, v160
s_waitcnt vmcnt(16) lgkmcnt(8)
v_mfma_f32_16x16x32_bf16 v[96:99], v[200:203], a[0:3], v[96:99]
buffer_load_dwordx4 v[196:199], v59, s[44:47], s68 offen offset:3072 sc1
ds_read_b128 a[12:15], v59 offset:3072
ds_read_b128 a[84:87], v59 offset:21504
ds_read_b128 a[156:159], v69 offset:3072
ds_read_b128 a[228:231], v69 offset:21504
v_mfma_f32_16x16x32_bf16 v[100:103], v[200:203], a[72:75], v[100:103]
v_exp_f32 v161, v161
v_exp_f32 v162, v162
v_mfma_f32_16x16x32_bf16 v[104:107], v[200:203], a[144:147], v[104:107]
v_exp_f32 v163, v163
v_exp_f32 v164, v164
v_mfma_f32_16x16x32_bf16 v[108:111], v[200:203], a[216:219], v[108:111]
v_exp_f32 v165, v165
v_exp_f32 v166, v166
s_waitcnt vmcnt(16) lgkmcnt(8)
v_mfma_f32_16x16x32_bf16 v[96:99], v[204:207], a[4:7], v[96:99]
s_add_u32 s68, s68, 4096
buffer_load_dwordx4 v[200:203], v59, s[44:47], s68 offen offset:0 sc1
ds_read_b128 a[16:19], v59 offset:4096
ds_read_b128 a[88:91], v59 offset:22528
ds_read_b128 a[160:163], v69 offset:4096
ds_read_b128 a[232:235], v69 offset:22528
v_mfma_f32_16x16x32_bf16 v[100:103], v[204:207], a[76:79], v[100:103]
v_exp_f32 v167, v167
v_fma_f32 v160, v160, v60, v60
v_fma_f32 v161, v161, v60, v60
v_fma_f32 v162, v162, v60, v60
v_mfma_f32_16x16x32_bf16 v[104:107], v[204:207], a[148:151], v[104:107]
v_fma_f32 v163, v163, v60, v60
v_fma_f32 v164, v164, v61, v61
v_fma_f32 v165, v165, v61, v61
v_fma_f32 v166, v166, v61, v61
v_mfma_f32_16x16x32_bf16 v[108:111], v[204:207], a[220:223], v[108:111]
v_fma_f32 v167, v167, v61, v61
v_rcp_f32 v160, v160
v_rcp_f32 v161, v161
s_waitcnt vmcnt(15) lgkmcnt(8)
v_mfma_f32_16x16x32_bf16 v[96:99], v[208:211], a[8:11], v[96:99]
buffer_load_dwordx4 v[204:207], v59, s[44:47], s68 offen offset:1024 sc1
ds_read_b128 a[20:23], v59 offset:5120
ds_read_b128 a[92:95], v59 offset:23552
ds_read_b128 a[164:167], v69 offset:5120
ds_read_b128 a[236:239], v69 offset:23552
v_mfma_f32_16x16x32_bf16 v[100:103], v[208:211], a[80:83], v[100:103]
v_rcp_f32 v162, v162
v_rcp_f32 v163, v163
v_mfma_f32_16x16x32_bf16 v[104:107], v[208:211], a[152:155], v[104:107]
v_rcp_f32 v164, v164
v_rcp_f32 v165, v165
v_mfma_f32_16x16x32_bf16 v[108:111], v[208:211], a[224:227], v[108:111]
v_rcp_f32 v166, v166
v_rcp_f32 v167, v167
v_mul_f32 v160, v160, v80
s_waitcnt vmcnt(15) lgkmcnt(8)
v_mfma_f32_16x16x32_bf16 v[96:99], v[212:215], a[12:15], v[96:99]
buffer_load_dwordx4 v[208:211], v59, s[44:47], s68 offen offset:2048 sc1
ds_read_b128 a[24:27], v59 offset:6144
ds_read_b128 a[96:99], v59 offset:24576
ds_read_b128 a[168:171], v69 offset:6144
ds_read_b128 a[240:243], v69 offset:24576
v_mfma_f32_16x16x32_bf16 v[100:103], v[212:215], a[84:87], v[100:103]
v_mul_f32 v161, v161, v81
v_mul_f32 v162, v162, v82
v_mul_f32 v163, v163, v83
v_mul_f32 v164, v164, v84
v_mfma_f32_16x16x32_bf16 v[104:107], v[212:215], a[156:159], v[104:107]
v_mul_f32 v165, v165, v85
v_mul_f32 v166, v166, v86
v_mul_f32 v167, v167, v87
v_cvt_pk_bf16_f32 v168, v160, v161
v_mfma_f32_16x16x32_bf16 v[108:111], v[212:215], a[228:231], v[108:111]
v_cvt_pk_bf16_f32 v169, v162, v163
v_cvt_pk_bf16_f32 v170, v164, v165
v_cvt_pk_bf16_f32 v171, v166, v167
ds_write_b64 v65, v[168:169] offset:16384
ds_write_b64 v65, v[170:171] offset:34816
s_waitcnt vmcnt(15) lgkmcnt(10)
v_mfma_f32_16x16x32_bf16 v[96:99], v[216:219], a[16:19], v[96:99]
buffer_load_dwordx4 v[212:215], v59, s[44:47], s68 offen offset:3072 sc1
ds_read_b128 a[28:31], v59 offset:7168
ds_read_b128 a[100:103], v59 offset:25600
ds_read_b128 a[172:175], v69 offset:7168
ds_read_b128 a[244:247], v69 offset:25600
v_mfma_f32_16x16x32_bf16 v[100:103], v[216:219], a[88:91], v[100:103]
v_mul_f32 v160, v88, v88
v_mul_f32 v161, v89, v89
v_mul_f32 v162, v90, v90
v_mul_f32 v163, v91, v91
v_mfma_f32_16x16x32_bf16 v[104:107], v[216:219], a[160:163], v[104:107]
v_mul_f32 v164, v92, v92
v_mul_f32 v165, v93, v93
v_mul_f32 v166, v94, v94
v_mul_f32 v167, v95, v95
v_mfma_f32_16x16x32_bf16 v[108:111], v[216:219], a[232:235], v[108:111]
v_fma_f32 v160, v160, v56, v6
v_fma_f32 v161, v161, v56, v6
v_fma_f32 v162, v162, v56, v6
v_fma_f32 v163, v163, v56, v6
v_fma_f32 v164, v164, v57, v7
s_waitcnt vmcnt(15) lgkmcnt(10)
v_mfma_f32_16x16x32_bf16 v[96:99], v[220:223], a[20:23], v[96:99]
s_add_u32 s68, s68, 4096
buffer_load_dwordx4 v[216:219], v59, s[44:47], s68 offen offset:0 sc1
ds_read_b128 a[32:35], v59 offset:8192
ds_read_b128 a[104:107], v59 offset:26624
ds_read_b128 a[176:179], v69 offset:8192
ds_read_b128 a[248:251], v69 offset:26624
v_mfma_f32_16x16x32_bf16 v[100:103], v[220:223], a[92:95], v[100:103]
v_fma_f32 v165, v165, v57, v7
v_fma_f32 v166, v166, v57, v7
v_fma_f32 v167, v167, v57, v7
v_mul_f32 v160, v160, v88
v_mfma_f32_16x16x32_bf16 v[104:107], v[220:223], a[164:167], v[104:107]
v_mul_f32 v161, v161, v89
v_mul_f32 v162, v162, v90
v_mul_f32 v163, v163, v91
v_mul_f32 v164, v164, v92
v_mfma_f32_16x16x32_bf16 v[108:111], v[220:223], a[236:239], v[108:111]
v_mul_f32 v165, v165, v93
v_mul_f32 v166, v166, v94
v_mul_f32 v167, v167, v95
v_exp_f32 v160, v160
s_waitcnt vmcnt(15) lgkmcnt(10)
v_mfma_f32_16x16x32_bf16 v[96:99], v[224:227], a[24:27], v[96:99]
buffer_load_dwordx4 v[220:223], v59, s[44:47], s68 offen offset:1024 sc1
ds_read_b128 a[36:39], v59 offset:9216
ds_read_b128 a[108:111], v59 offset:27648
ds_read_b128 a[180:183], v69 offset:9216
ds_read_b128 a[252:255], v69 offset:27648
v_mfma_f32_16x16x32_bf16 v[100:103], v[224:227], a[96:99], v[100:103]
v_exp_f32 v161, v161
v_exp_f32 v162, v162
v_mfma_f32_16x16x32_bf16 v[104:107], v[224:227], a[168:171], v[104:107]
v_exp_f32 v163, v163
v_exp_f32 v164, v164
v_mfma_f32_16x16x32_bf16 v[108:111], v[224:227], a[240:243], v[108:111]
v_exp_f32 v165, v165
v_exp_f32 v166, v166
s_waitcnt vmcnt(15) lgkmcnt(8)
v_mfma_f32_16x16x32_bf16 v[96:99], v[228:231], a[28:31], v[96:99]
buffer_load_dwordx4 v[224:227], v59, s[44:47], s68 offen offset:2048 sc1
ds_read_b128 a[40:43], v59 offset:10240
ds_read_b128 a[112:115], v59 offset:28672
ds_read_b128 a[184:187], v69 offset:10240
ds_read_b128 v[8:11], v69 offset:28672
v_mfma_f32_16x16x32_bf16 v[100:103], v[228:231], a[100:103], v[100:103]
v_exp_f32 v167, v167
v_fma_f32 v160, v160, v62, v62
v_fma_f32 v161, v161, v62, v62
v_fma_f32 v162, v162, v62, v62
v_mfma_f32_16x16x32_bf16 v[104:107], v[228:231], a[172:175], v[104:107]
v_fma_f32 v163, v163, v62, v62
v_fma_f32 v164, v164, v63, v63
v_fma_f32 v165, v165, v63, v63
v_fma_f32 v166, v166, v63, v63
v_mfma_f32_16x16x32_bf16 v[108:111], v[228:231], a[244:247], v[108:111]
v_fma_f32 v167, v167, v63, v63
v_rcp_f32 v160, v160
v_rcp_f32 v161, v161
s_waitcnt vmcnt(14) lgkmcnt(8)
v_mfma_f32_16x16x32_bf16 v[96:99], v[232:235], a[32:35], v[96:99]
buffer_load_dwordx4 v[228:231], v59, s[44:47], s68 offen offset:3072 sc1
ds_read_b128 a[44:47], v59 offset:11264
ds_read_b128 a[116:119], v59 offset:29696
ds_read_b128 a[188:191], v69 offset:11264
ds_read_b128 v[12:15], v69 offset:29696
v_mfma_f32_16x16x32_bf16 v[100:103], v[232:235], a[104:107], v[100:103]
v_rcp_f32 v162, v162
v_rcp_f32 v163, v163
v_mfma_f32_16x16x32_bf16 v[104:107], v[232:235], a[176:179], v[104:107]
v_rcp_f32 v164, v164
v_rcp_f32 v165, v165
v_mfma_f32_16x16x32_bf16 v[108:111], v[232:235], a[248:251], v[108:111]
v_rcp_f32 v166, v166
v_rcp_f32 v167, v167
v_mul_f32 v160, v160, v88
s_waitcnt vmcnt(14) lgkmcnt(8)
v_mfma_f32_16x16x32_bf16 v[96:99], v[236:239], a[36:39], v[96:99]
s_add_u32 s68, s68, 4096
buffer_load_dwordx4 v[232:235], v59, s[44:47], s68 offen offset:0 sc1
ds_read_b128 a[48:51], v59 offset:12288
ds_read_b128 a[120:123], v59 offset:30720
ds_read_b128 a[192:195], v69 offset:12288
ds_read_b128 v[16:19], v69 offset:30720
v_mfma_f32_16x16x32_bf16 v[100:103], v[236:239], a[108:111], v[100:103]
v_mul_f32 v161, v161, v89
v_mul_f32 v162, v162, v90
v_mul_f32 v163, v163, v91
v_mul_f32 v164, v164, v92
v_mfma_f32_16x16x32_bf16 v[104:107], v[236:239], a[180:183], v[104:107]
v_mul_f32 v165, v165, v93
v_mul_f32 v166, v166, v94
v_mul_f32 v167, v167, v95
v_cvt_pk_bf16_f32 v172, v160, v161
v_mfma_f32_16x16x32_bf16 v[108:111], v[236:239], a[252:255], v[108:111]
v_cvt_pk_bf16_f32 v173, v162, v163
v_cvt_pk_bf16_f32 v174, v164, v165
v_cvt_pk_bf16_f32 v175, v166, v167
ds_write_b64 v68, v[172:173] offset:16384
ds_write_b64 v68, v[174:175] offset:34816
s_waitcnt vmcnt(14) lgkmcnt(10)
v_mfma_f32_16x16x32_bf16 v[96:99], v[240:243], a[40:43], v[96:99]
buffer_load_dwordx4 v[236:239], v59, s[44:47], s68 offen offset:1024 sc1
ds_read_b128 a[52:55], v59 offset:13312
ds_read_b128 a[124:127], v59 offset:31744
ds_read_b128 a[196:199], v69 offset:13312
ds_read_b128 v[20:23], v69 offset:31744
v_mfma_f32_16x16x32_bf16 v[100:103], v[240:243], a[112:115], v[100:103]
v_mfma_f32_16x16x32_bf16 v[104:107], v[240:243], a[184:187], v[104:107]
v_mfma_f32_16x16x32_bf16 v[108:111], v[240:243], v[8:11], v[108:111]
s_waitcnt vmcnt(14) lgkmcnt(10)
v_mfma_f32_16x16x32_bf16 v[96:99], v[244:247], a[44:47], v[96:99]
buffer_load_dwordx4 v[240:243], v59, s[44:47], s68 offen offset:2048 sc1
ds_read_b128 a[56:59], v59 offset:14336
ds_read_b128 a[128:131], v59 offset:32768
ds_read_b128 a[200:203], v69 offset:14336
ds_read_b128 v[24:27], v69 offset:32768
v_mfma_f32_16x16x32_bf16 v[100:103], v[244:247], a[116:119], v[100:103]
v_mfma_f32_16x16x32_bf16 v[104:107], v[244:247], a[188:191], v[104:107]
v_mfma_f32_16x16x32_bf16 v[108:111], v[244:247], v[12:15], v[108:111]
s_waitcnt vmcnt(14) lgkmcnt(10)
v_mfma_f32_16x16x32_bf16 v[96:99], v[248:251], a[48:51], v[96:99]
buffer_load_dwordx4 v[244:247], v59, s[44:47], s68 offen offset:3072 sc1
ds_read_b128 a[60:63], v59 offset:15360
ds_read_b128 a[132:135], v59 offset:33792
ds_read_b128 a[204:207], v69 offset:15360
ds_read_b128 v[28:31], v69 offset:33792
v_mfma_f32_16x16x32_bf16 v[100:103], v[248:251], a[120:123], v[100:103]
v_mfma_f32_16x16x32_bf16 v[104:107], v[248:251], a[192:195], v[104:107]
v_mfma_f32_16x16x32_bf16 v[108:111], v[248:251], v[16:19], v[108:111]
s_waitcnt vmcnt(14) lgkmcnt(8)
v_mfma_f32_16x16x32_bf16 v[96:99], v[188:191], a[52:55], v[96:99]
s_add_u32 s68, s68, 4096
buffer_load_dwordx4 v[248:251], v59, s[44:47], s68 offen offset:0 sc1
s_waitcnt lgkmcnt(0)
s_barrier
ds_read_b128 a[64:67], v59 offset:16384
ds_read_b128 a[136:139], v59 offset:34816
ds_read_b128 a[208:211], v69 offset:16384
ds_read_b128 v[32:35], v69 offset:34816
v_mfma_f32_16x16x32_bf16 v[100:103], v[188:191], a[124:127], v[100:103]
v_mfma_f32_16x16x32_bf16 v[104:107], v[188:191], a[196:199], v[104:107]
v_mfma_f32_16x16x32_bf16 v[108:111], v[188:191], v[20:23], v[108:111]
s_waitcnt vmcnt(14)
v_mfma_f32_16x16x32_bf16 v[96:99], v[192:195], a[56:59], v[96:99]
buffer_load_dwordx4 v[188:191], v59, s[44:47], s68 offen offset:1024 sc1
ds_read_b128 a[68:71], v59 offset:17408
ds_read_b128 a[140:143], v59 offset:35840
ds_read_b128 a[212:215], v69 offset:17408
ds_read_b128 v[36:39], v69 offset:35840
v_mfma_f32_16x16x32_bf16 v[100:103], v[192:195], a[128:131], v[100:103]
v_mfma_f32_16x16x32_bf16 v[104:107], v[192:195], a[200:203], v[104:107]
v_mfma_f32_16x16x32_bf16 v[108:111], v[192:195], v[24:27], v[108:111]
s_waitcnt vmcnt(14)
v_mfma_f32_16x16x32_bf16 v[96:99], v[196:199], a[60:63], v[96:99]
buffer_load_dwordx4 v[192:195], v59, s[44:47], s68 offen offset:2048 sc1
v_mfma_f32_16x16x32_bf16 v[100:103], v[196:199], a[132:135], v[100:103]
v_mfma_f32_16x16x32_bf16 v[104:107], v[196:199], a[204:207], v[104:107]
v_mfma_f32_16x16x32_bf16 v[108:111], v[196:199], v[28:31], v[108:111]
s_waitcnt vmcnt(14) lgkmcnt(4)
v_mfma_f32_16x16x32_bf16 v[96:99], v[200:203], a[64:67], v[96:99]
buffer_load_dwordx4 v[196:199], v59, s[44:47], s68 offen offset:3072 sc1
v_mfma_f32_16x16x32_bf16 v[100:103], v[200:203], a[136:139], v[100:103]
v_mfma_f32_16x16x32_bf16 v[104:107], v[200:203], a[208:211], v[104:107]
v_mfma_f32_16x16x32_bf16 v[108:111], v[200:203], v[32:35], v[108:111]
s_waitcnt vmcnt(14) lgkmcnt(0)
v_mfma_f32_16x16x32_bf16 v[96:99], v[204:207], a[68:71], v[96:99]
s_add_u32 s68, s68, 4096
buffer_load_dwordx4 v[200:203], v59, s[44:47], s68 offen offset:0 sc1
v_mfma_f32_16x16x32_bf16 v[100:103], v[204:207], a[140:143], v[100:103]
v_mfma_f32_16x16x32_bf16 v[104:107], v[204:207], a[212:215], v[104:107]
v_mfma_f32_16x16x32_bf16 v[108:111], v[204:207], v[36:39], v[108:111]
v_mov_b32 v40, -1
v_mov_b32 v41, -1
v_mov_b32 v42, -1
v_mov_b32 v43, -1
s_add_u32 s52, s69, 65536
buffer_store_dwordx4 v[40:43], v70, s[44:47], s52 offen offset:0 sc0 sc1
buffer_store_dwordx4 v[40:43], v71, s[44:47], s52 offen offset:1024 sc0 sc1
s_waitcnt vmcnt(16)
v_mfma_f32_16x16x32_bf16 v[80:83], v[208:211], v[112:115], 0
buffer_load_dwordx4 v[204:207], v59, s[44:47], s68 offen offset:1024 sc1
v_mfma_f32_16x16x32_bf16 v[84:87], v[208:211], v[124:127], 0
v_mfma_f32_16x16x32_bf16 v[88:91], v[208:211], v[136:139], 0
v_mfma_f32_16x16x32_bf16 v[92:95], v[208:211], v[148:151], 0
s_waitcnt vmcnt(16)
v_mfma_f32_16x16x32_bf16 v[80:83], v[212:215], v[116:119], v[80:83]
buffer_load_dwordx4 v[208:211], v59, s[44:47], s68 offen offset:2048 sc1
v_mfma_f32_16x16x32_bf16 v[84:87], v[212:215], v[128:131], v[84:87]
v_mfma_f32_16x16x32_bf16 v[88:91], v[212:215], v[140:143], v[88:91]
v_cvt_pk_bf16_f32 v160, v96, v97
v_mfma_f32_16x16x32_bf16 v[92:95], v[212:215], v[152:155], v[92:95]
v_cvt_pk_bf16_f32 v161, v98, v99
s_waitcnt vmcnt(16)
v_mfma_f32_16x16x32_bf16 v[80:83], v[216:219], v[120:123], v[80:83]
buffer_load_dwordx4 v[212:215], v59, s[44:47], s68 offen offset:3072 sc1
v_mfma_f32_16x16x32_bf16 v[84:87], v[216:219], v[132:135], v[84:87]
v_cvt_pk_bf16_f32 v162, v100, v101
v_mfma_f32_16x16x32_bf16 v[88:91], v[216:219], v[144:147], v[88:91]
v_cvt_pk_bf16_f32 v163, v102, v103
v_mfma_f32_16x16x32_bf16 v[92:95], v[216:219], v[156:159], v[92:95]
s_nop 0
s_waitcnt vmcnt(16)
v_mfma_f32_16x16x32_bf16 v[80:83], v[220:223], a[0:3], v[80:83]
s_add_u32 s68, s68, 4096
buffer_load_dwordx4 v[216:219], v59, s[44:47], s68 offen offset:0 sc1
v_mfma_f32_16x16x32_bf16 v[84:87], v[220:223], a[72:75], v[84:87]
v_permlane16_swap_b32 v160, v162
v_mfma_f32_16x16x32_bf16 v[88:91], v[220:223], a[144:147], v[88:91]
v_permlane16_swap_b32 v161, v163
v_mfma_f32_16x16x32_bf16 v[92:95], v[220:223], a[216:219], v[92:95]
s_waitcnt vmcnt(16)
v_mfma_f32_16x16x32_bf16 v[80:83], v[224:227], a[4:7], v[80:83]
buffer_load_dwordx4 v[220:223], v59, s[44:47], s68 offen offset:1024 sc1
v_mfma_f32_16x16x32_bf16 v[84:87], v[224:227], a[76:79], v[84:87]
v_mfma_f32_16x16x32_bf16 v[88:91], v[224:227], a[148:151], v[88:91]
buffer_store_dwordx4 v[160:163], v70, s[44:47], s69 offen offset:0 sc0 sc1
ds_write_b128 v72, v[160:163] offset:0
v_mfma_f32_16x16x32_bf16 v[92:95], v[224:227], a[220:223], v[92:95]
v_cvt_pk_bf16_f32 v164, v104, v105
s_waitcnt vmcnt(17)
v_mfma_f32_16x16x32_bf16 v[80:83], v[228:231], a[8:11], v[80:83]
buffer_load_dwordx4 v[224:227], v59, s[44:47], s68 offen offset:2048 sc1
v_mfma_f32_16x16x32_bf16 v[84:87], v[228:231], a[80:83], v[84:87]
v_cvt_pk_bf16_f32 v165, v106, v107
v_mfma_f32_16x16x32_bf16 v[88:91], v[228:231], a[152:155], v[88:91]
v_cvt_pk_bf16_f32 v166, v108, v109
v_mfma_f32_16x16x32_bf16 v[92:95], v[228:231], a[224:227], v[92:95]
v_cvt_pk_bf16_f32 v167, v110, v111
s_waitcnt vmcnt(17)
v_mfma_f32_16x16x32_bf16 v[80:83], v[232:235], a[12:15], v[80:83]
buffer_load_dwordx4 v[228:231], v59, s[44:47], s68 offen offset:3072 sc1
v_mfma_f32_16x16x32_bf16 v[84:87], v[232:235], a[84:87], v[84:87]
s_nop 0
v_mfma_f32_16x16x32_bf16 v[88:91], v[232:235], a[156:159], v[88:91]
v_permlane16_swap_b32 v164, v166
v_mfma_f32_16x16x32_bf16 v[92:95], v[232:235], a[228:231], v[92:95]
v_permlane16_swap_b32 v165, v167
s_waitcnt vmcnt(17)
v_mfma_f32_16x16x32_bf16 v[80:83], v[236:239], a[16:19], v[80:83]
s_add_u32 s68, s68, 4096
buffer_load_dwordx4 v[232:235], v59, s[44:47], s68 offen offset:0 sc1
v_mfma_f32_16x16x32_bf16 v[84:87], v[236:239], a[88:91], v[84:87]
v_mfma_f32_16x16x32_bf16 v[88:91], v[236:239], a[160:163], v[88:91]
v_mfma_f32_16x16x32_bf16 v[92:95], v[236:239], a[232:235], v[92:95]
buffer_store_dwordx4 v[164:167], v71, s[44:47], s69 offen offset:1024 sc0 sc1
ds_write_b128 v73, v[164:167] offset:0
s_add_u32 s69, s69, 8192
s_waitcnt vmcnt(18)
v_mfma_f32_16x16x32_bf16 v[80:83], v[240:243], a[20:23], v[80:83]
buffer_load_dwordx4 v[236:239], v59, s[44:47], s68 offen offset:1024 sc1
v_mfma_f32_16x16x32_bf16 v[84:87], v[240:243], a[92:95], v[84:87]
v_mfma_f32_16x16x32_bf16 v[88:91], v[240:243], a[164:167], v[88:91]
v_mfma_f32_16x16x32_bf16 v[92:95], v[240:243], a[236:239], v[92:95]
s_waitcnt vmcnt(18)
v_mfma_f32_16x16x32_bf16 v[80:83], v[244:247], a[24:27], v[80:83]
buffer_load_dwordx4 v[240:243], v59, s[44:47], s68 offen offset:2048 sc1
v_mfma_f32_16x16x32_bf16 v[84:87], v[244:247], a[96:99], v[84:87]
v_mfma_f32_16x16x32_bf16 v[88:91], v[244:247], a[168:171], v[88:91]
v_mfma_f32_16x16x32_bf16 v[92:95], v[244:247], a[240:243], v[92:95]
s_waitcnt vmcnt(18)
v_mfma_f32_16x16x32_bf16 v[80:83], v[248:251], a[28:31], v[80:83]
buffer_load_dwordx4 v[244:247], v59, s[44:47], s68 offen offset:3072 sc1
v_mfma_f32_16x16x32_bf16 v[84:87], v[248:251], a[100:103], v[84:87]
v_mfma_f32_16x16x32_bf16 v[88:91], v[248:251], a[172:175], v[88:91]
v_mfma_f32_16x16x32_bf16 v[92:95], v[248:251], a[244:247], v[92:95]
s_waitcnt vmcnt(18)
v_mfma_f32_16x16x32_bf16 v[80:83], v[188:191], a[32:35], v[80:83]
s_add_u32 s68, s68, 4096
buffer_load_dwordx4 v[248:251], v59, s[44:47], s68 offen offset:0 sc1
v_mfma_f32_16x16x32_bf16 v[84:87], v[188:191], a[104:107], v[84:87]
v_mfma_f32_16x16x32_bf16 v[88:91], v[188:191], a[176:179], v[88:91]
v_mfma_f32_16x16x32_bf16 v[92:95], v[188:191], a[248:251], v[92:95]
s_waitcnt vmcnt(18)
v_mfma_f32_16x16x32_bf16 v[80:83], v[192:195], a[36:39], v[80:83]
buffer_load_dwordx4 v[188:191], v59, s[44:47], s68 offen offset:1024 sc1
v_mfma_f32_16x16x32_bf16 v[84:87], v[192:195], a[108:111], v[84:87]
v_mfma_f32_16x16x32_bf16 v[88:91], v[192:195], a[180:183], v[88:91]
v_mfma_f32_16x16x32_bf16 v[92:95], v[192:195], a[252:255], v[92:95]
s_waitcnt vmcnt(18)
v_mfma_f32_16x16x32_bf16 v[80:83], v[196:199], a[40:43], v[80:83]
buffer_load_dwordx4 v[192:195], v59, s[44:47], s68 offen offset:2048 sc1
v_mfma_f32_16x16x32_bf16 v[84:87], v[196:199], a[112:115], v[84:87]
v_mfma_f32_16x16x32_bf16 v[88:91], v[196:199], a[184:187], v[88:91]
v_mfma_f32_16x16x32_bf16 v[92:95], v[196:199], v[8:11], v[92:95]
s_waitcnt vmcnt(18)
v_mfma_f32_16x16x32_bf16 v[80:83], v[200:203], a[44:47], v[80:83]
buffer_load_dwordx4 v[196:199], v59, s[44:47], s68 offen offset:3072 sc1
v_mfma_f32_16x16x32_bf16 v[84:87], v[200:203], a[116:119], v[84:87]
v_mfma_f32_16x16x32_bf16 v[88:91], v[200:203], a[188:191], v[88:91]
v_mfma_f32_16x16x32_bf16 v[92:95], v[200:203], v[12:15], v[92:95]
s_waitcnt vmcnt(16)
v_mfma_f32_16x16x32_bf16 v[80:83], v[204:207], a[48:51], v[80:83]
s_add_u32 s68, s68, 4096
buffer_load_dwordx4 v[200:203], v59, s[44:47], s68 offen offset:0 sc1
v_mfma_f32_16x16x32_bf16 v[84:87], v[204:207], a[120:123], v[84:87]
v_mfma_f32_16x16x32_bf16 v[88:91], v[204:207], a[192:195], v[88:91]
v_mfma_f32_16x16x32_bf16 v[92:95], v[204:207], v[16:19], v[92:95]
s_waitcnt vmcnt(16)
v_mfma_f32_16x16x32_bf16 v[80:83], v[208:211], a[52:55], v[80:83]
buffer_load_dwordx4 v[204:207], v59, s[44:47], s68 offen offset:1024 sc1
v_mfma_f32_16x16x32_bf16 v[84:87], v[208:211], a[124:127], v[84:87]
v_mfma_f32_16x16x32_bf16 v[88:91], v[208:211], a[196:199], v[88:91]
v_mfma_f32_16x16x32_bf16 v[92:95], v[208:211], v[20:23], v[92:95]
s_waitcnt vmcnt(16)
v_mfma_f32_16x16x32_bf16 v[80:83], v[212:215], a[56:59], v[80:83]
buffer_load_dwordx4 v[208:211], v59, s[44:47], s68 offen offset:2048 sc1
v_mfma_f32_16x16x32_bf16 v[84:87], v[212:215], a[128:131], v[84:87]
v_mfma_f32_16x16x32_bf16 v[88:91], v[212:215], a[200:203], v[88:91]
v_mfma_f32_16x16x32_bf16 v[92:95], v[212:215], v[24:27], v[92:95]
s_waitcnt vmcnt(16)
v_mfma_f32_16x16x32_bf16 v[80:83], v[216:219], a[60:63], v[80:83]
buffer_load_dwordx4 v[212:215], v59, s[44:47], s68 offen offset:3072 sc1
v_mfma_f32_16x16x32_bf16 v[84:87], v[216:219], a[132:135], v[84:87]
v_mfma_f32_16x16x32_bf16 v[88:91], v[216:219], a[204:207], v[88:91]
v_mfma_f32_16x16x32_bf16 v[92:95], v[216:219], v[28:31], v[92:95]
s_waitcnt vmcnt(16)
v_mfma_f32_16x16x32_bf16 v[80:83], v[220:223], a[64:67], v[80:83]
s_add_u32 s68, s68, 4096
buffer_load_dwordx4 v[216:219], v59, s[44:47], s68 offen offset:0 sc1
v_mfma_f32_16x16x32_bf16 v[84:87], v[220:223], a[136:139], v[84:87]
v_mfma_f32_16x16x32_bf16 v[88:91], v[220:223], a[208:211], v[88:91]
v_mfma_f32_16x16x32_bf16 v[92:95], v[220:223], v[32:35], v[92:95]
s_waitcnt vmcnt(15)
v_mfma_f32_16x16x32_bf16 v[80:83], v[224:227], a[68:71], v[80:83]
buffer_load_dwordx4 v[220:223], v59, s[44:47], s68 offen offset:1024 sc1
v_mfma_f32_16x16x32_bf16 v[84:87], v[224:227], a[140:143], v[84:87]
v_mfma_f32_16x16x32_bf16 v[88:91], v[224:227], a[212:215], v[88:91]
v_mfma_f32_16x16x32_bf16 v[92:95], v[224:227], v[36:39], v[92:95]
s_waitcnt vmcnt(15)
v_mfma_f32_16x16x32_bf16 v[96:99], v[228:231], v[112:115], 0
buffer_load_dwordx4 v[224:227], v59, s[44:47], s68 offen offset:2048 sc1
v_mfma_f32_16x16x32_bf16 v[100:103], v[228:231], v[124:127], 0
v_mfma_f32_16x16x32_bf16 v[104:107], v[228:231], v[136:139], 0
v_mfma_f32_16x16x32_bf16 v[108:111], v[228:231], v[148:151], 0
s_waitcnt vmcnt(15)
v_mfma_f32_16x16x32_bf16 v[96:99], v[232:235], v[116:119], v[96:99]
buffer_load_dwordx4 v[228:231], v59, s[44:47], s68 offen offset:3072 sc1
v_mfma_f32_16x16x32_bf16 v[100:103], v[232:235], v[128:131], v[100:103]
v_mfma_f32_16x16x32_bf16 v[104:107], v[232:235], v[140:143], v[104:107]
v_cvt_pk_bf16_f32 v168, v80, v81
v_mfma_f32_16x16x32_bf16 v[108:111], v[232:235], v[152:155], v[108:111]
v_cvt_pk_bf16_f32 v169, v82, v83
s_waitcnt vmcnt(14)
v_mfma_f32_16x16x32_bf16 v[96:99], v[236:239], v[120:123], v[96:99]
s_add_u32 s68, s68, 4096
buffer_load_dwordx4 v[232:235], v59, s[44:47], s68 offen offset:0 sc1
v_mfma_f32_16x16x32_bf16 v[100:103], v[236:239], v[132:135], v[100:103]
v_cvt_pk_bf16_f32 v170, v84, v85
v_mfma_f32_16x16x32_bf16 v[104:107], v[236:239], v[144:147], v[104:107]
v_cvt_pk_bf16_f32 v171, v86, v87
v_mfma_f32_16x16x32_bf16 v[108:111], v[236:239], v[156:159], v[108:111]
s_nop 0
s_waitcnt vmcnt(14)
v_mfma_f32_16x16x32_bf16 v[96:99], v[240:243], a[0:3], v[96:99]
buffer_load_dwordx4 v[236:239], v59, s[44:47], s68 offen offset:1024 sc1
v_mfma_f32_16x16x32_bf16 v[100:103], v[240:243], a[72:75], v[100:103]
v_permlane16_swap_b32 v168, v170
v_mfma_f32_16x16x32_bf16 v[104:107], v[240:243], a[144:147], v[104:107]
v_permlane16_swap_b32 v169, v171
v_mfma_f32_16x16x32_bf16 v[108:111], v[240:243], a[216:219], v[108:111]
s_waitcnt vmcnt(14)
v_mfma_f32_16x16x32_bf16 v[96:99], v[244:247], a[4:7], v[96:99]
buffer_load_dwordx4 v[240:243], v59, s[44:47], s68 offen offset:2048 sc1
v_mfma_f32_16x16x32_bf16 v[100:103], v[244:247], a[76:79], v[100:103]
v_mfma_f32_16x16x32_bf16 v[104:107], v[244:247], a[148:151], v[104:107]
buffer_store_dwordx4 v[168:171], v70, s[44:47], s69 offen offset:0 sc0 sc1
ds_write_b128 v72, v[168:171] offset:256
v_mfma_f32_16x16x32_bf16 v[108:111], v[244:247], a[220:223], v[108:111]
v_cvt_pk_bf16_f32 v172, v88, v89
s_waitcnt vmcnt(15)
v_mfma_f32_16x16x32_bf16 v[96:99], v[248:251], a[8:11], v[96:99]
buffer_load_dwordx4 v[244:247], v59, s[44:47], s68 offen offset:3072 sc1
v_mfma_f32_16x16x32_bf16 v[100:103], v[248:251], a[80:83], v[100:103]
v_cvt_pk_bf16_f32 v173, v90, v91
v_mfma_f32_16x16x32_bf16 v[104:107], v[248:251], a[152:155], v[104:107]
v_cvt_pk_bf16_f32 v174, v92, v93
v_mfma_f32_16x16x32_bf16 v[108:111], v[248:251], a[224:227], v[108:111]
v_cvt_pk_bf16_f32 v175, v94, v95
s_waitcnt vmcnt(15)
v_mfma_f32_16x16x32_bf16 v[96:99], v[188:191], a[12:15], v[96:99]
s_add_u32 s68, s68, 4096
buffer_load_dwordx4 v[248:251], v59, s[44:47], s68 offen offset:0 sc1
v_mfma_f32_16x16x32_bf16 v[100:103], v[188:191], a[84:87], v[100:103]
s_nop 0
v_mfma_f32_16x16x32_bf16 v[104:107], v[188:191], a[156:159], v[104:107]
v_permlane16_swap_b32 v172, v174
v_mfma_f32_16x16x32_bf16 v[108:111], v[188:191], a[228:231], v[108:111]
v_permlane16_swap_b32 v173, v175
s_waitcnt vmcnt(15)
v_mfma_f32_16x16x32_bf16 v[96:99], v[192:195], a[16:19], v[96:99]
buffer_load_dwordx4 v[188:191], v59, s[44:47], s68 offen offset:1024 sc1
v_mfma_f32_16x16x32_bf16 v[100:103], v[192:195], a[88:91], v[100:103]
v_mfma_f32_16x16x32_bf16 v[104:107], v[192:195], a[160:163], v[104:107]
v_mfma_f32_16x16x32_bf16 v[108:111], v[192:195], a[232:235], v[108:111]
buffer_store_dwordx4 v[172:175], v71, s[44:47], s69 offen offset:1024 sc0 sc1
ds_write_b128 v73, v[172:175] offset:256
s_add_u32 s69, s69, 8192
s_waitcnt vmcnt(16)
v_mfma_f32_16x16x32_bf16 v[96:99], v[196:199], a[20:23], v[96:99]
buffer_load_dwordx4 v[192:195], v59, s[44:47], s68 offen offset:2048 sc1
v_mfma_f32_16x16x32_bf16 v[100:103], v[196:199], a[92:95], v[100:103]
v_mfma_f32_16x16x32_bf16 v[104:107], v[196:199], a[164:167], v[104:107]
v_mfma_f32_16x16x32_bf16 v[108:111], v[196:199], a[236:239], v[108:111]
s_waitcnt vmcnt(16)
v_mfma_f32_16x16x32_bf16 v[96:99], v[200:203], a[24:27], v[96:99]
buffer_load_dwordx4 v[196:199], v59, s[44:47], s68 offen offset:3072 sc1
v_mfma_f32_16x16x32_bf16 v[100:103], v[200:203], a[96:99], v[100:103]
v_mfma_f32_16x16x32_bf16 v[104:107], v[200:203], a[168:171], v[104:107]
v_mfma_f32_16x16x32_bf16 v[108:111], v[200:203], a[240:243], v[108:111]
s_waitcnt vmcnt(16)
v_mfma_f32_16x16x32_bf16 v[96:99], v[204:207], a[28:31], v[96:99]
s_add_u32 s68, s68, 4096
buffer_load_dwordx4 v[200:203], v59, s[44:47], s68 offen offset:0 sc1
v_mfma_f32_16x16x32_bf16 v[100:103], v[204:207], a[100:103], v[100:103]
v_mfma_f32_16x16x32_bf16 v[104:107], v[204:207], a[172:175], v[104:107]
v_mfma_f32_16x16x32_bf16 v[108:111], v[204:207], a[244:247], v[108:111]
s_waitcnt vmcnt(16)
v_mfma_f32_16x16x32_bf16 v[96:99], v[208:211], a[32:35], v[96:99]
buffer_load_dwordx4 v[204:207], v59, s[44:47], s68 offen offset:1024 sc1
v_mfma_f32_16x16x32_bf16 v[100:103], v[208:211], a[104:107], v[100:103]
v_mfma_f32_16x16x32_bf16 v[104:107], v[208:211], a[176:179], v[104:107]
v_mfma_f32_16x16x32_bf16 v[108:111], v[208:211], a[248:251], v[108:111]
s_waitcnt vmcnt(16)
v_mfma_f32_16x16x32_bf16 v[96:99], v[212:215], a[36:39], v[96:99]
buffer_load_dwordx4 v[208:211], v59, s[44:47], s68 offen offset:2048 sc1
v_mfma_f32_16x16x32_bf16 v[100:103], v[212:215], a[108:111], v[100:103]
v_mfma_f32_16x16x32_bf16 v[104:107], v[212:215], a[180:183], v[104:107]
v_mfma_f32_16x16x32_bf16 v[108:111], v[212:215], a[252:255], v[108:111]
s_waitcnt vmcnt(16)
v_mfma_f32_16x16x32_bf16 v[96:99], v[216:219], a[40:43], v[96:99]
buffer_load_dwordx4 v[212:215], v59, s[44:47], s68 offen offset:3072 sc1
v_mfma_f32_16x16x32_bf16 v[100:103], v[216:219], a[112:115], v[100:103]
v_mfma_f32_16x16x32_bf16 v[104:107], v[216:219], a[184:187], v[104:107]
v_mfma_f32_16x16x32_bf16 v[108:111], v[216:219], v[8:11], v[108:111]
s_waitcnt vmcnt(16)
v_mfma_f32_16x16x32_bf16 v[96:99], v[220:223], a[44:47], v[96:99]
s_add_u32 s68, s68, 4096
buffer_load_dwordx4 v[216:219], v59, s[44:47], s68 offen offset:0 sc1
v_mfma_f32_16x16x32_bf16 v[100:103], v[220:223], a[116:119], v[100:103]
v_mfma_f32_16x16x32_bf16 v[104:107], v[220:223], a[188:191], v[104:107]
v_mfma_f32_16x16x32_bf16 v[108:111], v[220:223], v[12:15], v[108:111]
s_waitcnt vmcnt(16)
v_mfma_f32_16x16x32_bf16 v[96:99], v[224:227], a[48:51], v[96:99]
buffer_load_dwordx4 v[220:223], v59, s[44:47], s68 offen offset:1024 sc1
v_mfma_f32_16x16x32_bf16 v[100:103], v[224:227], a[120:123], v[100:103]
v_mfma_f32_16x16x32_bf16 v[104:107], v[224:227], a[192:195], v[104:107]
v_mfma_f32_16x16x32_bf16 v[108:111], v[224:227], v[16:19], v[108:111]
s_waitcnt vmcnt(16)
v_mfma_f32_16x16x32_bf16 v[96:99], v[228:231], a[52:55], v[96:99]
buffer_load_dwordx4 v[224:227], v59, s[44:47], s68 offen offset:2048 sc1
v_mfma_f32_16x16x32_bf16 v[100:103], v[228:231], a[124:127], v[100:103]
v_mfma_f32_16x16x32_bf16 v[104:107], v[228:231], a[196:199], v[104:107]
v_mfma_f32_16x16x32_bf16 v[108:111], v[228:231], v[20:23], v[108:111]
s_waitcnt vmcnt(16)
v_mfma_f32_16x16x32_bf16 v[96:99], v[232:235], a[56:59], v[96:99]
buffer_load_dwordx4 v[228:231], v59, s[44:47], s68 offen offset:3072 sc1
v_mfma_f32_16x16x32_bf16 v[100:103], v[232:235], a[128:131], v[100:103]
v_mfma_f32_16x16x32_bf16 v[104:107], v[232:235], a[200:203], v[104:107]
v_mfma_f32_16x16x32_bf16 v[108:111], v[232:235], v[24:27], v[108:111]
s_waitcnt vmcnt(16)
v_mfma_f32_16x16x32_bf16 v[96:99], v[236:239], a[60:63], v[96:99]
s_add_u32 s68, s68, 4096
buffer_load_dwordx4 v[232:235], v59, s[44:47], s68 offen offset:0 sc1
v_mfma_f32_16x16x32_bf16 v[100:103], v[236:239], a[132:135], v[100:103]
v_mfma_f32_16x16x32_bf16 v[104:107], v[236:239], a[204:207], v[104:107]
v_mfma_f32_16x16x32_bf16 v[108:111], v[236:239], v[28:31], v[108:111]
s_waitcnt vmcnt(16)
v_mfma_f32_16x16x32_bf16 v[96:99], v[240:243], a[64:67], v[96:99]
buffer_load_dwordx4 v[236:239], v59, s[44:47], s68 offen offset:1024 sc1
v_mfma_f32_16x16x32_bf16 v[100:103], v[240:243], a[136:139], v[100:103]
v_mfma_f32_16x16x32_bf16 v[104:107], v[240:243], a[208:211], v[104:107]
v_mfma_f32_16x16x32_bf16 v[108:111], v[240:243], v[32:35], v[108:111]
s_waitcnt vmcnt(15)
v_mfma_f32_16x16x32_bf16 v[96:99], v[244:247], a[68:71], v[96:99]
buffer_load_dwordx4 v[240:243], v59, s[44:47], s68 offen offset:2048 sc1
v_mfma_f32_16x16x32_bf16 v[100:103], v[244:247], a[140:143], v[100:103]
v_mfma_f32_16x16x32_bf16 v[104:107], v[244:247], a[212:215], v[104:107]
v_mfma_f32_16x16x32_bf16 v[108:111], v[244:247], v[36:39], v[108:111]
s_waitcnt vmcnt(15)
v_mfma_f32_16x16x32_bf16 v[80:83], v[248:251], v[112:115], 0
buffer_load_dwordx4 v[244:247], v59, s[44:47], s68 offen offset:3072 sc1
v_mfma_f32_16x16x32_bf16 v[84:87], v[248:251], v[124:127], 0
v_mfma_f32_16x16x32_bf16 v[88:91], v[248:251], v[136:139], 0
v_mfma_f32_16x16x32_bf16 v[92:95], v[248:251], v[148:151], 0
s_waitcnt vmcnt(15)
v_mfma_f32_16x16x32_bf16 v[80:83], v[188:191], v[116:119], v[80:83]
s_add_u32 s68, s68, 4096
buffer_load_dwordx4 v[248:251], v59, s[44:47], s68 offen offset:0 sc1
v_mfma_f32_16x16x32_bf16 v[84:87], v[188:191], v[128:131], v[84:87]
v_mfma_f32_16x16x32_bf16 v[88:91], v[188:191], v[140:143], v[88:91]
v_cvt_pk_bf16_f32 v160, v96, v97
v_mfma_f32_16x16x32_bf16 v[92:95], v[188:191], v[152:155], v[92:95]
v_cvt_pk_bf16_f32 v161, v98, v99
s_waitcnt vmcnt(14)
v_mfma_f32_16x16x32_bf16 v[80:83], v[192:195], v[120:123], v[80:83]
buffer_load_dwordx4 v[188:191], v59, s[44:47], s68 offen offset:1024 sc1
v_mfma_f32_16x16x32_bf16 v[84:87], v[192:195], v[132:135], v[84:87]
v_cvt_pk_bf16_f32 v162, v100, v101
v_mfma_f32_16x16x32_bf16 v[88:91], v[192:195], v[144:147], v[88:91]
v_cvt_pk_bf16_f32 v163, v102, v103
v_mfma_f32_16x16x32_bf16 v[92:95], v[192:195], v[156:159], v[92:95]
s_nop 0
s_waitcnt vmcnt(14)
v_mfma_f32_16x16x32_bf16 v[80:83], v[196:199], a[0:3], v[80:83]
buffer_load_dwordx4 v[192:195], v59, s[44:47], s68 offen offset:2048 sc1
v_mfma_f32_16x16x32_bf16 v[84:87], v[196:199], a[72:75], v[84:87]
v_permlane16_swap_b32 v160, v162
v_mfma_f32_16x16x32_bf16 v[88:91], v[196:199], a[144:147], v[88:91]
v_permlane16_swap_b32 v161, v163
v_mfma_f32_16x16x32_bf16 v[92:95], v[196:199], a[216:219], v[92:95]
s_waitcnt vmcnt(14)
v_mfma_f32_16x16x32_bf16 v[80:83], v[200:203], a[4:7], v[80:83]
buffer_load_dwordx4 v[196:199], v59, s[44:47], s68 offen offset:3072 sc1
v_mfma_f32_16x16x32_bf16 v[84:87], v[200:203], a[76:79], v[84:87]
v_mfma_f32_16x16x32_bf16 v[88:91], v[200:203], a[148:151], v[88:91]
buffer_store_dwordx4 v[160:163], v70, s[44:47], s69 offen offset:0 sc0 sc1
ds_write_b128 v72, v[160:163] offset:512
v_mfma_f32_16x16x32_bf16 v[92:95], v[200:203], a[220:223], v[92:95]
v_cvt_pk_bf16_f32 v164, v104, v105
s_waitcnt vmcnt(15)
v_mfma_f32_16x16x32_bf16 v[80:83], v[204:207], a[8:11], v[80:83]
s_add_u32 s68, s68, 4096
buffer_load_dwordx4 v[200:203], v59, s[44:47], s68 offen offset:0 sc1
v_mfma_f32_16x16x32_bf16 v[84:87], v[204:207], a[80:83], v[84:87]
v_cvt_pk_bf16_f32 v165, v106, v107
v_mfma_f32_16x16x32_bf16 v[88:91], v[204:207], a[152:155], v[88:91]
v_cvt_pk_bf16_f32 v166, v108, v109
v_mfma_f32_16x16x32_bf16 v[92:95], v[204:207], a[224:227], v[92:95]
v_cvt_pk_bf16_f32 v167, v110, v111
s_waitcnt vmcnt(15)
v_mfma_f32_16x16x32_bf16 v[80:83], v[208:211], a[12:15], v[80:83]
buffer_load_dwordx4 v[204:207], v59, s[44:47], s68 offen offset:1024 sc1
v_mfma_f32_16x16x32_bf16 v[84:87], v[208:211], a[84:87], v[84:87]
s_nop 0
v_mfma_f32_16x16x32_bf16 v[88:91], v[208:211], a[156:159], v[88:91]
v_permlane16_swap_b32 v164, v166
v_mfma_f32_16x16x32_bf16 v[92:95], v[208:211], a[228:231], v[92:95]
v_permlane16_swap_b32 v165, v167
s_waitcnt vmcnt(15)
v_mfma_f32_16x16x32_bf16 v[80:83], v[212:215], a[16:19], v[80:83]
buffer_load_dwordx4 v[208:211], v59, s[44:47], s68 offen offset:2048 sc1
v_mfma_f32_16x16x32_bf16 v[84:87], v[212:215], a[88:91], v[84:87]
v_mfma_f32_16x16x32_bf16 v[88:91], v[212:215], a[160:163], v[88:91]
v_mfma_f32_16x16x32_bf16 v[92:95], v[212:215], a[232:235], v[92:95]
buffer_store_dwordx4 v[164:167], v71, s[44:47], s69 offen offset:1024 sc0 sc1
ds_write_b128 v73, v[164:167] offset:512
s_add_u32 s69, s69, 8192
s_waitcnt vmcnt(16)
v_mfma_f32_16x16x32_bf16 v[80:83], v[216:219], a[20:23], v[80:83]
buffer_load_dwordx4 v[212:215], v59, s[44:47], s68 offen offset:3072 sc1
v_mfma_f32_16x16x32_bf16 v[84:87], v[216:219], a[92:95], v[84:87]
v_mfma_f32_16x16x32_bf16 v[88:91], v[216:219], a[164:167], v[88:91]
v_mfma_f32_16x16x32_bf16 v[92:95], v[216:219], a[236:239], v[92:95]
s_waitcnt vmcnt(16)
v_mfma_f32_16x16x32_bf16 v[80:83], v[220:223], a[24:27], v[80:83]
s_add_u32 s68, s68, 4096
buffer_load_dwordx4 v[216:219], v59, s[44:47], s68 offen offset:0 sc1
v_mfma_f32_16x16x32_bf16 v[84:87], v[220:223], a[96:99], v[84:87]
v_mfma_f32_16x16x32_bf16 v[88:91], v[220:223], a[168:171], v[88:91]
v_mfma_f32_16x16x32_bf16 v[92:95], v[220:223], a[240:243], v[92:95]
s_waitcnt vmcnt(16)
v_mfma_f32_16x16x32_bf16 v[80:83], v[224:227], a[28:31], v[80:83]
buffer_load_dwordx4 v[220:223], v59, s[44:47], s68 offen offset:1024 sc1
v_mfma_f32_16x16x32_bf16 v[84:87], v[224:227], a[100:103], v[84:87]
v_mfma_f32_16x16x32_bf16 v[88:91], v[224:227], a[172:175], v[88:91]
v_mfma_f32_16x16x32_bf16 v[92:95], v[224:227], a[244:247], v[92:95]
s_waitcnt vmcnt(16)
v_mfma_f32_16x16x32_bf16 v[80:83], v[228:231], a[32:35], v[80:83]
buffer_load_dwordx4 v[224:227], v59, s[44:47], s68 offen offset:2048 sc1
v_mfma_f32_16x16x32_bf16 v[84:87], v[228:231], a[104:107], v[84:87]
v_mfma_f32_16x16x32_bf16 v[88:91], v[228:231], a[176:179], v[88:91]
v_mfma_f32_16x16x32_bf16 v[92:95], v[228:231], a[248:251], v[92:95]
s_waitcnt vmcnt(16)
v_mfma_f32_16x16x32_bf16 v[80:83], v[232:235], a[36:39], v[80:83]
buffer_load_dwordx4 v[228:231], v59, s[44:47], s68 offen offset:3072 sc1
v_mfma_f32_16x16x32_bf16 v[84:87], v[232:235], a[108:111], v[84:87]
v_mfma_f32_16x16x32_bf16 v[88:91], v[232:235], a[180:183], v[88:91]
v_mfma_f32_16x16x32_bf16 v[92:95], v[232:235], a[252:255], v[92:95]
s_waitcnt vmcnt(16)
v_mfma_f32_16x16x32_bf16 v[80:83], v[236:239], a[40:43], v[80:83]
s_add_u32 s68, s68, 4096
buffer_load_dwordx4 v[232:235], v59, s[44:47], s68 offen offset:0 sc1
v_mfma_f32_16x16x32_bf16 v[84:87], v[236:239], a[112:115], v[84:87]
v_mfma_f32_16x16x32_bf16 v[88:91], v[236:239], a[184:187], v[88:91]
v_mfma_f32_16x16x32_bf16 v[92:95], v[236:239], v[8:11], v[92:95]
s_waitcnt vmcnt(16)
v_mfma_f32_16x16x32_bf16 v[80:83], v[240:243], a[44:47], v[80:83]
buffer_load_dwordx4 v[236:239], v59, s[44:47], s68 offen offset:1024 sc1
v_mfma_f32_16x16x32_bf16 v[84:87], v[240:243], a[116:119], v[84:87]
v_mfma_f32_16x16x32_bf16 v[88:91], v[240:243], a[188:191], v[88:91]
v_mfma_f32_16x16x32_bf16 v[92:95], v[240:243], v[12:15], v[92:95]
s_waitcnt vmcnt(16)
v_mfma_f32_16x16x32_bf16 v[80:83], v[244:247], a[48:51], v[80:83]
buffer_load_dwordx4 v[240:243], v59, s[44:47], s68 offen offset:2048 sc1
v_mfma_f32_16x16x32_bf16 v[84:87], v[244:247], a[120:123], v[84:87]
v_mfma_f32_16x16x32_bf16 v[88:91], v[244:247], a[192:195], v[88:91]
v_mfma_f32_16x16x32_bf16 v[92:95], v[244:247], v[16:19], v[92:95]
s_waitcnt vmcnt(16)
v_mfma_f32_16x16x32_bf16 v[80:83], v[248:251], a[52:55], v[80:83]
buffer_load_dwordx4 v[244:247], v59, s[44:47], s68 offen offset:3072 sc1
v_mfma_f32_16x16x32_bf16 v[84:87], v[248:251], a[124:127], v[84:87]
v_mfma_f32_16x16x32_bf16 v[88:91], v[248:251], a[196:199], v[88:91]
v_mfma_f32_16x16x32_bf16 v[92:95], v[248:251], v[20:23], v[92:95]
s_waitcnt vmcnt(16)
v_mfma_f32_16x16x32_bf16 v[80:83], v[188:191], a[56:59], v[80:83]
s_add_u32 s68, s68, 4096
buffer_load_dwordx4 v[248:251], v59, s[44:47], s68 offen offset:0 sc1
v_mfma_f32_16x16x32_bf16 v[84:87], v[188:191], a[128:131], v[84:87]
v_mfma_f32_16x16x32_bf16 v[88:91], v[188:191], a[200:203], v[88:91]
v_mfma_f32_16x16x32_bf16 v[92:95], v[188:191], v[24:27], v[92:95]
s_waitcnt vmcnt(16)
v_mfma_f32_16x16x32_bf16 v[80:83], v[192:195], a[60:63], v[80:83]
buffer_load_dwordx4 v[188:191], v59, s[44:47], s68 offen offset:1024 sc1
v_mfma_f32_16x16x32_bf16 v[84:87], v[192:195], a[132:135], v[84:87]
v_mfma_f32_16x16x32_bf16 v[88:91], v[192:195], a[204:207], v[88:91]
v_mfma_f32_16x16x32_bf16 v[92:95], v[192:195], v[28:31], v[92:95]
s_waitcnt vmcnt(16)
v_mfma_f32_16x16x32_bf16 v[80:83], v[196:199], a[64:67], v[80:83]
buffer_load_dwordx4 v[192:195], v59, s[44:47], s68 offen offset:2048 sc1
v_mfma_f32_16x16x32_bf16 v[84:87], v[196:199], a[136:139], v[84:87]
v_mfma_f32_16x16x32_bf16 v[88:91], v[196:199], a[208:211], v[88:91]
v_mfma_f32_16x16x32_bf16 v[92:95], v[196:199], v[32:35], v[92:95]
s_waitcnt vmcnt(15)
v_mfma_f32_16x16x32_bf16 v[80:83], v[200:203], a[68:71], v[80:83]
buffer_load_dwordx4 v[196:199], v59, s[44:47], s68 offen offset:3072 sc1
v_mfma_f32_16x16x32_bf16 v[84:87], v[200:203], a[140:143], v[84:87]
v_mfma_f32_16x16x32_bf16 v[88:91], v[200:203], a[212:215], v[88:91]
v_mfma_f32_16x16x32_bf16 v[92:95], v[200:203], v[36:39], v[92:95]
s_waitcnt vmcnt(15)
v_mfma_f32_16x16x32_bf16 v[96:99], v[204:207], v[112:115], 0
s_add_u32 s68, s68, 4096
buffer_load_dwordx4 v[200:203], v59, s[44:47], s68 offen offset:0 sc1
v_mfma_f32_16x16x32_bf16 v[100:103], v[204:207], v[124:127], 0
v_mfma_f32_16x16x32_bf16 v[104:107], v[204:207], v[136:139], 0
v_mfma_f32_16x16x32_bf16 v[108:111], v[204:207], v[148:151], 0
s_waitcnt vmcnt(15)
v_mfma_f32_16x16x32_bf16 v[96:99], v[208:211], v[116:119], v[96:99]
buffer_load_dwordx4 v[204:207], v59, s[44:47], s68 offen offset:1024 sc1
v_mfma_f32_16x16x32_bf16 v[100:103], v[208:211], v[128:131], v[100:103]
v_mfma_f32_16x16x32_bf16 v[104:107], v[208:211], v[140:143], v[104:107]
v_cvt_pk_bf16_f32 v168, v80, v81
v_mfma_f32_16x16x32_bf16 v[108:111], v[208:211], v[152:155], v[108:111]
v_cvt_pk_bf16_f32 v169, v82, v83
s_waitcnt vmcnt(14)
v_mfma_f32_16x16x32_bf16 v[96:99], v[212:215], v[120:123], v[96:99]
buffer_load_dwordx4 v[208:211], v59, s[44:47], s68 offen offset:2048 sc1
v_mfma_f32_16x16x32_bf16 v[100:103], v[212:215], v[132:135], v[100:103]
v_cvt_pk_bf16_f32 v170, v84, v85
v_mfma_f32_16x16x32_bf16 v[104:107], v[212:215], v[144:147], v[104:107]
v_cvt_pk_bf16_f32 v171, v86, v87
v_mfma_f32_16x16x32_bf16 v[108:111], v[212:215], v[156:159], v[108:111]
s_nop 0
s_waitcnt vmcnt(14)
v_mfma_f32_16x16x32_bf16 v[96:99], v[216:219], a[0:3], v[96:99]
buffer_load_dwordx4 v[212:215], v59, s[44:47], s68 offen offset:3072 sc1
v_mfma_f32_16x16x32_bf16 v[100:103], v[216:219], a[72:75], v[100:103]
v_permlane16_swap_b32 v168, v170
v_mfma_f32_16x16x32_bf16 v[104:107], v[216:219], a[144:147], v[104:107]
v_permlane16_swap_b32 v169, v171
v_mfma_f32_16x16x32_bf16 v[108:111], v[216:219], a[216:219], v[108:111]
s_waitcnt vmcnt(14)
v_mfma_f32_16x16x32_bf16 v[96:99], v[220:223], a[4:7], v[96:99]
s_add_u32 s68, s68, 4096
buffer_load_dwordx4 v[216:219], v59, s[44:47], s68 offen offset:0 sc1
v_mfma_f32_16x16x32_bf16 v[100:103], v[220:223], a[76:79], v[100:103]
v_mfma_f32_16x16x32_bf16 v[104:107], v[220:223], a[148:151], v[104:107]
buffer_store_dwordx4 v[168:171], v70, s[44:47], s69 offen offset:0 sc0 sc1
ds_write_b128 v72, v[168:171] offset:768
v_mfma_f32_16x16x32_bf16 v[108:111], v[220:223], a[220:223], v[108:111]
v_cvt_pk_bf16_f32 v172, v88, v89
s_waitcnt vmcnt(15)
v_mfma_f32_16x16x32_bf16 v[96:99], v[224:227], a[8:11], v[96:99]
buffer_load_dwordx4 v[220:223], v59, s[44:47], s68 offen offset:1024 sc1
v_mfma_f32_16x16x32_bf16 v[100:103], v[224:227], a[80:83], v[100:103]
v_cvt_pk_bf16_f32 v173, v90, v91
v_mfma_f32_16x16x32_bf16 v[104:107], v[224:227], a[152:155], v[104:107]
v_cvt_pk_bf16_f32 v174, v92, v93
v_mfma_f32_16x16x32_bf16 v[108:111], v[224:227], a[224:227], v[108:111]
v_cvt_pk_bf16_f32 v175, v94, v95
s_waitcnt vmcnt(15)
v_mfma_f32_16x16x32_bf16 v[96:99], v[228:231], a[12:15], v[96:99]
buffer_load_dwordx4 v[224:227], v59, s[44:47], s68 offen offset:2048 sc1
v_mfma_f32_16x16x32_bf16 v[100:103], v[228:231], a[84:87], v[100:103]
s_nop 0
v_mfma_f32_16x16x32_bf16 v[104:107], v[228:231], a[156:159], v[104:107]
v_permlane16_swap_b32 v172, v174
v_mfma_f32_16x16x32_bf16 v[108:111], v[228:231], a[228:231], v[108:111]
v_permlane16_swap_b32 v173, v175
s_waitcnt vmcnt(15)
v_mfma_f32_16x16x32_bf16 v[96:99], v[232:235], a[16:19], v[96:99]
buffer_load_dwordx4 v[228:231], v59, s[44:47], s68 offen offset:3072 sc1
v_mfma_f32_16x16x32_bf16 v[100:103], v[232:235], a[88:91], v[100:103]
v_mfma_f32_16x16x32_bf16 v[104:107], v[232:235], a[160:163], v[104:107]
v_mfma_f32_16x16x32_bf16 v[108:111], v[232:235], a[232:235], v[108:111]
buffer_store_dwordx4 v[172:175], v71, s[44:47], s69 offen offset:1024 sc0 sc1
ds_write_b128 v73, v[172:175] offset:768
s_add_u32 s69, s69, 8192
s_waitcnt vmcnt(16)
v_mfma_f32_16x16x32_bf16 v[96:99], v[236:239], a[20:23], v[96:99]
s_add_u32 s68, s68, 4096
buffer_load_dwordx4 v[232:235], v59, s[44:47], s68 offen offset:0 sc1
v_mfma_f32_16x16x32_bf16 v[100:103], v[236:239], a[92:95], v[100:103]
v_mfma_f32_16x16x32_bf16 v[104:107], v[236:239], a[164:167], v[104:107]
v_mfma_f32_16x16x32_bf16 v[108:111], v[236:239], a[236:239], v[108:111]
s_waitcnt vmcnt(16)
v_mfma_f32_16x16x32_bf16 v[96:99], v[240:243], a[24:27], v[96:99]
buffer_load_dwordx4 v[236:239], v59, s[44:47], s68 offen offset:1024 sc1
v_mfma_f32_16x16x32_bf16 v[100:103], v[240:243], a[96:99], v[100:103]
v_mfma_f32_16x16x32_bf16 v[104:107], v[240:243], a[168:171], v[104:107]
v_mfma_f32_16x16x32_bf16 v[108:111], v[240:243], a[240:243], v[108:111]
s_waitcnt vmcnt(16)
v_mfma_f32_16x16x32_bf16 v[96:99], v[244:247], a[28:31], v[96:99]
buffer_load_dwordx4 v[240:243], v59, s[44:47], s68 offen offset:2048 sc1
v_mfma_f32_16x16x32_bf16 v[100:103], v[244:247], a[100:103], v[100:103]
v_mfma_f32_16x16x32_bf16 v[104:107], v[244:247], a[172:175], v[104:107]
v_mfma_f32_16x16x32_bf16 v[108:111], v[244:247], a[244:247], v[108:111]
s_waitcnt vmcnt(16)
v_mfma_f32_16x16x32_bf16 v[96:99], v[248:251], a[32:35], v[96:99]
buffer_load_dwordx4 v[244:247], v59, s[44:47], s68 offen offset:3072 sc1
v_mfma_f32_16x16x32_bf16 v[100:103], v[248:251], a[104:107], v[100:103]
v_mfma_f32_16x16x32_bf16 v[104:107], v[248:251], a[176:179], v[104:107]
v_mfma_f32_16x16x32_bf16 v[108:111], v[248:251], a[248:251], v[108:111]
s_add_u32 s90, s49, 1
s_and_b32 s90, s90, 7
s_mul_i32 s90, s90, 73728
s_add_u32 s91, s49, 2
s_and_b32 s91, s91, 7
s_mul_i32 s91, s91, 73728
s_add_u32 s92, s49, 3
s_and_b32 s92, s92, 7
s_mul_i32 s92, s92, 73728
s_add_u32 s93, s49, 4
s_and_b32 s93, s93, 7
s_mul_i32 s93, s93, 73728
s_add_u32 s94, s49, 5
s_and_b32 s94, s94, 7
s_mul_i32 s94, s94, 73728
s_add_u32 s95, s49, 6
s_and_b32 s95, s95, 7
s_mul_i32 s95, s95, 73728
s_add_u32 s96, s49, 7
s_and_b32 s96, s96, 7
s_mul_i32 s96, s96, 73728
s_mul_i32 s97, s50, 2304
s_add_u32 s97, s97, 86016
s_waitcnt vmcnt(16)
v_mfma_f32_16x16x32_bf16 v[96:99], v[188:191], a[36:39], v[96:99]
s_add_u32 s68, s68, 4096
buffer_load_dwordx4 v[248:251], v59, s[44:47], s68 offen offset:0 sc1
v_mfma_f32_16x16x32_bf16 v[100:103], v[188:191], a[108:111], v[100:103]
v_mfma_f32_16x16x32_bf16 v[104:107], v[188:191], a[180:183], v[104:107]
v_mfma_f32_16x16x32_bf16 v[108:111], v[188:191], a[252:255], v[108:111]
s_waitcnt vmcnt(16)
v_mfma_f32_16x16x32_bf16 v[96:99], v[192:195], a[40:43], v[96:99]
buffer_load_dwordx4 v[188:191], v59, s[44:47], s68 offen offset:1024 sc1
v_mfma_f32_16x16x32_bf16 v[100:103], v[192:195], a[112:115], v[100:103]
v_mfma_f32_16x16x32_bf16 v[104:107], v[192:195], a[184:187], v[104:107]
v_mfma_f32_16x16x32_bf16 v[108:111], v[192:195], v[8:11], v[108:111]
s_waitcnt vmcnt(16)
v_mfma_f32_16x16x32_bf16 v[96:99], v[196:199], a[44:47], v[96:99]
buffer_load_dwordx4 v[192:195], v59, s[44:47], s68 offen offset:2048 sc1
v_mfma_f32_16x16x32_bf16 v[100:103], v[196:199], a[116:119], v[100:103]
v_mfma_f32_16x16x32_bf16 v[104:107], v[196:199], a[188:191], v[104:107]
v_mfma_f32_16x16x32_bf16 v[108:111], v[196:199], v[12:15], v[108:111]
s_waitcnt vmcnt(16)
v_mfma_f32_16x16x32_bf16 v[96:99], v[200:203], a[48:51], v[96:99]
buffer_load_dwordx4 v[196:199], v59, s[44:47], s68 offen offset:3072 sc1
v_mfma_f32_16x16x32_bf16 v[100:103], v[200:203], a[120:123], v[100:103]
v_mfma_f32_16x16x32_bf16 v[104:107], v[200:203], a[192:195], v[104:107]
v_mfma_f32_16x16x32_bf16 v[108:111], v[200:203], v[16:19], v[108:111]
s_waitcnt vmcnt(16)
v_mfma_f32_16x16x32_bf16 v[96:99], v[204:207], a[52:55], v[96:99]
s_add_u32 s68, s68, 4096
buffer_load_dwordx4 v[200:203], v59, s[44:47], s68 offen offset:0 sc1
v_mfma_f32_16x16x32_bf16 v[100:103], v[204:207], a[124:127], v[100:103]
v_mfma_f32_16x16x32_bf16 v[104:107], v[204:207], a[196:199], v[104:107]
v_mfma_f32_16x16x32_bf16 v[108:111], v[204:207], v[20:23], v[108:111]
s_waitcnt vmcnt(16)
v_mfma_f32_16x16x32_bf16 v[96:99], v[208:211], a[56:59], v[96:99]
buffer_load_dwordx4 v[204:207], v59, s[44:47], s68 offen offset:1024 sc1
v_mfma_f32_16x16x32_bf16 v[100:103], v[208:211], a[128:131], v[100:103]
v_mfma_f32_16x16x32_bf16 v[104:107], v[208:211], a[200:203], v[104:107]
v_mfma_f32_16x16x32_bf16 v[108:111], v[208:211], v[24:27], v[108:111]
s_waitcnt vmcnt(16)
v_mfma_f32_16x16x32_bf16 v[96:99], v[212:215], a[60:63], v[96:99]
buffer_load_dwordx4 v[208:211], v59, s[44:47], s68 offen offset:2048 sc1
v_mfma_f32_16x16x32_bf16 v[100:103], v[212:215], a[132:135], v[100:103]
v_mfma_f32_16x16x32_bf16 v[104:107], v[212:215], a[204:207], v[104:107]
v_mfma_f32_16x16x32_bf16 v[108:111], v[212:215], v[28:31], v[108:111]
s_waitcnt vmcnt(16)
v_mfma_f32_16x16x32_bf16 v[96:99], v[216:219], a[64:67], v[96:99]
buffer_load_dwordx4 v[212:215], v59, s[44:47], s68 offen offset:3072 sc1
v_mfma_f32_16x16x32_bf16 v[100:103], v[216:219], a[136:139], v[100:103]
v_mfma_f32_16x16x32_bf16 v[104:107], v[216:219], a[208:211], v[104:107]
v_mfma_f32_16x16x32_bf16 v[108:111], v[216:219], v[32:35], v[108:111]
s_waitcnt vmcnt(15)
v_mfma_f32_16x16x32_bf16 v[96:99], v[220:223], a[68:71], v[96:99]
s_add_u32 s68, s68, 4096
buffer_load_dwordx4 v[216:219], v59, s[44:47], s68 offen offset:0 sc1
v_mfma_f32_16x16x32_bf16 v[100:103], v[220:223], a[140:143], v[100:103]
v_mfma_f32_16x16x32_bf16 v[104:107], v[220:223], a[212:215], v[104:107]
v_mfma_f32_16x16x32_bf16 v[108:111], v[220:223], v[36:39], v[108:111]
s_waitcnt vmcnt(13)
s_mul_i32 s52, s63, 32
s_add_u32 s52, s52, s49
s_lshl_b32 s52, s52, 2
s_add_u32 s52, s52, 37958656
s_sub_u32 s53, s51, 6
v_mov_b32 v1, s52
v_mov_b32 v2, s53
s_mov_b64 exec, 1
buffer_store_dword v2, v1, s[44:47], 0 offen sc0 sc1
s_mov_b64 exec, -1
v_mfma_f32_16x16x32_bf16 v[80:83], v[224:227], v[112:115], 0
buffer_load_dwordx4 v[220:223], v59, s[44:47], s68 offen offset:1024 sc1
v_mfma_f32_16x16x32_bf16 v[84:87], v[224:227], v[124:127], 0
v_mfma_f32_16x16x32_bf16 v[88:91], v[224:227], v[136:139], 0
v_mfma_f32_16x16x32_bf16 v[92:95], v[224:227], v[148:151], 0
v_mfma_f32_16x16x32_bf16 v[80:83], v[228:231], v[116:119], v[80:83]
buffer_load_dwordx4 v[224:227], v59, s[44:47], s68 offen offset:2048 sc1
v_mfma_f32_16x16x32_bf16 v[84:87], v[228:231], v[128:131], v[84:87]
v_cvt_pk_bf16_f32 v160, v96, v97
v_mfma_f32_16x16x32_bf16 v[88:91], v[228:231], v[140:143], v[88:91]
v_cvt_pk_bf16_f32 v161, v98, v99
v_mfma_f32_16x16x32_bf16 v[92:95], v[228:231], v[152:155], v[92:95]
v_cvt_pk_bf16_f32 v162, v100, v101
v_cvt_pk_bf16_f32 v163, v102, v103
s_waitcnt vmcnt(15)
v_mfma_f32_16x16x32_bf16 v[80:83], v[232:235], v[120:123], v[80:83]
buffer_load_dwordx4 v[228:231], v59, s[44:47], s68 offen offset:3072 sc1
v_mfma_f32_16x16x32_bf16 v[84:87], v[232:235], v[132:135], v[84:87]
s_nop 0
v_mfma_f32_16x16x32_bf16 v[88:91], v[232:235], v[144:147], v[88:91]
v_permlane16_swap_b32 v160, v162
v_permlane16_swap_b32 v161, v163
v_mfma_f32_16x16x32_bf16 v[92:95], v[232:235], v[156:159], v[92:95]
s_waitcnt vmcnt(15)
v_mfma_f32_16x16x32_bf16 v[80:83], v[236:239], a[0:3], v[80:83]
s_add_u32 s68, s68, 4096
buffer_load_dwordx4 v[232:235], v59, s[44:47], s68 offen offset:0 sc1
v_mfma_f32_16x16x32_bf16 v[84:87], v[236:239], a[72:75], v[84:87]
buffer_store_dwordx4 v[160:163], v70, s[44:47], s69 offen offset:0 sc0 sc1
ds_write_b128 v72, v[160:163] offset:1024
v_mfma_f32_16x16x32_bf16 v[88:91], v[236:239], a[144:147], v[88:91]
v_cvt_pk_bf16_f32 v164, v104, v105
v_mfma_f32_16x16x32_bf16 v[92:95], v[236:239], a[216:219], v[92:95]
v_cvt_pk_bf16_f32 v165, v106, v107
v_cvt_pk_bf16_f32 v166, v108, v109
s_waitcnt vmcnt(16)
v_mfma_f32_16x16x32_bf16 v[80:83], v[240:243], a[4:7], v[80:83]
buffer_load_dwordx4 v[236:239], v59, s[44:47], s68 offen offset:1024 sc1
v_mfma_f32_16x16x32_bf16 v[84:87], v[240:243], a[76:79], v[84:87]
v_cvt_pk_bf16_f32 v167, v110, v111
v_mfma_f32_16x16x32_bf16 v[88:91], v[240:243], a[148:151], v[88:91]
s_nop 0
v_permlane16_swap_b32 v164, v166
v_mfma_f32_16x16x32_bf16 v[92:95], v[240:243], a[220:223], v[92:95]
v_permlane16_swap_b32 v165, v167
s_waitcnt vmcnt(16)
v_mfma_f32_16x16x32_bf16 v[80:83], v[244:247], a[8:11], v[80:83]
buffer_load_dwordx4 v[240:243], v59, s[44:47], s68 offen offset:2048 sc1
v_mfma_f32_16x16x32_bf16 v[84:87], v[244:247], a[80:83], v[84:87]
v_mfma_f32_16x16x32_bf16 v[88:91], v[244:247], a[152:155], v[88:91]
buffer_store_dwordx4 v[164:167], v71, s[44:47], s69 offen offset:1024 sc0 sc1
ds_write_b128 v73, v[164:167] offset:1024
s_add_u32 s69, s69, 8192
v_mfma_f32_16x16x32_bf16 v[92:95], v[244:247], a[224:227], v[92:95]
v_and_b32 v4, 7, v0
v_bfe_u32 v5, v0, 3, 1
s_waitcnt vmcnt(17)
v_mfma_f32_16x16x32_bf16 v[80:83], v[248:251], a[12:15], v[80:83]
buffer_load_dwordx4 v[244:247], v59, s[44:47], s68 offen offset:3072 sc1
v_mfma_f32_16x16x32_bf16 v[84:87], v[248:251], a[84:87], v[84:87]
v_lshrrev_b32 v6, 4, v0
v_mfma_f32_16x16x32_bf16 v[88:91], v[248:251], a[156:159], v[88:91]
v_lshlrev_b32 v7, 13, v6
v_lshl_add_u32 v7, v5, 9, v7
v_mfma_f32_16x16x32_bf16 v[92:95], v[248:251], a[228:231], v[92:95]
v_lshl_add_u32 v7, v4, 4, v7
s_waitcnt vmcnt(17)
v_mfma_f32_16x16x32_bf16 v[80:83], v[188:191], a[16:19], v[80:83]
s_add_u32 s68, s68, 4096
buffer_load_dwordx4 v[248:251], v59, s[44:47], s68 offen offset:0 sc1
v_mfma_f32_16x16x32_bf16 v[84:87], v[188:191], a[88:91], v[84:87]
s_lshr_b32 s70, s49, 2
v_mfma_f32_16x16x32_bf16 v[88:91], v[188:191], a[160:163], v[88:91]
s_lshl_b32 s70, s70, 10
s_and_b32 s71, s49, 3
v_mfma_f32_16x16x32_bf16 v[92:95], v[188:191], a[232:235], v[92:95]
s_lshl_b32 s71, s71, 7
s_waitcnt vmcnt(17)
v_mfma_f32_16x16x32_bf16 v[80:83], v[192:195], a[20:23], v[80:83]
buffer_load_dwordx4 v[188:191], v59, s[44:47], s68 offen offset:1024 sc1
v_mfma_f32_16x16x32_bf16 v[84:87], v[192:195], a[92:95], v[84:87]
s_add_u32 s70, s70, s71
s_mul_i32 s71, s48, 589824
v_mfma_f32_16x16x32_bf16 v[88:91], v[192:195], a[164:167], v[88:91]
s_add_u32 s70, s70, s71
v_mfma_f32_16x16x32_bf16 v[92:95], v[192:195], a[236:239], v[92:95]
s_lshl_b32 s71, s50, 11
s_add_u32 s70, s70, s71
s_waitcnt vmcnt(17)
v_mfma_f32_16x16x32_bf16 v[80:83], v[196:199], a[24:27], v[80:83]
buffer_load_dwordx4 v[192:195], v59, s[44:47], s68 offen offset:2048 sc1
v_mfma_f32_16x16x32_bf16 v[84:87], v[196:199], a[96:99], v[84:87]
s_add_u32 s70, s70, 4718592
v_mfma_f32_16x16x32_bf16 v[88:91], v[196:199], a[168:171], v[88:91]
v_add_u32 v60, s70, v7
v_lshlrev_b32 v7, 11, v6
v_mfma_f32_16x16x32_bf16 v[92:95], v[196:199], a[240:243], v[92:95]
v_lshl_add_u32 v7, v5, 8, v7
s_waitcnt vmcnt(17)
v_mfma_f32_16x16x32_bf16 v[80:83], v[200:203], a[28:31], v[80:83]
buffer_load_dwordx4 v[196:199], v59, s[44:47], s68 offen offset:3072 sc1
v_mfma_f32_16x16x32_bf16 v[84:87], v[200:203], a[100:103], v[84:87]
v_lshl_add_u32 v7, v4, 4, v7
s_lshl_b32 s70, s48, 2
v_mfma_f32_16x16x32_bf16 v[88:91], v[200:203], a[172:175], v[88:91]
s_lshr_b32 s71, s49, 1
v_mfma_f32_16x16x32_bf16 v[92:95], v[200:203], a[244:247], v[92:95]
s_add_u32 s70, s70, s71
s_mul_i32 s70, s70, 18432
s_waitcnt vmcnt(17)
v_mfma_f32_16x16x32_bf16 v[80:83], v[204:207], a[32:35], v[80:83]
s_add_u32 s68, s68, 4096
buffer_load_dwordx4 v[200:203], v59, s[44:47], s68 offen offset:0 sc1
v_mfma_f32_16x16x32_bf16 v[84:87], v[204:207], a[104:107], v[84:87]
s_and_b32 s71, s49, 1
v_mfma_f32_16x16x32_bf16 v[88:91], v[204:207], a[176:179], v[88:91]
s_lshl_b32 s71, s71, 7
s_add_u32 s70, s70, s71
v_mfma_f32_16x16x32_bf16 v[92:95], v[204:207], a[248:251], v[92:95]
s_lshl_b32 s71, s50, 9
s_waitcnt vmcnt(17)
v_mfma_f32_16x16x32_bf16 v[80:83], v[208:211], a[36:39], v[80:83]
buffer_load_dwordx4 v[204:207], v59, s[44:47], s68 offen offset:1024 sc1
v_mfma_f32_16x16x32_bf16 v[84:87], v[208:211], a[108:111], v[84:87]
s_add_u32 s70, s70, s71
s_add_u32 s70, s70, 2359296
v_mfma_f32_16x16x32_bf16 v[88:91], v[208:211], a[180:183], v[88:91]
v_add_u32 v63, s70, v7
v_mfma_f32_16x16x32_bf16 v[92:95], v[208:211], a[252:255], v[92:95]
v_mul_u32_u24 v7, 1152, v4
s_waitcnt vmcnt(17)
v_mfma_f32_16x16x32_bf16 v[80:83], v[212:215], a[40:43], v[80:83]
buffer_load_dwordx4 v[208:211], v59, s[44:47], s68 offen offset:2048 sc1
v_mfma_f32_16x16x32_bf16 v[84:87], v[212:215], a[112:115], v[84:87]
v_lshl_add_u32 v7, v6, 7, v7
v_lshl_add_u32 v7, v5, 4, v7
v_mfma_f32_16x16x32_bf16 v[88:91], v[212:215], a[184:187], v[88:91]
s_lshl_b32 s70, s48, 3
v_mfma_f32_16x16x32_bf16 v[92:95], v[212:215], v[8:11], v[92:95]
s_add_u32 s70, s70, s49
s_mul_i32 s70, s70, 9216
s_waitcnt vmcnt(17)
v_mfma_f32_16x16x32_bf16 v[80:83], v[216:219], a[44:47], v[80:83]
buffer_load_dwordx4 v[212:215], v59, s[44:47], s68 offen offset:3072 sc1
v_mfma_f32_16x16x32_bf16 v[84:87], v[216:219], a[116:119], v[84:87]
s_lshl_b32 s71, s50, 5
v_mfma_f32_16x16x32_bf16 v[88:91], v[216:219], a[188:191], v[88:91]
s_add_u32 s70, s70, s71
v_add_u32 v66, s70, v7
v_mfma_f32_16x16x32_bf16 v[92:95], v[216:219], v[12:15], v[92:95]
v_mov_b32 v7, 1073741824
s_waitcnt vmcnt(16)
v_mfma_f32_16x16x32_bf16 v[80:83], v[220:223], a[48:51], v[80:83]
s_add_u32 s68, s68, 4096
buffer_load_dwordx4 v[216:219], v59, s[44:47], s68 offen offset:0 sc1
v_mfma_f32_16x16x32_bf16 v[84:87], v[220:223], a[120:123], v[84:87]
v_cmp_gt_u32 s[56:57], 32, v0
s_nop 1
v_mfma_f32_16x16x32_bf16 v[88:91], v[220:223], a[192:195], v[88:91]
v_cndmask_b32 v61, v7, v60, s[56:57]
v_mfma_f32_16x16x32_bf16 v[92:95], v[220:223], v[16:19], v[92:95]
v_cndmask_b32 v64, v7, v63, s[56:57]
v_cndmask_b32 v67, v7, v66, s[56:57]
s_waitcnt vmcnt(16)
v_mfma_f32_16x16x32_bf16 v[80:83], v[224:227], a[52:55], v[80:83]
buffer_load_dwordx4 v[220:223], v59, s[44:47], s68 offen offset:1024 sc1
v_mfma_f32_16x16x32_bf16 v[84:87], v[224:227], a[124:127], v[84:87]
v_cmp_gt_u32 s[56:57], 48, v0
v_mfma_f32_16x16x32_bf16 v[88:91], v[224:227], a[196:199], v[88:91]
s_nop 1
v_cndmask_b32 v62, v7, v60, s[56:57]
v_mfma_f32_16x16x32_bf16 v[92:95], v[224:227], v[20:23], v[92:95]
v_cndmask_b32 v65, v7, v63, s[56:57]
s_waitcnt vmcnt(16)
v_mfma_f32_16x16x32_bf16 v[80:83], v[228:231], a[56:59], v[80:83]
buffer_load_dwordx4 v[224:227], v59, s[44:47], s68 offen offset:2048 sc1
v_mfma_f32_16x16x32_bf16 v[84:87], v[228:231], a[128:131], v[84:87]
v_cndmask_b32 v68, v7, v66, s[56:57]
s_lshl_b32 s70, s49, 5
v_mfma_f32_16x16x32_bf16 v[88:91], v[228:231], a[200:203], v[88:91]
s_add_u32 s70, s70, 159744
v_mfma_f32_16x16x32_bf16 v[92:95], v[228:231], v[24:27], v[92:95]
v_lshl_add_u32 v69, v4, 2, s70
ds_read_b32 v69, v69
s_waitcnt vmcnt(16)
v_mfma_f32_16x16x32_bf16 v[80:83], v[232:235], a[60:63], v[80:83]
buffer_load_dwordx4 v[228:231], v59, s[44:47], s68 offen offset:3072 sc1
v_mfma_f32_16x16x32_bf16 v[84:87], v[232:235], a[132:135], v[84:87]
v_mfma_f32_16x16x32_bf16 v[88:91], v[232:235], a[204:207], v[88:91]
v_mfma_f32_16x16x32_bf16 v[92:95], v[232:235], v[28:31], v[92:95]
s_waitcnt vmcnt(15)
v_mfma_f32_16x16x32_bf16 v[80:83], v[236:239], a[64:67], v[80:83]
s_add_u32 s68, s68, 4096
buffer_load_dwordx4 v[232:235], v59, s[44:47], s68 offen offset:0 sc1
v_mfma_f32_16x16x32_bf16 v[84:87], v[236:239], a[136:139], v[84:87]
v_mfma_f32_16x16x32_bf16 v[88:91], v[236:239], a[208:211], v[88:91]
v_mfma_f32_16x16x32_bf16 v[92:95], v[236:239], v[32:35], v[92:95]
s_waitcnt vmcnt(15)
v_mfma_f32_16x16x32_bf16 v[80:83], v[240:243], a[68:71], v[80:83]
buffer_load_dwordx4 v[236:239], v59, s[44:47], s68 offen offset:1024 sc1
v_mfma_f32_16x16x32_bf16 v[84:87], v[240:243], a[140:143], v[84:87]
v_mfma_f32_16x16x32_bf16 v[88:91], v[240:243], a[212:215], v[88:91]
v_mfma_f32_16x16x32_bf16 v[92:95], v[240:243], v[36:39], v[92:95]
s_waitcnt vmcnt(14)
v_mfma_f32_16x16x32_bf16 v[96:99], v[244:247], v[112:115], 0
buffer_load_dwordx4 v[240:243], v59, s[44:47], s68 offen offset:2048 sc1
v_mfma_f32_16x16x32_bf16 v[100:103], v[244:247], v[124:127], 0
v_mfma_f32_16x16x32_bf16 v[104:107], v[244:247], v[136:139], 0
v_mfma_f32_16x16x32_bf16 v[108:111], v[244:247], v[148:151], 0
s_waitcnt vmcnt(14)
v_mfma_f32_16x16x32_bf16 v[96:99], v[248:251], v[116:119], v[96:99]
buffer_load_dwordx4 v[244:247], v59, s[44:47], s68 offen offset:3072 sc1
v_mfma_f32_16x16x32_bf16 v[100:103], v[248:251], v[128:131], v[100:103]
v_mfma_f32_16x16x32_bf16 v[104:107], v[248:251], v[140:143], v[104:107]
v_cvt_pk_bf16_f32 v168, v80, v81
v_mfma_f32_16x16x32_bf16 v[108:111], v[248:251], v[152:155], v[108:111]
v_cvt_pk_bf16_f32 v169, v82, v83
s_waitcnt vmcnt(14)
v_mfma_f32_16x16x32_bf16 v[96:99], v[188:191], v[120:123], v[96:99]
s_add_u32 s68, s68, 4096
buffer_load_dwordx4 v[248:251], v59, s[44:47], s68 offen offset:0 sc1
v_mfma_f32_16x16x32_bf16 v[100:103], v[188:191], v[132:135], v[100:103]
v_cvt_pk_bf16_f32 v170, v84, v85
v_mfma_f32_16x16x32_bf16 v[104:107], v[188:191], v[144:147], v[104:107]
v_cvt_pk_bf16_f32 v171, v86, v87
v_mfma_f32_16x16x32_bf16 v[108:111], v[188:191], v[156:159], v[108:111]
s_nop 0
s_waitcnt vmcnt(14)
v_mfma_f32_16x16x32_bf16 v[96:99], v[192:195], a[0:3], v[96:99]
buffer_load_dwordx4 v[188:191], v59, s[44:47], s68 offen offset:1024 sc1
v_mfma_f32_16x16x32_bf16 v[100:103], v[192:195], a[72:75], v[100:103]
v_permlane16_swap_b32 v168, v170
v_mfma_f32_16x16x32_bf16 v[104:107], v[192:195], a[144:147], v[104:107]
v_permlane16_swap_b32 v169, v171
v_mfma_f32_16x16x32_bf16 v[108:111], v[192:195], a[216:219], v[108:111]
s_mul_i32 s52, s63, 128
s_add_u32 s52, s52, 37958656
v_and_b32 v1, 7, v0
v_lshl_add_u32 v76, v1, 2, s52
buffer_load_dword v77, v76, s[44:47], 0 offen sc0 sc1
s_waitcnt vmcnt(15)
v_mfma_f32_16x16x32_bf16 v[96:99], v[196:199], a[4:7], v[96:99]
buffer_load_dwordx4 v[192:195], v59, s[44:47], s68 offen offset:2048 sc1
v_mfma_f32_16x16x32_bf16 v[100:103], v[196:199], a[76:79], v[100:103]
v_mfma_f32_16x16x32_bf16 v[104:107], v[196:199], a[148:151], v[104:107]
buffer_store_dwordx4 v[168:171], v70, s[44:47], s69 offen offset:0 sc0 sc1
ds_write_b128 v72, v[168:171] offset:1280
v_mfma_f32_16x16x32_bf16 v[108:111], v[196:199], a[220:223], v[108:111]
v_cvt_pk_bf16_f32 v172, v88, v89
s_waitcnt vmcnt(16)
v_mfma_f32_16x16x32_bf16 v[96:99], v[200:203], a[8:11], v[96:99]
buffer_load_dwordx4 v[196:199], v59, s[44:47], s68 offen offset:3072 sc1
v_mfma_f32_16x16x32_bf16 v[100:103], v[200:203], a[80:83], v[100:103]
v_cvt_pk_bf16_f32 v173, v90, v91
v_mfma_f32_16x16x32_bf16 v[104:107], v[200:203], a[152:155], v[104:107]
v_cvt_pk_bf16_f32 v174, v92, v93
v_mfma_f32_16x16x32_bf16 v[108:111], v[200:203], a[224:227], v[108:111]
v_cvt_pk_bf16_f32 v175, v94, v95
s_waitcnt vmcnt(16)
v_mfma_f32_16x16x32_bf16 v[96:99], v[204:207], a[12:15], v[96:99]
s_add_u32 s68, s68, 4096
buffer_load_dwordx4 v[200:203], v59, s[44:47], s68 offen offset:0 sc1
v_mfma_f32_16x16x32_bf16 v[100:103], v[204:207], a[84:87], v[100:103]
s_nop 0
v_mfma_f32_16x16x32_bf16 v[104:107], v[204:207], a[156:159], v[104:107]
v_permlane16_swap_b32 v172, v174
v_mfma_f32_16x16x32_bf16 v[108:111], v[204:207], a[228:231], v[108:111]
v_permlane16_swap_b32 v173, v175
s_waitcnt vmcnt(16)
v_mfma_f32_16x16x32_bf16 v[96:99], v[208:211], a[16:19], v[96:99]
buffer_load_dwordx4 v[204:207], v59, s[44:47], s68 offen offset:1024 sc1
v_mfma_f32_16x16x32_bf16 v[100:103], v[208:211], a[88:91], v[100:103]
v_mfma_f32_16x16x32_bf16 v[104:107], v[208:211], a[160:163], v[104:107]
v_mfma_f32_16x16x32_bf16 v[108:111], v[208:211], a[232:235], v[108:111]
buffer_store_dwordx4 v[172:175], v71, s[44:47], s69 offen offset:1024 sc0 sc1
ds_write_b128 v73, v[172:175] offset:1280
s_add_u32 s69, s69, 8192
s_waitcnt vmcnt(17)
v_mfma_f32_16x16x32_bf16 v[96:99], v[212:215], a[20:23], v[96:99]
buffer_load_dwordx4 v[208:211], v59, s[44:47], s68 offen offset:2048 sc1
v_mfma_f32_16x16x32_bf16 v[100:103], v[212:215], a[92:95], v[100:103]
v_mfma_f32_16x16x32_bf16 v[104:107], v[212:215], a[164:167], v[104:107]
v_mfma_f32_16x16x32_bf16 v[108:111], v[212:215], a[236:239], v[108:111]
s_waitcnt vmcnt(17)
v_mfma_f32_16x16x32_bf16 v[96:99], v[216:219], a[24:27], v[96:99]
buffer_load_dwordx4 v[212:215], v59, s[44:47], s68 offen offset:3072 sc1
v_mfma_f32_16x16x32_bf16 v[100:103], v[216:219], a[96:99], v[100:103]
v_mfma_f32_16x16x32_bf16 v[104:107], v[216:219], a[168:171], v[104:107]
v_mfma_f32_16x16x32_bf16 v[108:111], v[216:219], a[240:243], v[108:111]
s_waitcnt vmcnt(17)
v_mfma_f32_16x16x32_bf16 v[96:99], v[220:223], a[28:31], v[96:99]
s_add_u32 s68, s68, 4096
buffer_load_dwordx4 v[216:219], v59, s[44:47], s68 offen offset:0 sc1
v_mfma_f32_16x16x32_bf16 v[100:103], v[220:223], a[100:103], v[100:103]
v_mfma_f32_16x16x32_bf16 v[104:107], v[220:223], a[172:175], v[104:107]
v_mfma_f32_16x16x32_bf16 v[108:111], v[220:223], a[244:247], v[108:111]
s_waitcnt vmcnt(17)
v_mfma_f32_16x16x32_bf16 v[96:99], v[224:227], a[32:35], v[96:99]
buffer_load_dwordx4 v[220:223], v59, s[44:47], s68 offen offset:1024 sc1
v_mfma_f32_16x16x32_bf16 v[100:103], v[224:227], a[104:107], v[100:103]
v_mfma_f32_16x16x32_bf16 v[104:107], v[224:227], a[176:179], v[104:107]
v_mfma_f32_16x16x32_bf16 v[108:111], v[224:227], a[248:251], v[108:111]
s_waitcnt vmcnt(10)
s_sub_u32 s52, s51, 6
v_subrev_u32 v77, s52, v77
v_cmp_lt_u32 vcc, 6, v77
s_nop 3
s_cbranch_vccz L_fl_ok_22
s_mov_b32 s58, 100000
L_fl_poll_23:
buffer_load_dword v77, v76, s[44:47], 0 offen sc0 sc1
s_waitcnt vmcnt(0)
s_sub_u32 s52, s51, 6
v_subrev_u32 v77, s52, v77
v_cmp_lt_u32 vcc, 6, v77
s_sub_u32 s58, s58, 1
s_cmp_eq_u32 s58, 0
s_cbranch_scc1 L_fl_ok_22
s_nop 1
s_cbranch_vccnz L_fl_poll_23
L_fl_ok_22:
v_mfma_f32_16x16x32_bf16 v[96:99], v[228:231], a[36:39], v[96:99]
buffer_load_dwordx4 v[224:227], v59, s[44:47], s68 offen offset:2048 sc1
v_mfma_f32_16x16x32_bf16 v[100:103], v[228:231], a[108:111], v[100:103]
v_mfma_f32_16x16x32_bf16 v[104:107], v[228:231], a[180:183], v[104:107]
v_mfma_f32_16x16x32_bf16 v[108:111], v[228:231], a[252:255], v[108:111]
s_add_u32 s70, s90, 0
buffer_load_dwordx4 v[40:43], v60, s[44:47], s70 offen sc0 sc1
v_mfma_f32_16x16x32_bf16 v[96:99], v[232:235], a[40:43], v[96:99]
buffer_load_dwordx4 v[228:231], v59, s[44:47], s68 offen offset:3072 sc1
v_mfma_f32_16x16x32_bf16 v[100:103], v[232:235], a[112:115], v[100:103]
v_mfma_f32_16x16x32_bf16 v[104:107], v[232:235], a[184:187], v[104:107]
v_mfma_f32_16x16x32_bf16 v[108:111], v[232:235], v[8:11], v[108:111]
v_mfma_f32_16x16x32_bf16 v[96:99], v[236:239], a[44:47], v[96:99]
s_add_u32 s68, s68, 4096
buffer_load_dwordx4 v[232:235], v59, s[44:47], s68 offen offset:0 sc1
v_mfma_f32_16x16x32_bf16 v[100:103], v[236:239], a[116:119], v[100:103]
v_mfma_f32_16x16x32_bf16 v[104:107], v[236:239], a[188:191], v[104:107]
v_mfma_f32_16x16x32_bf16 v[108:111], v[236:239], v[12:15], v[108:111]
v_mfma_f32_16x16x32_bf16 v[96:99], v[240:243], a[48:51], v[96:99]
buffer_load_dwordx4 v[236:239], v59, s[44:47], s68 offen offset:1024 sc1
v_mfma_f32_16x16x32_bf16 v[100:103], v[240:243], a[120:123], v[100:103]
v_mfma_f32_16x16x32_bf16 v[104:107], v[240:243], a[192:195], v[104:107]
v_mfma_f32_16x16x32_bf16 v[108:111], v[240:243], v[16:19], v[108:111]
s_add_u32 s70, s91, 0
buffer_load_dwordx4 v[44:47], v60, s[44:47], s70 offen sc0 sc1
v_mfma_f32_16x16x32_bf16 v[96:99], v[244:247], a[52:55], v[96:99]
buffer_load_dwordx4 v[240:243], v59, s[44:47], s68 offen offset:2048 sc1
v_mfma_f32_16x16x32_bf16 v[100:103], v[244:247], a[124:127], v[100:103]
v_mfma_f32_16x16x32_bf16 v[104:107], v[244:247], a[196:199], v[104:107]
v_mfma_f32_16x16x32_bf16 v[108:111], v[244:247], v[20:23], v[108:111]
v_mfma_f32_16x16x32_bf16 v[96:99], v[248:251], a[56:59], v[96:99]
buffer_load_dwordx4 v[244:247], v59, s[44:47], s68 offen offset:3072 sc1
v_mfma_f32_16x16x32_bf16 v[100:103], v[248:251], a[128:131], v[100:103]
v_mfma_f32_16x16x32_bf16 v[104:107], v[248:251], a[200:203], v[104:107]
v_mfma_f32_16x16x32_bf16 v[108:111], v[248:251], v[24:27], v[108:111]
v_mfma_f32_16x16x32_bf16 v[96:99], v[188:191], a[60:63], v[96:99]
s_add_u32 s68, s68, 4096
buffer_load_dwordx4 v[248:251], v59, s[44:47], s68 offen offset:0 sc1
v_mfma_f32_16x16x32_bf16 v[100:103], v[188:191], a[132:135], v[100:103]
v_mfma_f32_16x16x32_bf16 v[104:107], v[188:191], a[204:207], v[104:107]
v_mfma_f32_16x16x32_bf16 v[108:111], v[188:191], v[28:31], v[108:111]
s_add_u32 s70, s92, 0
buffer_load_dwordx4 v[48:51], v60, s[44:47], s70 offen sc0 sc1
s_waitcnt vmcnt(19)
v_mfma_f32_16x16x32_bf16 v[96:99], v[192:195], a[64:67], v[96:99]
buffer_load_dwordx4 v[188:191], v59, s[44:47], s68 offen offset:1024 sc1
v_mfma_f32_16x16x32_bf16 v[100:103], v[192:195], a[136:139], v[100:103]
v_mfma_f32_16x16x32_bf16 v[104:107], v[192:195], a[208:211], v[104:107]
v_mfma_f32_16x16x32_bf16 v[108:111], v[192:195], v[32:35], v[108:111]
s_waitcnt vmcnt(18)
v_mfma_f32_16x16x32_bf16 v[96:99], v[196:199], a[68:71], v[96:99]
buffer_load_dwordx4 v[192:195], v59, s[44:47], s68 offen offset:2048 sc1
v_mfma_f32_16x16x32_bf16 v[100:103], v[196:199], a[140:143], v[100:103]
v_mfma_f32_16x16x32_bf16 v[104:107], v[196:199], a[212:215], v[104:107]
v_mfma_f32_16x16x32_bf16 v[108:111], v[196:199], v[36:39], v[108:111]
s_waitcnt vmcnt(16)
s_mul_i32 s52, s63, 32
s_add_u32 s52, s52, s49
s_lshl_b32 s52, s52, 2
s_add_u32 s52, s52, 37958656
s_sub_u32 s53, s51, 5
v_mov_b32 v1, s52
v_mov_b32 v2, s53
s_mov_b64 exec, 1
buffer_store_dword v2, v1, s[44:47], 0 offen sc0 sc1
s_mov_b64 exec, -1
v_mfma_f32_16x16x32_bf16 v[80:83], v[200:203], v[112:115], 0
buffer_load_dwordx4 v[196:199], v59, s[44:47], s68 offen offset:3072 sc1
v_mfma_f32_16x16x32_bf16 v[84:87], v[200:203], v[124:127], 0
v_mfma_f32_16x16x32_bf16 v[88:91], v[200:203], v[136:139], 0
v_mfma_f32_16x16x32_bf16 v[92:95], v[200:203], v[148:151], 0
s_add_u32 s70, s93, 0
buffer_load_dwordx4 v[52:55], v60, s[44:47], s70 offen sc0 sc1
v_mfma_f32_16x16x32_bf16 v[80:83], v[204:207], v[116:119], v[80:83]
s_add_u32 s68, s68, 4096
buffer_load_dwordx4 v[200:203], v59, s[44:47], s68 offen offset:0 sc1
v_mfma_f32_16x16x32_bf16 v[84:87], v[204:207], v[128:131], v[84:87]
v_mfma_f32_16x16x32_bf16 v[88:91], v[204:207], v[140:143], v[88:91]
v_cvt_pk_bf16_f32 v160, v96, v97
v_mfma_f32_16x16x32_bf16 v[92:95], v[204:207], v[152:155], v[92:95]
v_cvt_pk_bf16_f32 v161, v98, v99
s_waitcnt vmcnt(19)
v_mfma_f32_16x16x32_bf16 v[80:83], v[208:211], v[120:123], v[80:83]
buffer_load_dwordx4 v[204:207], v59, s[44:47], s68 offen offset:1024 sc1
v_mfma_f32_16x16x32_bf16 v[84:87], v[208:211], v[132:135], v[84:87]
v_cvt_pk_bf16_f32 v162, v100, v101
v_mfma_f32_16x16x32_bf16 v[88:91], v[208:211], v[144:147], v[88:91]
v_cvt_pk_bf16_f32 v163, v102, v103
v_mfma_f32_16x16x32_bf16 v[92:95], v[208:211], v[156:159], v[92:95]
s_nop 0
s_waitcnt vmcnt(19)
v_mfma_f32_16x16x32_bf16 v[80:83], v[212:215], a[0:3], v[80:83]
buffer_load_dwordx4 v[208:211], v59, s[44:47], s68 offen offset:2048 sc1
v_mfma_f32_16x16x32_bf16 v[84:87], v[212:215], a[72:75], v[84:87]
v_permlane16_swap_b32 v160, v162
v_mfma_f32_16x16x32_bf16 v[88:91], v[212:215], a[144:147], v[88:91]
v_permlane16_swap_b32 v161, v163
v_mfma_f32_16x16x32_bf16 v[92:95], v[212:215], a[216:219], v[92:95]
s_add_u32 s70, s94, 0
buffer_load_dwordx4 v[176:179], v60, s[44:47], s70 offen sc0 sc1
s_waitcnt vmcnt(20)
v_mfma_f32_16x16x32_bf16 v[80:83], v[216:219], a[4:7], v[80:83]
buffer_load_dwordx4 v[212:215], v59, s[44:47], s68 offen offset:3072 sc1
v_mfma_f32_16x16x32_bf16 v[84:87], v[216:219], a[76:79], v[84:87]
v_mfma_f32_16x16x32_bf16 v[88:91], v[216:219], a[148:151], v[88:91]
buffer_store_dwordx4 v[160:163], v70, s[44:47], s69 offen offset:0 sc0 sc1
ds_write_b128 v72, v[160:163] offset:1536
v_mfma_f32_16x16x32_bf16 v[92:95], v[216:219], a[220:223], v[92:95]
v_cvt_pk_bf16_f32 v164, v104, v105
s_waitcnt vmcnt(21)
v_mfma_f32_16x16x32_bf16 v[80:83], v[220:223], a[8:11], v[80:83]
s_add_u32 s68, s68, 4096
buffer_load_dwordx4 v[216:219], v59, s[44:47], s68 offen offset:0 sc1
v_mfma_f32_16x16x32_bf16 v[84:87], v[220:223], a[80:83], v[84:87]
v_cvt_pk_bf16_f32 v165, v106, v107
v_mfma_f32_16x16x32_bf16 v[88:91], v[220:223], a[152:155], v[88:91]
v_cvt_pk_bf16_f32 v166, v108, v109
v_mfma_f32_16x16x32_bf16 v[92:95], v[220:223], a[224:227], v[92:95]
v_cvt_pk_bf16_f32 v167, v110, v111
s_waitcnt vmcnt(21)
v_mfma_f32_16x16x32_bf16 v[80:83], v[224:227], a[12:15], v[80:83]
buffer_load_dwordx4 v[220:223], v59, s[44:47], s68 offen offset:1024 sc1
v_mfma_f32_16x16x32_bf16 v[84:87], v[224:227], a[84:87], v[84:87]
s_nop 0
v_mfma_f32_16x16x32_bf16 v[88:91], v[224:227], a[156:159], v[88:91]
v_permlane16_swap_b32 v164, v166
v_mfma_f32_16x16x32_bf16 v[92:95], v[224:227], a[228:231], v[92:95]
v_permlane16_swap_b32 v165, v167
s_add_u32 s70, s95, 0
buffer_load_dwordx4 v[180:183], v60, s[44:47], s70 offen sc0 sc1
s_waitcnt vmcnt(21)
v_mfma_f32_16x16x32_bf16 v[80:83], v[228:231], a[16:19], v[80:83]
buffer_load_dwordx4 v[224:227], v59, s[44:47], s68 offen offset:2048 sc1
v_mfma_f32_16x16x32_bf16 v[84:87], v[228:231], a[88:91], v[84:87]
v_mfma_f32_16x16x32_bf16 v[88:91], v[228:231], a[160:163], v[88:91]
v_mfma_f32_16x16x32_bf16 v[92:95], v[228:231], a[232:235], v[92:95]
buffer_store_dwordx4 v[164:167], v71, s[44:47], s69 offen offset:1024 sc0 sc1
ds_write_b128 v73, v[164:167] offset:1536
s_add_u32 s69, s69, 8192
s_waitcnt vmcnt(22)
v_mfma_f32_16x16x32_bf16 v[80:83], v[232:235], a[20:23], v[80:83]
buffer_load_dwordx4 v[228:231], v59, s[44:47], s68 offen offset:3072 sc1
v_mfma_f32_16x16x32_bf16 v[84:87], v[232:235], a[92:95], v[84:87]
v_mfma_f32_16x16x32_bf16 v[88:91], v[232:235], a[164:167], v[88:91]
v_mfma_f32_16x16x32_bf16 v[92:95], v[232:235], a[236:239], v[92:95]
s_waitcnt vmcnt(22)
v_mfma_f32_16x16x32_bf16 v[80:83], v[236:239], a[24:27], v[80:83]
s_add_u32 s68, s68, 4096
buffer_load_dwordx4 v[232:235], v59, s[44:47], s68 offen offset:0 sc1
v_mfma_f32_16x16x32_bf16 v[84:87], v[236:239], a[96:99], v[84:87]
v_mfma_f32_16x16x32_bf16 v[88:91], v[236:239], a[168:171], v[88:91]
v_mfma_f32_16x16x32_bf16 v[92:95], v[236:239], a[240:243], v[92:95]
s_add_u32 s70, s96, 0
buffer_load_dwordx4 v[184:187], v60, s[44:47], s70 offen sc0 sc1
s_waitcnt vmcnt(22)
v_mfma_f32_16x16x32_bf16 v[80:83], v[240:243], a[28:31], v[80:83]
buffer_load_dwordx4 v[236:239], v59, s[44:47], s68 offen offset:1024 sc1
v_mfma_f32_16x16x32_bf16 v[84:87], v[240:243], a[100:103], v[84:87]
v_mfma_f32_16x16x32_bf16 v[88:91], v[240:243], a[172:175], v[88:91]
v_mfma_f32_16x16x32_bf16 v[92:95], v[240:243], a[244:247], v[92:95]
s_waitcnt vmcnt(22)
v_mfma_f32_16x16x32_bf16 v[80:83], v[244:247], a[32:35], v[80:83]
buffer_load_dwordx4 v[240:243], v59, s[44:47], s68 offen offset:2048 sc1
v_mfma_f32_16x16x32_bf16 v[84:87], v[244:247], a[104:107], v[84:87]
v_mfma_f32_16x16x32_bf16 v[88:91], v[244:247], a[176:179], v[88:91]
v_mfma_f32_16x16x32_bf16 v[92:95], v[244:247], a[248:251], v[92:95]
s_waitcnt vmcnt(22)
v_mfma_f32_16x16x32_bf16 v[80:83], v[248:251], a[36:39], v[80:83]
buffer_load_dwordx4 v[244:247], v59, s[44:47], s68 offen offset:3072 sc1
v_mfma_f32_16x16x32_bf16 v[84:87], v[248:251], a[108:111], v[84:87]
v_mfma_f32_16x16x32_bf16 v[88:91], v[248:251], a[180:183], v[88:91]
v_mfma_f32_16x16x32_bf16 v[92:95], v[248:251], a[252:255], v[92:95]
s_waitcnt vmcnt(21)
v_mfma_f32_16x16x32_bf16 v[80:83], v[188:191], a[40:43], v[80:83]
s_add_u32 s68, s68, 4096
buffer_load_dwordx4 v[248:251], v59, s[44:47], s68 offen offset:0 sc1
v_mfma_f32_16x16x32_bf16 v[84:87], v[188:191], a[112:115], v[84:87]
v_mfma_f32_16x16x32_bf16 v[88:91], v[188:191], a[184:187], v[88:91]
v_mfma_f32_16x16x32_bf16 v[92:95], v[188:191], v[8:11], v[92:95]
s_waitcnt vmcnt(21)
v_mfma_f32_16x16x32_bf16 v[80:83], v[192:195], a[44:47], v[80:83]
buffer_load_dwordx4 v[188:191], v59, s[44:47], s68 offen offset:1024 sc1
v_mfma_f32_16x16x32_bf16 v[84:87], v[192:195], a[116:119], v[84:87]
v_mfma_f32_16x16x32_bf16 v[88:91], v[192:195], a[188:191], v[88:91]
v_mfma_f32_16x16x32_bf16 v[92:95], v[192:195], v[12:15], v[92:95]
s_waitcnt vmcnt(20)
v_mfma_f32_16x16x32_bf16 v[80:83], v[196:199], a[48:51], v[80:83]
buffer_load_dwordx4 v[192:195], v59, s[44:47], s68 offen offset:2048 sc1
v_mfma_f32_16x16x32_bf16 v[84:87], v[196:199], a[120:123], v[84:87]
v_mfma_f32_16x16x32_bf16 v[88:91], v[196:199], a[192:195], v[88:91]
v_mfma_f32_16x16x32_bf16 v[92:95], v[196:199], v[16:19], v[92:95]
s_waitcnt vmcnt(19)
v_mfma_f32_16x16x32_bf16 v[80:83], v[200:203], a[52:55], v[80:83]
buffer_load_dwordx4 v[196:199], v59, s[44:47], s68 offen offset:3072 sc1
v_mfma_f32_16x16x32_bf16 v[84:87], v[200:203], a[124:127], v[84:87]
v_mfma_f32_16x16x32_bf16 v[88:91], v[200:203], a[196:199], v[88:91]
v_mfma_f32_16x16x32_bf16 v[92:95], v[200:203], v[20:23], v[92:95]
s_mul_i32 s52, s63, 128
s_add_u32 s52, s52, 37958656
v_and_b32 v1, 7, v0
v_lshl_add_u32 v76, v1, 2, s52
buffer_load_dword v77, v76, s[44:47], 0 offen sc0 sc1
s_waitcnt vmcnt(20)
v_mfma_f32_16x16x32_bf16 v[80:83], v[204:207], a[56:59], v[80:83]
s_add_u32 s68, s68, 4096
buffer_load_dwordx4 v[200:203], v59, s[44:47], s68 offen offset:0 sc1
v_mfma_f32_16x16x32_bf16 v[84:87], v[204:207], a[128:131], v[84:87]
v_mfma_f32_16x16x32_bf16 v[88:91], v[204:207], a[200:203], v[88:91]
v_mfma_f32_16x16x32_bf16 v[92:95], v[204:207], v[24:27], v[92:95]
s_waitcnt vmcnt(20)
v_mfma_f32_16x16x32_bf16 v[80:83], v[208:211], a[60:63], v[80:83]
buffer_load_dwordx4 v[204:207], v59, s[44:47], s68 offen offset:1024 sc1
v_mfma_f32_16x16x32_bf16 v[84:87], v[208:211], a[132:135], v[84:87]
v_mfma_f32_16x16x32_bf16 v[88:91], v[208:211], a[204:207], v[88:91]
v_mfma_f32_16x16x32_bf16 v[92:95], v[208:211], v[28:31], v[92:95]
s_waitcnt vmcnt(19)
v_mfma_f32_16x16x32_bf16 v[80:83], v[212:215], a[64:67], v[80:83]
buffer_load_dwordx4 v[208:211], v59, s[44:47], s68 offen offset:2048 sc1
v_mfma_f32_16x16x32_bf16 v[84:87], v[212:215], a[136:139], v[84:87]
v_mfma_f32_16x16x32_bf16 v[88:91], v[212:215], a[208:211], v[88:91]
v_mfma_f32_16x16x32_bf16 v[92:95], v[212:215], v[32:35], v[92:95]
s_waitcnt vmcnt(18)
v_mfma_f32_16x16x32_bf16 v[80:83], v[216:219], a[68:71], v[80:83]
buffer_load_dwordx4 v[212:215], v59, s[44:47], s68 offen offset:3072 sc1
v_mfma_f32_16x16x32_bf16 v[84:87], v[216:219], a[140:143], v[84:87]
v_mfma_f32_16x16x32_bf16 v[88:91], v[216:219], a[212:215], v[88:91]
v_mfma_f32_16x16x32_bf16 v[92:95], v[216:219], v[36:39], v[92:95]
s_waitcnt vmcnt(18)
v_mfma_f32_16x16x32_bf16 v[96:99], v[220:223], v[112:115], 0
s_add_u32 s68, s68, 4096
buffer_load_dwordx4 v[216:219], v59, s[44:47], s68 offen offset:0 sc1
v_mfma_f32_16x16x32_bf16 v[100:103], v[220:223], v[124:127], 0
v_mfma_f32_16x16x32_bf16 v[104:107], v[220:223], v[136:139], 0
v_mfma_f32_16x16x32_bf16 v[108:111], v[220:223], v[148:151], 0
s_waitcnt vmcnt(17)
v_mfma_f32_16x16x32_bf16 v[96:99], v[224:227], v[116:119], v[96:99]
buffer_load_dwordx4 v[220:223], v59, s[44:47], s68 offen offset:1024 sc1
v_mfma_f32_16x16x32_bf16 v[100:103], v[224:227], v[128:131], v[100:103]
v_cvt_pk_bf16_f32 v168, v80, v81
v_mfma_f32_16x16x32_bf16 v[104:107], v[224:227], v[140:143], v[104:107]
v_cvt_pk_bf16_f32 v169, v82, v83
v_cvt_pk_bf16_f32 v170, v84, v85
v_mfma_f32_16x16x32_bf16 v[108:111], v[224:227], v[152:155], v[108:111]
v_cvt_pk_bf16_f32 v171, v86, v87
s_waitcnt vmcnt(16)
v_mfma_f32_16x16x32_bf16 v[96:99], v[228:231], v[120:123], v[96:99]
buffer_load_dwordx4 v[224:227], v59, s[44:47], s68 offen offset:2048 sc1
v_mfma_f32_16x16x32_bf16 v[100:103], v[228:231], v[132:135], v[100:103]
s_nop 0
v_permlane16_swap_b32 v168, v170
v_mfma_f32_16x16x32_bf16 v[104:107], v[228:231], v[144:147], v[104:107]
v_permlane16_swap_b32 v169, v171
v_mfma_f32_16x16x32_bf16 v[108:111], v[228:231], v[156:159], v[108:111]
s_waitcnt vmcnt(16)
v_mfma_f32_16x16x32_bf16 v[96:99], v[232:235], a[0:3], v[96:99]
buffer_load_dwordx4 v[228:231], v59, s[44:47], s68 offen offset:3072 sc1
v_mfma_f32_16x16x32_bf16 v[100:103], v[232:235], a[72:75], v[100:103]
buffer_store_dwordx4 v[168:171], v70, s[44:47], s69 offen offset:0 sc0 sc1
s_waitcnt lgkmcnt(13)
ds_write_b128 v72, v[168:171] offset:1792
v_mfma_f32_16x16x32_bf16 v[104:107], v[232:235], a[144:147], v[104:107]
v_cvt_pk_bf16_f32 v172, v88, v89
v_cvt_pk_bf16_f32 v173, v90, v91
v_mfma_f32_16x16x32_bf16 v[108:111], v[232:235], a[216:219], v[108:111]
v_cvt_pk_bf16_f32 v174, v92, v93
s_waitcnt vmcnt(9)
s_sub_u32 s52, s51, 5
v_subrev_u32 v77, s52, v77
v_cmp_lt_u32 vcc, 5, v77
s_nop 3
s_cbranch_vccz L_fl_ok_24
s_mov_b32 s58, 100000
L_fl_poll_25:
buffer_load_dword v77, v76, s[44:47], 0 offen sc0 sc1
s_waitcnt vmcnt(0)
s_sub_u32 s52, s51, 5
v_subrev_u32 v77, s52, v77
v_cmp_lt_u32 vcc, 5, v77
s_sub_u32 s58, s58, 1
s_cmp_eq_u32 s58, 0
s_cbranch_scc1 L_fl_ok_24
s_nop 1
s_cbranch_vccnz L_fl_poll_25
L_fl_ok_24:
v_mfma_f32_16x16x32_bf16 v[96:99], v[236:239], a[4:7], v[96:99]
s_add_u32 s68, s68, 4096
buffer_load_dwordx4 v[232:235], v59, s[44:47], s68 offen offset:0 sc1
v_mfma_f32_16x16x32_bf16 v[100:103], v[236:239], a[76:79], v[100:103]
v_cvt_pk_bf16_f32 v175, v94, v95
s_nop 0
v_mfma_f32_16x16x32_bf16 v[104:107], v[236:239], a[148:151], v[104:107]
v_permlane16_swap_b32 v172, v174
v_mfma_f32_16x16x32_bf16 v[108:111], v[236:239], a[220:223], v[108:111]
v_permlane16_swap_b32 v173, v175
v_mfma_f32_16x16x32_bf16 v[96:99], v[240:243], a[8:11], v[96:99]
buffer_load_dwordx4 v[236:239], v59, s[44:47], s68 offen offset:1024 sc1
v_mfma_f32_16x16x32_bf16 v[100:103], v[240:243], a[80:83], v[100:103]
v_mfma_f32_16x16x32_bf16 v[104:107], v[240:243], a[152:155], v[104:107]
buffer_store_dwordx4 v[172:175], v71, s[44:47], s69 offen offset:1024 sc0 sc1
ds_write_b128 v73, v[172:175] offset:1792
s_add_u32 s69, s69, 8192
s_mov_b32 s70, 0
buffer_load_dwordx4 v[144:147], v63, s[44:47], s70 offen sc0 sc1
v_mfma_f32_16x16x32_bf16 v[108:111], v[240:243], a[224:227], v[108:111]
s_mov_b32 s70, 8192
buffer_load_dwordx4 v[148:151], v64, s[44:47], s70 offen sc0 sc1
v_mfma_f32_16x16x32_bf16 v[96:99], v[244:247], a[12:15], v[96:99]
v_mfma_f32_16x16x32_bf16 v[100:103], v[244:247], a[84:87], v[100:103]
s_mov_b32 s70, 12288
buffer_load_dwordx4 v[152:155], v65, s[44:47], s70 offen sc0 sc1
s_add_u32 s70, s90, 32768
buffer_load_dwordx4 v[112:115], v61, s[44:47], s70 offen sc0 sc1
v_mfma_f32_16x16x32_bf16 v[104:107], v[244:247], a[156:159], v[104:107]
s_add_u32 s70, s91, 32768
buffer_load_dwordx4 v[116:119], v61, s[44:47], s70 offen sc0 sc1
v_mfma_f32_16x16x32_bf16 v[108:111], v[244:247], a[228:231], v[108:111]
v_mfma_f32_16x16x32_bf16 v[96:99], v[248:251], a[16:19], v[96:99]
v_mfma_f32_16x16x32_bf16 v[100:103], v[248:251], a[88:91], v[100:103]
s_add_u32 s70, s92, 32768
buffer_load_dwordx4 v[120:123], v61, s[44:47], s70 offen sc0 sc1
v_mfma_f32_16x16x32_bf16 v[104:107], v[248:251], a[160:163], v[104:107]
v_mfma_f32_16x16x32_bf16 v[108:111], v[248:251], a[232:235], v[108:111]
v_mfma_f32_16x16x32_bf16 v[96:99], v[188:191], a[20:23], v[96:99]
v_mfma_f32_16x16x32_bf16 v[100:103], v[188:191], a[92:95], v[100:103]
s_add_u32 s70, s93, 32768
buffer_load_dwordx4 v[124:127], v61, s[44:47], s70 offen sc0 sc1
v_mfma_f32_16x16x32_bf16 v[104:107], v[188:191], a[164:167], v[104:107]
v_mfma_f32_16x16x32_bf16 v[108:111], v[188:191], a[236:239], v[108:111]
v_mfma_f32_16x16x32_bf16 v[96:99], v[192:195], a[24:27], v[96:99]
v_mfma_f32_16x16x32_bf16 v[100:103], v[192:195], a[96:99], v[100:103]
s_add_u32 s70, s94, 32768
buffer_load_dwordx4 v[128:131], v61, s[44:47], s70 offen sc0 sc1
s_add_u32 s70, s95, 32768
buffer_load_dwordx4 v[132:135], v61, s[44:47], s70 offen sc0 sc1
v_mfma_f32_16x16x32_bf16 v[104:107], v[192:195], a[168:171], v[104:107]
v_mfma_f32_16x16x32_bf16 v[108:111], v[192:195], a[240:243], v[108:111]
v_mfma_f32_16x16x32_bf16 v[96:99], v[196:199], a[28:31], v[96:99]
v_mfma_f32_16x16x32_bf16 v[100:103], v[196:199], a[100:103], v[100:103]
s_add_u32 s70, s96, 32768
buffer_load_dwordx4 v[136:139], v61, s[44:47], s70 offen sc0 sc1
v_mfma_f32_16x16x32_bf16 v[104:107], v[196:199], a[172:175], v[104:107]
v_mfma_f32_16x16x32_bf16 v[108:111], v[196:199], a[244:247], v[108:111]
s_waitcnt vmcnt(21)
v_mfma_f32_16x16x32_bf16 v[96:99], v[200:203], a[32:35], v[96:99]
v_mfma_f32_16x16x32_bf16 v[100:103], v[200:203], a[104:107], v[100:103]
v_mfma_f32_16x16x32_bf16 v[104:107], v[200:203], a[176:179], v[104:107]
v_mfma_f32_16x16x32_bf16 v[108:111], v[200:203], a[248:251], v[108:111]
s_waitcnt vmcnt(20)
v_mfma_f32_16x16x32_bf16 v[96:99], v[204:207], a[36:39], v[96:99]
v_mfma_f32_16x16x32_bf16 v[100:103], v[204:207], a[108:111], v[100:103]
v_mfma_f32_16x16x32_bf16 v[104:107], v[204:207], a[180:183], v[104:107]
v_mfma_f32_16x16x32_bf16 v[108:111], v[204:207], a[252:255], v[108:111]
s_waitcnt vmcnt(10)
s_mul_i32 s52, s63, 32
s_add_u32 s52, s52, s49
s_lshl_b32 s52, s52, 2
s_add_u32 s52, s52, 37958656
s_sub_u32 s53, s51, 4
v_mov_b32 v1, s52
v_mov_b32 v2, s53
s_mov_b64 exec, 1
buffer_store_dword v2, v1, s[44:47], 0 offen sc0 sc1
s_mov_b64 exec, -1
v_mfma_f32_16x16x32_bf16 v[96:99], v[208:211], a[40:43], v[96:99]
v_mfma_f32_16x16x32_bf16 v[100:103], v[208:211], a[112:115], v[100:103]
v_mfma_f32_16x16x32_bf16 v[104:107], v[208:211], a[184:187], v[104:107]
v_mfma_f32_16x16x32_bf16 v[108:111], v[208:211], v[8:11], v[108:111]
v_mfma_f32_16x16x32_bf16 v[96:99], v[212:215], a[44:47], v[96:99]
v_mfma_f32_16x16x32_bf16 v[100:103], v[212:215], a[116:119], v[100:103]
v_mfma_f32_16x16x32_bf16 v[104:107], v[212:215], a[188:191], v[104:107]
v_mfma_f32_16x16x32_bf16 v[108:111], v[212:215], v[12:15], v[108:111]
v_mfma_f32_16x16x32_bf16 v[96:99], v[216:219], a[48:51], v[96:99]
v_mfma_f32_16x16x32_bf16 v[100:103], v[216:219], a[120:123], v[100:103]
v_mfma_f32_16x16x32_bf16 v[104:107], v[216:219], a[192:195], v[104:107]
v_mfma_f32_16x16x32_bf16 v[108:111], v[216:219], v[16:19], v[108:111]
v_mfma_f32_16x16x32_bf16 v[96:99], v[220:223], a[52:55], v[96:99]
v_mfma_f32_16x16x32_bf16 v[100:103], v[220:223], a[124:127], v[100:103]
v_mfma_f32_16x16x32_bf16 v[104:107], v[220:223], a[196:199], v[104:107]
v_mfma_f32_16x16x32_bf16 v[108:111], v[220:223], v[20:23], v[108:111]
v_mfma_f32_16x16x32_bf16 v[96:99], v[224:227], a[56:59], v[96:99]
v_mfma_f32_16x16x32_bf16 v[100:103], v[224:227], a[128:131], v[100:103]
v_mfma_f32_16x16x32_bf16 v[104:107], v[224:227], a[200:203], v[104:107]
v_mfma_f32_16x16x32_bf16 v[108:111], v[224:227], v[24:27], v[108:111]
v_mfma_f32_16x16x32_bf16 v[96:99], v[228:231], a[60:63], v[96:99]
v_mfma_f32_16x16x32_bf16 v[100:103], v[228:231], a[132:135], v[100:103]
v_mfma_f32_16x16x32_bf16 v[104:107], v[228:231], a[204:207], v[104:107]
v_mfma_f32_16x16x32_bf16 v[108:111], v[228:231], v[28:31], v[108:111]
v_mfma_f32_16x16x32_bf16 v[96:99], v[232:235], a[64:67], v[96:99]
v_mfma_f32_16x16x32_bf16 v[100:103], v[232:235], a[136:139], v[100:103]
v_mfma_f32_16x16x32_bf16 v[104:107], v[232:235], a[208:211], v[104:107]
v_mfma_f32_16x16x32_bf16 v[108:111], v[232:235], v[32:35], v[108:111]
v_mfma_f32_16x16x32_bf16 v[96:99], v[236:239], a[68:71], v[96:99]
v_mfma_f32_16x16x32_bf16 v[100:103], v[236:239], a[140:143], v[100:103]
v_mfma_f32_16x16x32_bf16 v[104:107], v[236:239], a[212:215], v[104:107]
v_mfma_f32_16x16x32_bf16 v[108:111], v[236:239], v[36:39], v[108:111]
s_nop 4
v_cvt_pk_bf16_f32 v160, v96, v97
v_cvt_pk_bf16_f32 v161, v98, v99
v_cvt_pk_bf16_f32 v162, v100, v101
v_cvt_pk_bf16_f32 v163, v102, v103
s_nop 0
v_permlane16_swap_b32 v160, v162
v_permlane16_swap_b32 v161, v163
buffer_store_dwordx4 v[160:163], v70, s[44:47], s69 offen offset:0 sc0 sc1
s_waitcnt lgkmcnt(13)
ds_write_b128 v72, v[160:163] offset:2048
v_cvt_pk_bf16_f32 v164, v104, v105
v_cvt_pk_bf16_f32 v165, v106, v107
v_cvt_pk_bf16_f32 v166, v108, v109
v_cvt_pk_bf16_f32 v167, v110, v111
s_nop 0
v_permlane16_swap_b32 v164, v166
v_permlane16_swap_b32 v165, v167
buffer_store_dwordx4 v[164:167], v71, s[44:47], s69 offen offset:1024 sc0 sc1
ds_write_b128 v73, v[164:167] offset:2048
s_add_u32 s69, s69, 8192
s_waitcnt lgkmcnt(8)
v_add_f32 v69, 1.0, v69
v_rcp_f32 v69, v69
v_add_u32 v3, s97, v59
ds_read_b128 v[252:255], v3 offset:0
ds_read_b128 v[140:143], v3 offset:1024
ds_read_b128 v[216:219], v3 offset:1536
s_mul_i32 s52, s63, 128
s_add_u32 s52, s52, 37958656
v_and_b32 v1, 7, v0
v_lshl_add_u32 v76, v1, 2, s52
buffer_load_dword v77, v76, s[44:47], 0 offen sc0 sc1
s_waitcnt vmcnt(13)
v_lshlrev_b32 v8, 16, v144
v_and_b32 v9, s62, v144
v_lshlrev_b32 v10, 16, v145
v_and_b32 v11, s62, v145
v_lshlrev_b32 v12, 16, v146
v_and_b32 v13, s62, v146
v_lshlrev_b32 v14, 16, v147
v_and_b32 v15, s62, v147
v_mul_f32 v8, v8, v69
v_mul_f32 v9, v9, v69
v_mul_f32 v10, v10, v69
v_mul_f32 v11, v11, v69
v_mul_f32 v12, v12, v69
v_mul_f32 v13, v13, v69
v_mul_f32 v14, v14, v69
v_mul_f32 v15, v15, v69
s_waitcnt lgkmcnt(2)
v_dot2_f32_bf16 v8, v252, s88, v8
v_dot2_f32_bf16 v9, v252, s89, v9
v_dot2_f32_bf16 v10, v253, s88, v10
v_dot2_f32_bf16 v11, v253, s89, v11
v_dot2_f32_bf16 v12, v254, s88, v12
v_dot2_f32_bf16 v13, v254, s89, v13
v_dot2_f32_bf16 v14, v255, s88, v14
v_dot2_f32_bf16 v15, v255, s89, v15
v_dot2_f32_bf16 v8, v40, s88, v8
v_dot2_f32_bf16 v9, v40, s89, v9
v_dot2_f32_bf16 v10, v41, s88, v10
v_dot2_f32_bf16 v11, v41, s89, v11
v_dot2_f32_bf16 v12, v42, s88, v12
v_dot2_f32_bf16 v13, v42, s89, v13
v_dot2_f32_bf16 v14, v43, s88, v14
v_dot2_f32_bf16 v15, v43, s89, v15
v_dot2_f32_bf16 v8, v44, s88, v8
v_dot2_f32_bf16 v9, v44, s89, v9
v_dot2_f32_bf16 v10, v45, s88, v10
v_dot2_f32_bf16 v11, v45, s89, v11
v_dot2_f32_bf16 v12, v46, s88, v12
v_dot2_f32_bf16 v13, v46, s89, v13
v_dot2_f32_bf16 v14, v47, s88, v14
v_dot2_f32_bf16 v15, v47, s89, v15
v_dot2_f32_bf16 v8, v48, s88, v8
v_dot2_f32_bf16 v9, v48, s89, v9
v_dot2_f32_bf16 v10, v49, s88, v10
v_dot2_f32_bf16 v11, v49, s89, v11
v_dot2_f32_bf16 v12, v50, s88, v12
v_dot2_f32_bf16 v13, v50, s89, v13
v_dot2_f32_bf16 v14, v51, s88, v14
v_dot2_f32_bf16 v15, v51, s89, v15
v_dot2_f32_bf16 v8, v52, s88, v8
v_dot2_f32_bf16 v9, v52, s89, v9
v_dot2_f32_bf16 v10, v53, s88, v10
v_dot2_f32_bf16 v11, v53, s89, v11
v_dot2_f32_bf16 v12, v54, s88, v12
v_dot2_f32_bf16 v13, v54, s89, v13
v_dot2_f32_bf16 v14, v55, s88, v14
v_dot2_f32_bf16 v15, v55, s89, v15
v_dot2_f32_bf16 v8, v176, s88, v8
v_dot2_f32_bf16 v9, v176, s89, v9
v_dot2_f32_bf16 v10, v177, s88, v10
v_dot2_f32_bf16 v11, v177, s89, v11
v_dot2_f32_bf16 v12, v178, s88, v12
v_dot2_f32_bf16 v13, v178, s89, v13
v_dot2_f32_bf16 v14, v179, s88, v14
v_dot2_f32_bf16 v15, v179, s89, v15
v_dot2_f32_bf16 v8, v180, s88, v8
v_dot2_f32_bf16 v9, v180, s89, v9
v_dot2_f32_bf16 v10, v181, s88, v10
v_dot2_f32_bf16 v11, v181, s89, v11
v_dot2_f32_bf16 v12, v182, s88, v12
v_dot2_f32_bf16 v13, v182, s89, v13
v_dot2_f32_bf16 v14, v183, s88, v14
v_dot2_f32_bf16 v15, v183, s89, v15
v_dot2_f32_bf16 v8, v184, s88, v8
v_dot2_f32_bf16 v9, v184, s89, v9
v_dot2_f32_bf16 v10, v185, s88, v10
v_dot2_f32_bf16 v11, v185, s89, v11
v_dot2_f32_bf16 v12, v186, s88, v12
v_dot2_f32_bf16 v13, v186, s89, v13
v_dot2_f32_bf16 v14, v187, s88, v14
v_dot2_f32_bf16 v15, v187, s89, v15
v_cvt_pk_bf16_f32 v96, v8, v9
v_cvt_pk_bf16_f32 v97, v10, v11
v_cvt_pk_bf16_f32 v98, v12, v13
v_cvt_pk_bf16_f32 v99, v14, v15
s_waitcnt vmcnt(12)
v_lshlrev_b32 v16, 16, v148
v_and_b32 v17, s62, v148
v_lshlrev_b32 v18, 16, v149
v_and_b32 v19, s62, v149
v_lshlrev_b32 v20, 16, v150
v_and_b32 v21, s62, v150
v_lshlrev_b32 v22, 16, v151
v_and_b32 v23, s62, v151
v_mul_f32 v16, v16, v69
v_mul_f32 v17, v17, v69
v_mul_f32 v18, v18, v69
v_mul_f32 v19, v19, v69
v_mul_f32 v20, v20, v69
v_mul_f32 v21, v21, v69
v_mul_f32 v22, v22, v69
v_mul_f32 v23, v23, v69
s_waitcnt lgkmcnt(1)
v_dot2_f32_bf16 v16, v140, s88, v16
v_dot2_f32_bf16 v17, v140, s89, v17
v_dot2_f32_bf16 v18, v141, s88, v18
v_dot2_f32_bf16 v19, v141, s89, v19
v_dot2_f32_bf16 v20, v142, s88, v20
v_dot2_f32_bf16 v21, v142, s89, v21
v_dot2_f32_bf16 v22, v143, s88, v22
v_dot2_f32_bf16 v23, v143, s89, v23
s_waitcnt vmcnt(10)
v_dot2_f32_bf16 v16, v112, s88, v16
v_dot2_f32_bf16 v17, v112, s89, v17
v_dot2_f32_bf16 v18, v113, s88, v18
v_dot2_f32_bf16 v19, v113, s89, v19
v_dot2_f32_bf16 v20, v114, s88, v20
v_dot2_f32_bf16 v21, v114, s89, v21
v_dot2_f32_bf16 v22, v115, s88, v22
v_dot2_f32_bf16 v23, v115, s89, v23
s_waitcnt vmcnt(9)
v_dot2_f32_bf16 v16, v116, s88, v16
v_dot2_f32_bf16 v17, v116, s89, v17
v_dot2_f32_bf16 v18, v117, s88, v18
v_dot2_f32_bf16 v19, v117, s89, v19
v_dot2_f32_bf16 v20, v118, s88, v20
v_dot2_f32_bf16 v21, v118, s89, v21
v_dot2_f32_bf16 v22, v119, s88, v22
v_dot2_f32_bf16 v23, v119, s89, v23
s_waitcnt vmcnt(8)
v_dot2_f32_bf16 v16, v120, s88, v16
v_dot2_f32_bf16 v17, v120, s89, v17
v_dot2_f32_bf16 v18, v121, s88, v18
v_dot2_f32_bf16 v19, v121, s89, v19
v_dot2_f32_bf16 v20, v122, s88, v20
v_dot2_f32_bf16 v21, v122, s89, v21
v_dot2_f32_bf16 v22, v123, s88, v22
v_dot2_f32_bf16 v23, v123, s89, v23
s_waitcnt vmcnt(7)
v_dot2_f32_bf16 v16, v124, s88, v16
v_dot2_f32_bf16 v17, v124, s89, v17
v_dot2_f32_bf16 v18, v125, s88, v18
v_dot2_f32_bf16 v19, v125, s89, v19
v_dot2_f32_bf16 v20, v126, s88, v20
v_dot2_f32_bf16 v21, v126, s89, v21
v_dot2_f32_bf16 v22, v127, s88, v22
v_dot2_f32_bf16 v23, v127, s89, v23
s_waitcnt vmcnt(6)
v_dot2_f32_bf16 v16, v128, s88, v16
v_dot2_f32_bf16 v17, v128, s89, v17
v_dot2_f32_bf16 v18, v129, s88, v18
v_dot2_f32_bf16 v19, v129, s89, v19
v_dot2_f32_bf16 v20, v130, s88, v20
v_dot2_f32_bf16 v21, v130, s89, v21
v_dot2_f32_bf16 v22, v131, s88, v22
v_dot2_f32_bf16 v23, v131, s89, v23
s_waitcnt vmcnt(5)
v_dot2_f32_bf16 v16, v132, s88, v16
v_dot2_f32_bf16 v17, v132, s89, v17
v_dot2_f32_bf16 v18, v133, s88, v18
v_dot2_f32_bf16 v19, v133, s89, v19
v_dot2_f32_bf16 v20, v134, s88, v20
v_dot2_f32_bf16 v21, v134, s89, v21
v_dot2_f32_bf16 v22, v135, s88, v22
v_dot2_f32_bf16 v23, v135, s89, v23
s_waitcnt vmcnt(4)
v_dot2_f32_bf16 v16, v136, s88, v16
v_dot2_f32_bf16 v17, v136, s89, v17
v_dot2_f32_bf16 v18, v137, s88, v18
v_dot2_f32_bf16 v19, v137, s89, v19
v_dot2_f32_bf16 v20, v138, s88, v20
v_dot2_f32_bf16 v21, v138, s89, v21
v_dot2_f32_bf16 v22, v139, s88, v22
v_dot2_f32_bf16 v23, v139, s89, v23
v_cvt_pk_bf16_f32 v100, v16, v17
v_cvt_pk_bf16_f32 v101, v18, v19
v_cvt_pk_bf16_f32 v102, v20, v21
v_cvt_pk_bf16_f32 v103, v22, v23
s_waitcnt vmcnt(0)
s_sub_u32 s52, s51, 4
v_subrev_u32 v77, s52, v77
v_cmp_lt_u32 vcc, 4, v77
s_nop 3
s_cbranch_vccz L_fl_ok_26
s_mov_b32 s58, 100000
L_fl_poll_27:
buffer_load_dword v77, v76, s[44:47], 0 offen sc0 sc1
s_waitcnt vmcnt(0)
s_sub_u32 s52, s51, 4
v_subrev_u32 v77, s52, v77
v_cmp_lt_u32 vcc, 4, v77
s_sub_u32 s58, s58, 1
s_cmp_eq_u32 s58, 0
s_cbranch_scc1 L_fl_ok_26
s_nop 1
s_cbranch_vccnz L_fl_poll_27
L_fl_ok_26:
s_add_u32 s70, s90, 49152
buffer_load_dwordx4 v[188:191], v62, s[44:47], s70 offen sc0 sc1
s_add_u32 s70, s91, 49152
buffer_load_dwordx4 v[192:195], v62, s[44:47], s70 offen sc0 sc1
s_add_u32 s70, s92, 49152
buffer_load_dwordx4 v[196:199], v62, s[44:47], s70 offen sc0 sc1
s_add_u32 s70, s93, 49152
buffer_load_dwordx4 v[200:203], v62, s[44:47], s70 offen sc0 sc1
s_add_u32 s70, s94, 49152
buffer_load_dwordx4 v[204:207], v62, s[44:47], s70 offen sc0 sc1
s_add_u32 s70, s95, 49152
buffer_load_dwordx4 v[208:211], v62, s[44:47], s70 offen sc0 sc1
s_add_u32 s70, s96, 49152
buffer_load_dwordx4 v[212:215], v62, s[44:47], s70 offen sc0 sc1
buffer_store_dwordx4 v[96:99], v66, s[36:39], 0 offen offset:0 nt
buffer_store_dwordx4 v[100:103], v67, s[36:39], 0 offen offset:512 nt
s_waitcnt vmcnt(2)
v_max3_u32 v1, v188, v189, v190
v_max3_u32 v2, v191, v192, v193
v_max3_u32 v1, v1, v194, v195
v_max3_u32 v2, v2, v196, v197
v_max3_u32 v1, v1, v198, v199
v_max3_u32 v2, v2, v200, v201
v_max3_u32 v1, v1, v202, v203
v_max3_u32 v2, v2, v204, v205
v_max3_u32 v1, v1, v206, v207
v_max3_u32 v2, v2, v208, v209
v_max3_u32 v1, v1, v210, v211
v_max3_u32 v2, v2, v212, v213
v_max3_u32 v1, v1, v214, v215
v_max3_u32 v2, v2, v188, v189
v_max3_u32 v1, v1, v190, v191
v_max_u32 v1, v1, v2
v_cmp_eq_u32 vcc, -1, v1
s_nop 3
s_cbranch_vccz L_pp_ok_28
s_mov_b32 s58, 100000
L_pp_poll_29:
s_add_u32 s70, s90, 49152
buffer_load_dwordx4 v[188:191], v62, s[44:47], s70 offen sc0 sc1
s_add_u32 s70, s91, 49152
buffer_load_dwordx4 v[192:195], v62, s[44:47], s70 offen sc0 sc1
s_add_u32 s70, s92, 49152
buffer_load_dwordx4 v[196:199], v62, s[44:47], s70 offen sc0 sc1
s_add_u32 s70, s93, 49152
buffer_load_dwordx4 v[200:203], v62, s[44:47], s70 offen sc0 sc1
s_add_u32 s70, s94, 49152
buffer_load_dwordx4 v[204:207], v62, s[44:47], s70 offen sc0 sc1
s_add_u32 s70, s95, 49152
buffer_load_dwordx4 v[208:211], v62, s[44:47], s70 offen sc0 sc1
s_add_u32 s70, s96, 49152
buffer_load_dwordx4 v[212:215], v62, s[44:47], s70 offen sc0 sc1
s_waitcnt vmcnt(0)
v_max3_u32 v1, v188, v189, v190
v_max3_u32 v2, v191, v192, v193
v_max3_u32 v1, v1, v194, v195
v_max3_u32 v2, v2, v196, v197
v_max3_u32 v1, v1, v198, v199
v_max3_u32 v2, v2, v200, v201
v_max3_u32 v1, v1, v202, v203
v_max3_u32 v2, v2, v204, v205
v_max3_u32 v1, v1, v206, v207
v_max3_u32 v2, v2, v208, v209
v_max3_u32 v1, v1, v210, v211
v_max3_u32 v2, v2, v212, v213
v_max3_u32 v1, v1, v214, v215
v_max3_u32 v2, v2, v188, v189
v_max3_u32 v1, v1, v190, v191
v_max_u32 v1, v1, v2
v_cmp_eq_u32 vcc, -1, v1
s_sub_u32 s58, s58, 1
s_cmp_eq_u32 s58, 0
s_cbranch_scc1 L_pp_ok_28
s_nop 1
s_cbranch_vccnz L_pp_poll_29
L_pp_ok_28:
v_lshlrev_b32 v24, 16, v152
v_and_b32 v25, s62, v152
v_lshlrev_b32 v26, 16, v153
v_and_b32 v27, s62, v153
v_lshlrev_b32 v28, 16, v154
v_and_b32 v29, s62, v154
v_lshlrev_b32 v30, 16, v155
v_and_b32 v31, s62, v155
v_mul_f32 v24, v24, v69
v_mul_f32 v25, v25, v69
v_mul_f32 v26, v26, v69
v_mul_f32 v27, v27, v69
v_mul_f32 v28, v28, v69
v_mul_f32 v29, v29, v69
v_mul_f32 v30, v30, v69
v_mul_f32 v31, v31, v69
s_waitcnt lgkmcnt(0)
v_dot2_f32_bf16 v24, v216, s88, v24
v_dot2_f32_bf16 v25, v216, s89, v25
v_dot2_f32_bf16 v26, v217, s88, v26
v_dot2_f32_bf16 v27, v217, s89, v27
v_dot2_f32_bf16 v28, v218, s88, v28
v_dot2_f32_bf16 v29, v218, s89, v29
v_dot2_f32_bf16 v30, v219, s88, v30
v_dot2_f32_bf16 v31, v219, s89, v31
v_dot2_f32_bf16 v24, v188, s88, v24
v_dot2_f32_bf16 v25, v188, s89, v25
v_dot2_f32_bf16 v26, v189, s88, v26
v_dot2_f32_bf16 v27, v189, s89, v27
v_dot2_f32_bf16 v28, v190, s88, v28
v_dot2_f32_bf16 v29, v190, s89, v29
v_dot2_f32_bf16 v30, v191, s88, v30
v_dot2_f32_bf16 v31, v191, s89, v31
v_dot2_f32_bf16 v24, v192, s88, v24
v_dot2_f32_bf16 v25, v192, s89, v25
v_dot2_f32_bf16 v26, v193, s88, v26
v_dot2_f32_bf16 v27, v193, s89, v27
v_dot2_f32_bf16 v28, v194, s88, v28
v_dot2_f32_bf16 v29, v194, s89, v29
v_dot2_f32_bf16 v30, v195, s88, v30
v_dot2_f32_bf16 v31, v195, s89, v31
v_dot2_f32_bf16 v24, v196, s88, v24
v_dot2_f32_bf16 v25, v196, s89, v25
v_dot2_f32_bf16 v26, v197, s88, v26
v_dot2_f32_bf16 v27, v197, s89, v27
v_dot2_f32_bf16 v28, v198, s88, v28
v_dot2_f32_bf16 v29, v198, s89, v29
v_dot2_f32_bf16 v30, v199, s88, v30
v_dot2_f32_bf16 v31, v199, s89, v31
v_dot2_f32_bf16 v24, v200, s88, v24
v_dot2_f32_bf16 v25, v200, s89, v25
v_dot2_f32_bf16 v26, v201, s88, v26
v_dot2_f32_bf16 v27, v201, s89, v27
v_dot2_f32_bf16 v28, v202, s88, v28
v_dot2_f32_bf16 v29, v202, s89, v29
v_dot2_f32_bf16 v30, v203, s88, v30
v_dot2_f32_bf16 v31, v203, s89, v31
v_dot2_f32_bf16 v24, v204, s88, v24
v_dot2_f32_bf16 v25, v204, s89, v25
v_dot2_f32_bf16 v26, v205, s88, v26
v_dot2_f32_bf16 v27, v205, s89, v27
v_dot2_f32_bf16 v28, v206, s88, v28
v_dot2_f32_bf16 v29, v206, s89, v29
v_dot2_f32_bf16 v30, v207, s88, v30
v_dot2_f32_bf16 v31, v207, s89, v31
v_dot2_f32_bf16 v24, v208, s88, v24
v_dot2_f32_bf16 v25, v208, s89, v25
v_dot2_f32_bf16 v26, v209, s88, v26
v_dot2_f32_bf16 v27, v209, s89, v27
v_dot2_f32_bf16 v28, v210, s88, v28
v_dot2_f32_bf16 v29, v210, s89, v29
v_dot2_f32_bf16 v30, v211, s88, v30
v_dot2_f32_bf16 v31, v211, s89, v31
v_dot2_f32_bf16 v24, v212, s88, v24
v_dot2_f32_bf16 v25, v212, s89, v25
v_dot2_f32_bf16 v26, v213, s88, v26
v_dot2_f32_bf16 v27, v213, s89, v27
v_dot2_f32_bf16 v28, v214, s88, v28
v_dot2_f32_bf16 v29, v214, s89, v29
v_dot2_f32_bf16 v30, v215, s88, v30
v_dot2_f32_bf16 v31, v215, s89, v31
v_cvt_pk_bf16_f32 v104, v24, v25
v_cvt_pk_bf16_f32 v105, v26, v27
v_cvt_pk_bf16_f32 v106, v28, v29
v_cvt_pk_bf16_f32 v107, v30, v31
buffer_store_dwordx4 v[104:107], v68, s[36:39], 0 offen offset:768 nt
s_xor_b32 s52, s2, 36
s_xor_b32 s53, s50, 0
s_or_b32 s52, s52, s53
s_cmp_lg_u32 s52, 0
s_cbranch_scc1 L_noclr_30
v_mov_b32 v1, 0
s_mov_b64 exec, 1
buffer_store_dword v1, v1, s[40:43], 0 offen sc0 sc1
s_mov_b64 exec, -1
L_noclr_30:
L_end:
s_endpgm
.section .rodata,"a"
.p2align 6
.amdhsa_kernel gated_mix__sliding_local_dilated__mixer_s_mlp__prompt_kernel
  .amdhsa_next_free_vgpr 512
  .amdhsa_next_free_sgpr 102
  .amdhsa_accum_offset 256
  .amdhsa_group_segment_fixed_size 0
  .amdhsa_kernarg_size 96
  .amdhsa_user_sgpr_count 2
  .amdhsa_user_sgpr_kernarg_segment_ptr 1
  .amdhsa_system_sgpr_workgroup_id_x 1
.end_amdhsa_kernel
```
